```python
import torch

def _softmax(x, axis=-1):
    return torch.softmax(x, dim=axis)
def _gelu(x):
    return torch.nn.functional.gelu(x, approximate="tanh")
def _silu(x):
    return torch.nn.functional.silu(x)
def _sigmoid(x):
    return torch.sigmoid(x)
def _layernorm(x, axis=-1, eps=1e-5):
    m = x.mean(dim=axis, keepdim=True)
    v = x.var(dim=axis, keepdim=True, unbiased=False)
    return (x - m) / torch.sqrt(v + eps)
def _scatter_add(tgt, idx, src, axis=0):
    return tgt.clone().index_add_(axis, idx, src)
def _segment_sum(src, seg, n):
    out = torch.zeros((n,) + src.shape[1:], dtype=src.dtype)
    return out.index_add_(0, seg, src)
def _pad(x, pw):
    flat = tuple(v for pair in reversed(pw) for v in pair)
    return torch.nn.functional.pad(x, flat)

kernel_name = 'parallel_sum__grouped_kv_mqa__mixer_channel_mlp__prompt'

def setup_inputs():

    _w = (lambda a: (lambda t: t.to(torch.bfloat16) if t.is_floating_point() else t)(torch.as_tensor(a)))
    def _A_setup():
        B, S, D, H = 1, 2048, 1024, 32
        Dh = D // H
        return {
            "x": _w((lambda *s: torch.randn(*s, dtype=torch.bfloat16) * 0.05)(B, S, D)),
            "wq": _w((lambda *s: torch.randn(*s, dtype=torch.bfloat16) * 0.05)(D, H * Dh)),
            "wk": _w((lambda *s: torch.randn(*s, dtype=torch.bfloat16) * 0.05)(D, Dh)),
            "wv": _w((lambda *s: torch.randn(*s, dtype=torch.bfloat16) * 0.05)(D, Dh)),
            "wo": _w((lambda *s: torch.randn(*s, dtype=torch.bfloat16) * 0.05)(H * Dh, D)),
        }
    _A_in = _A_setup()

    def _B_setup():
        B, S, D, F = 1, 2048, 1024, 3584
        return {
            "x": _w((lambda *s: torch.randn(*s, dtype=torch.bfloat16) * 0.05)(B, S, D)),
            "w1": _w((lambda *s: torch.randn(*s, dtype=torch.bfloat16) * 3.2)(D, F) * (D ** -0.5)),
            "b1": _w((lambda *s: torch.randn(*s, dtype=torch.bfloat16) * 1.6)(F)),
            "w2": _w((lambda *s: torch.randn(*s, dtype=torch.bfloat16) * 0.4)(F, D) * (F ** -0.5)),
            "b2": _w((lambda *s: torch.randn(*s, dtype=torch.bfloat16) * 0.8)(D)),
        }
    _B_in = _B_setup()

    return {
        "A_x": _A_in["x"],
        "A_wq": _A_in["wq"],
        "A_wk": _A_in["wk"],
        "A_wv": _A_in["wv"],
        "A_wo": _A_in["wo"],
        "B_x": _B_in["x"],
        "B_w1": _B_in["w1"],
        "B_b1": _B_in["b1"],
        "B_w2": _B_in["w2"],
        "B_b2": _B_in["b2"],
    }

def reference(A_x, A_wq, A_wk, A_wv, A_wo, B_x, B_w1, B_b1, B_w2, B_b2):
    def _A_ref(x, wq, wk, wv, wo):
        B, S, D = x.shape
        H = 32
        Dh = D // H
        q = (lambda x, *d: x.permute(*d))((x @ wq).reshape(B, S, H, Dh), 0, 2, 1, 3)
        k = x @ wk
        v = x @ wv
        scores = torch.einsum("bhqd,bkd->bhqk", q, k) * (Dh ** -0.5)
        p = _softmax(scores, axis=-1)
        o = torch.einsum("bhqk,bkd->bhqd", p, v)
        return (lambda x, *d: x.permute(*d))(o, 0, 2, 1, 3).reshape(B, S, H * Dh) @ wo

    def _B_ref(x, w1, b1, w2, b2):
        y = _layernorm(x, axis=-1)
        h = _gelu(torch.einsum("bsd,df->bsf", y, w1) + b1)
        return torch.einsum("bsf,fd->bsd", h, w2) + b2

    x = A_x
    xn = _layernorm(x, axis=-1)
    return x + _A_ref(xn, A_wq, A_wk, A_wv, A_wo) + _B_ref(xn, B_w1, B_b1, B_w2, B_b2)
```

```asm
; @launch grid=(256,1,1) block=(512,1,1) lds=163840
.amdgcn_target "amdgcn-amd-amdhsa--gfx950"
.text
.p2align 8
code_begin:
  .globl parallel_sum__grouped_kv_mqa__mixer_channel_mlp__prompt_kernel
  .p2align 8
  .type parallel_sum__grouped_kv_mqa__mixer_channel_mlp__prompt_kernel,@function
parallel_sum__grouped_kv_mqa__mixer_channel_mlp__prompt_kernel:
  s_cmp_ge_u32 s2, 256
  s_cbranch_scc1 parallel_sum__grouped_kv_mqa__mixer_channel_mlp__prompt_kernel_exit
  s_load_dwordx8 s[8:15], s[0:1], 0
  s_load_dwordx4 s[16:19], s[0:1], 48
  s_load_dwordx4 s[20:23], s[0:1], 88
  s_load_dwordx2 s[4:5], s[0:1], 32
  s_load_dwordx2 s[6:7], s[0:1], 64
  s_load_dwordx4 s[96:99], s[0:1], 72
  v_lshrrev_b32 v1, 6, v0
  v_and_b32 v0, 63, v0
  v_readfirstlane_b32 s55, v1
  s_and_b32 s57, s2, 7
  s_lshr_b32 s58, s2, 3
  s_and_b32 s48, s57, 1
  s_lshl_b32 s48, s48, 2
  s_and_b32 s59, s58, 3
  s_add_u32 s48, s48, s59
  s_lshr_b32 s57, s57, 1
  s_lshr_b32 s59, s58, 2
  s_mul_i32 s49, s57, 7
  s_add_u32 s49, s49, s59
  s_add_u32 s57, s57, 28
  s_cmp_lt_u32 s59, 7
  s_cselect_b32 s49, s49, s57
  s_cselect_b32 s56, 0, 1
  s_sub_u32 s62, s55, 4
  s_cmp_lt_u32 s55, 4
  s_cbranch_scc1 parallel_sum__grouped_kv_mqa__mixer_channel_mlp__prompt_kernel_comp
  s_cmp_eq_u32 s56, 0
  s_cbranch_scc0 parallel_sum__grouped_kv_mqa__mixer_channel_mlp__prompt_kernel_ll
  v_lshrrev_b32 v96, 3, v0
  v_and_b32 v97, 7, v0
  v_lshrrev_b32 v98, 4, v0
  v_xor_b32 v98, v97, v98
  v_lshlrev_b32 v99, 11, v96
  v_lshl_add_u32 v99, v98, 4, v99
  s_lshl_b32 s57, s48, 19
  s_lshl_b32 s58, s62, 17
  s_add_u32 s57, s57, s58
  v_add_u32 v99, s57, v99
  v_xor_b32 v98, 64, v99
  v_add_u32 v2, 0, v99
  v_add_u32 v3, 15360, v98
  v_add_u32 v4, 30720, v99
  v_add_u32 v5, 46080, v98
  v_add_u32 v6, 65536, v99
  v_add_u32 v7, 80896, v98
  v_add_u32 v8, 96256, v99
  v_add_u32 v9, 111616, v98
  v_mul_u32_u24 v96, 7168, v96
  v_bfe_u32 v98, v0, 4, 1
  v_lshlrev_b32 v98, 2, v98
  v_xor_b32 v97, v97, v98
  v_lshl_add_u32 v99, v97, 4, v96
  s_and_b32 s57, s62, 1
  s_mul_i32 s57, s57, 229376
  s_lshl_b32 s58, s49, 8
  s_add_u32 s57, s57, s58
  s_lshr_b32 s58, s62, 1
  s_lshl_b32 s58, s58, 7
  s_add_u32 s57, s57, s58
  v_add_u32 v10, s57, v99
  v_xor_b32 v99, 32, v10
  v_add_u32 v11, 56320, v99
  v_add_u32 v12, 112640, v10
  v_add_u32 v13, 168960, v99
  s_lshl_b32 s66, s62, 12
  s_add_u32 s66, s66, 98304
  s_mul_i32 s61, s62, 3072
  s_sub_u32 s61, 16384, s61
  v_lshrrev_b32 v96, 2, v0
  v_lshlrev_b32 v96, 11, v96
  v_and_b32 v97, 3, v0
  v_lshl_add_u32 v96, v97, 4, v96
  v_and_b32 v97, 32, v0
  v_xor_b32 v96, v96, v97
  s_lshl_b32 s57, s49, 6
  s_lshl_b32 s58, s62, 15
  s_add_u32 s57, s57, s58
  v_add_u32 v14, s57, v96
  s_mov_b32 s64, 0
  s_mul_i32 s65, s62, 24576
  s_mov_b32 s60, 0
  s_waitcnt lgkmcnt(0)
  s_mov_b32 s24, s8
  s_mov_b32 s25, s9
  s_mov_b32 s26, 4194304
  s_mov_b32 s27, 0x20000
  s_mov_b32 s28, s16
  s_mov_b32 s29, s17
  s_mov_b32 s30, 7340032
  s_mov_b32 s31, 0x20000
  s_mov_b32 s32, s10
  s_mov_b32 s33, s11
  s_mov_b32 s34, 2097152
  s_mov_b32 s35, 0x20000
  s_mov_b32 s36, s22
  s_mov_b32 s37, s23
  s_mov_b32 s38, 24215552
  s_mov_b32 s39, 0x20000
  s_mov_b32 s40, s18
  s_mov_b32 s41, s19
  s_mov_b32 s42, 7168
  s_mov_b32 s43, 0x20000
  s_mov_b32 s44, s20
  s_mov_b32 s45, s21
  s_mov_b32 s46, 256
  s_mov_b32 s47, 0x20000
  s_lshl_b32 s67, s64, 7
  s_mul_i32 s68, s64, 458752
  s_mov_b32 m0, s66
  s_lshl_b32 s69, s64, 17
  buffer_load_dwordx4 v10, s[28:31], s68 offen offset:0 lds
  buffer_load_dwordx4 v11, s[28:31], s68 offen offset:1024 lds
  buffer_load_dwordx4 v12, s[28:31], s68 offen offset:2048 lds
  buffer_load_dwordx4 v13, s[28:31], s68 offen offset:3072 lds
  s_mov_b32 m0, s65
  s_add_u32 s64, s64, 1
  buffer_load_dwordx4 v2, s[24:27], s67 offen offset:0 lds
  buffer_load_dwordx4 v3, s[24:27], s67 offen offset:1024 lds
  buffer_load_dwordx4 v4, s[24:27], s67 offen offset:2048 lds
  buffer_load_dwordx4 v5, s[24:27], s67 offen offset:3072 lds
  s_add_u32 m0, s65, 4096
  s_add_u32 s60, s60, 1
  buffer_load_dwordx4 v6, s[24:27], s67 offen offset:0 lds
  buffer_load_dwordx4 v7, s[24:27], s67 offen offset:1024 lds
  buffer_load_dwordx4 v8, s[24:27], s67 offen offset:2048 lds
  buffer_load_dwordx4 v9, s[24:27], s67 offen offset:3072 lds
  s_add_u32 m0, s66, s61
  s_add_u32 s65, s65, 8192
  buffer_load_dwordx4 v14, s[32:35], s69 offen lds
  s_cmp_eq_u32 s64, 16
  s_cselect_b32 s64, 2, s64
  s_add_u32 s66, s66, 20480
  s_cmp_eq_u32 s60, 3
  s_cselect_b32 s57, 24576, 0
  s_cselect_b32 s58, 61440, 0
  s_cselect_b32 s60, 0, s60
  s_sub_u32 s65, s65, s57
  s_sub_u32 s66, s66, s58
  s_lshl_b32 s67, s64, 7
  s_mul_i32 s68, s64, 458752
  s_mov_b32 m0, s66
  s_lshl_b32 s69, s64, 17
  buffer_load_dwordx4 v10, s[28:31], s68 offen offset:0 lds
  buffer_load_dwordx4 v11, s[28:31], s68 offen offset:1024 lds
  buffer_load_dwordx4 v12, s[28:31], s68 offen offset:2048 lds
  buffer_load_dwordx4 v13, s[28:31], s68 offen offset:3072 lds
  s_mov_b32 m0, s65
  s_add_u32 s64, s64, 1
  buffer_load_dwordx4 v2, s[24:27], s67 offen offset:0 lds
  buffer_load_dwordx4 v3, s[24:27], s67 offen offset:1024 lds
  buffer_load_dwordx4 v4, s[24:27], s67 offen offset:2048 lds
  buffer_load_dwordx4 v5, s[24:27], s67 offen offset:3072 lds
  s_add_u32 m0, s65, 4096
  s_add_u32 s60, s60, 1
  buffer_load_dwordx4 v6, s[24:27], s67 offen offset:0 lds
  buffer_load_dwordx4 v7, s[24:27], s67 offen offset:1024 lds
  buffer_load_dwordx4 v8, s[24:27], s67 offen offset:2048 lds
  buffer_load_dwordx4 v9, s[24:27], s67 offen offset:3072 lds
  s_add_u32 m0, s66, s61
  s_add_u32 s65, s65, 8192
  buffer_load_dwordx4 v14, s[32:35], s69 offen lds
  s_cmp_eq_u32 s64, 16
  s_cselect_b32 s64, 2, s64
  s_add_u32 s66, s66, 20480
  s_cmp_eq_u32 s60, 3
  s_cselect_b32 s57, 24576, 0
  s_cselect_b32 s58, 61440, 0
  s_cselect_b32 s60, 0, s60
  s_sub_u32 s65, s65, s57
  s_sub_u32 s66, s66, s58
  s_lshl_b32 s64, s48, 1
  s_add_u32 s64, s64, 2
  s_cmp_eq_u32 s64, 16
  s_cselect_b32 s64, 9, s64
  v_bfe_u32 v96, v0, 4, 1
  v_and_b32 v97, 3, v0
  v_lshlrev_b32 v96, 5, v96
  v_lshl_add_u32 v96, v97, 3, v96
  v_and_b32 v97, 32, v0
  v_xor_b32 v96, v96, v97
  v_bfe_u32 v98, v0, 2, 2
  v_lshrrev_b32 v97, 5, v0
  v_lshl_add_u32 v97, v97, 3, v98
  v_lshl_add_u32 v99, v97, 6, v96
  s_lshl_b32 s57, s62, 10
  s_add_u32 s57, s57, 98304
  v_add_u32 v17, s57, v99
  v_lshrrev_b32 v98, 1, v98
  s_and_b32 s57, s62, 1
  v_xor_b32 v98, s57, v98
  v_lshlrev_b32 v98, 6, v98
  v_xor_b32 v98, v98, v96
  v_lshl_add_u32 v98, v97, 7, v98
  s_lshr_b32 s57, s62, 1
  s_lshl_b32 s57, s57, 13
  s_add_u32 s57, s57, 98304
  v_add_u32 v16, s57, v98
  v_mov_b32 v112, 0
  v_mov_b32 v113, 0
  v_mov_b32 v114, 0
  v_mov_b32 v115, 0
  v_mov_b32 v116, 0
  v_mov_b32 v117, 0
  v_mov_b32 v118, 0
  v_mov_b32 v119, 0
  s_cmp_eq_u32 s48, 7
  s_cselect_b32 s74, 3, 12
  s_cselect_b32 s70, 0, 61440
  s_sub_u32 s70, 20480, s70
  s_cmp_eq_u32 s48, 7
  s_cselect_b32 s57, 0, 40960
  v_add_u32 v16, s57, v16
  v_add_u32 v17, s57, v17
  s_cmp_eq_u32 s62, 0
  s_cselect_b32 s75, 23616, 0
  s_or_b32 s75, s75, 16
  v_lshlrev_b32 v86, 2, v0
  v_mov_b32 v87, 0x1000
  v_cmp_gt_u32 vcc, 32, v0
  s_nop 1
  v_cndmask_b32 v81, v87, v86, vcc
  v_cndmask_b32 v86, v86, v87, vcc
  v_cndmask_b32 v84, 0, 1, vcc
  s_waitcnt vmcnt(13)
  s_barrier
  s_mov_b32 s63, 0
parallel_sum__grouped_kv_mqa__mixer_channel_mlp__prompt_kernel_ld_loop:
  s_bitcmp1_b32 s75, s63
  s_cbranch_scc1 parallel_sum__grouped_kv_mqa__mixer_channel_mlp__prompt_kernel_ld_sp
parallel_sum__grouped_kv_mqa__mixer_channel_mlp__prompt_kernel_ld_spret:
  s_cmp_lt_u32 s63, 14
  s_cbranch_scc0 parallel_sum__grouped_kv_mqa__mixer_channel_mlp__prompt_kernel_ld_noiss
  s_bitcmp1_b32 s74, s63
  s_cbranch_scc1 parallel_sum__grouped_kv_mqa__mixer_channel_mlp__prompt_kernel_ld_cs
  s_lshl_b32 s67, s64, 7
  s_mul_i32 s68, s64, 458752
  s_mov_b32 m0, s66
  s_lshl_b32 s69, s64, 17
  buffer_load_dwordx4 v10, s[28:31], s68 offen offset:0 lds
  buffer_load_dwordx4 v11, s[28:31], s68 offen offset:1024 lds
  buffer_load_dwordx4 v12, s[28:31], s68 offen offset:2048 lds
  buffer_load_dwordx4 v13, s[28:31], s68 offen offset:3072 lds
  s_mov_b32 m0, s65
  s_add_u32 s64, s64, 1
  buffer_load_dwordx4 v2, s[24:27], s67 offen offset:0 lds
  buffer_load_dwordx4 v3, s[24:27], s67 offen offset:1024 lds
  buffer_load_dwordx4 v4, s[24:27], s67 offen offset:2048 lds
  buffer_load_dwordx4 v5, s[24:27], s67 offen offset:3072 lds
  s_add_u32 m0, s65, 4096
  s_add_u32 s60, s60, 1
  buffer_load_dwordx4 v6, s[24:27], s67 offen offset:0 lds
  buffer_load_dwordx4 v7, s[24:27], s67 offen offset:1024 lds
  buffer_load_dwordx4 v8, s[24:27], s67 offen offset:2048 lds
  buffer_load_dwordx4 v9, s[24:27], s67 offen offset:3072 lds
  s_add_u32 m0, s66, s61
  s_add_u32 s65, s65, 8192
  buffer_load_dwordx4 v14, s[32:35], s69 offen lds
  s_cmp_eq_u32 s64, 16
  s_cselect_b32 s64, 2, s64
  s_add_u32 s66, s66, 20480
  s_cmp_eq_u32 s60, 3
  s_cselect_b32 s57, 24576, 0
  s_cselect_b32 s58, 61440, 0
  s_cselect_b32 s60, 0, s60
  s_sub_u32 s65, s65, s57
  s_sub_u32 s66, s66, s58
parallel_sum__grouped_kv_mqa__mixer_channel_mlp__prompt_kernel_ld_csret:
  s_waitcnt vmcnt(13) lgkmcnt(0)
parallel_sum__grouped_kv_mqa__mixer_channel_mlp__prompt_kernel_ld_w0:
  s_barrier
  s_add_u32 s63, s63, 1
  s_branch parallel_sum__grouped_kv_mqa__mixer_channel_mlp__prompt_kernel_ld_loop
parallel_sum__grouped_kv_mqa__mixer_channel_mlp__prompt_kernel_ld_noiss:
  s_waitcnt vmcnt(0)
  s_cmp_eq_u32 s62, 0
  s_cbranch_scc1 parallel_sum__grouped_kv_mqa__mixer_channel_mlp__prompt_kernel_ld_ck
parallel_sum__grouped_kv_mqa__mixer_channel_mlp__prompt_kernel_ld_ckret:
  s_barrier
  s_branch parallel_sum__grouped_kv_mqa__mixer_channel_mlp__prompt_kernel_att_early
parallel_sum__grouped_kv_mqa__mixer_channel_mlp__prompt_kernel_att_early_ret:
  s_barrier
  s_branch parallel_sum__grouped_kv_mqa__mixer_channel_mlp__prompt_kernel_att
parallel_sum__grouped_kv_mqa__mixer_channel_mlp__prompt_kernel_ld_cs:
  ds_read_b64_tr_b16 v[32:33], v16 offset:0
  ds_read_b64_tr_b16 v[34:35], v16 offset:512
  ds_read_b64_tr_b16 v[36:37], v16 offset:2048
  ds_read_b64_tr_b16 v[38:39], v16 offset:2560
  ds_read_b64_tr_b16 v[40:41], v16 offset:4096
  ds_read_b64_tr_b16 v[42:43], v16 offset:4608
  ds_read_b64_tr_b16 v[44:45], v16 offset:6144
  ds_read_b64_tr_b16 v[46:47], v16 offset:6656
  ds_read_b64_tr_b16 v[48:49], v17 offset:16384
  ds_read_b64_tr_b16 v[50:51], v17 offset:16640
  v_add_u32 v16, s70, v16
  v_add_u32 v17, s70, v17
  s_lshl_b32 s67, s64, 7
  s_mul_i32 s68, s64, 458752
  s_mov_b32 m0, s66
  s_lshl_b32 s69, s64, 17
  buffer_load_dwordx4 v10, s[28:31], s68 offen offset:0 lds
  buffer_load_dwordx4 v11, s[28:31], s68 offen offset:1024 lds
  s_waitcnt lgkmcnt(0)
  v_lshlrev_b32 v104, 16, v32
  v_lshlrev_b32 v105, 16, v33
  v_lshlrev_b32 v106, 16, v34
  v_lshlrev_b32 v107, 16, v35
  v_and_b32 v32, 0xffff0000, v32
  v_and_b32 v33, 0xffff0000, v33
  v_and_b32 v34, 0xffff0000, v34
  buffer_load_dwordx4 v12, s[28:31], s68 offen offset:2048 lds
  v_and_b32 v35, 0xffff0000, v35
  v_add_f32 v112, v112, v104
  v_add_f32 v113, v113, v105
  v_add_f32 v114, v114, v106
  v_add_f32 v115, v115, v107
  v_add_f32 v112, v112, v32
  v_add_f32 v113, v113, v33
  v_add_f32 v114, v114, v34
  buffer_load_dwordx4 v13, s[28:31], s68 offen offset:3072 lds
  v_add_f32 v115, v115, v35
  v_lshlrev_b32 v104, 16, v36
  v_lshlrev_b32 v105, 16, v37
  v_lshlrev_b32 v106, 16, v38
  v_lshlrev_b32 v107, 16, v39
  v_and_b32 v36, 0xffff0000, v36
  v_and_b32 v37, 0xffff0000, v37
  v_and_b32 v38, 0xffff0000, v38
  s_mov_b32 m0, s65
  s_add_u32 s64, s64, 1
  buffer_load_dwordx4 v2, s[24:27], s67 offen offset:0 lds
  v_and_b32 v39, 0xffff0000, v39
  v_add_f32 v112, v112, v104
  v_add_f32 v113, v113, v105
  v_add_f32 v114, v114, v106
  v_add_f32 v115, v115, v107
  v_add_f32 v112, v112, v36
  v_add_f32 v113, v113, v37
  v_add_f32 v114, v114, v38
  buffer_load_dwordx4 v3, s[24:27], s67 offen offset:1024 lds
  v_add_f32 v115, v115, v39
  v_lshlrev_b32 v104, 16, v40
  v_lshlrev_b32 v105, 16, v41
  v_lshlrev_b32 v106, 16, v42
  v_lshlrev_b32 v107, 16, v43
  v_and_b32 v40, 0xffff0000, v40
  v_and_b32 v41, 0xffff0000, v41
  v_and_b32 v42, 0xffff0000, v42
  buffer_load_dwordx4 v4, s[24:27], s67 offen offset:2048 lds
  v_and_b32 v43, 0xffff0000, v43
  v_add_f32 v112, v112, v104
  v_add_f32 v113, v113, v105
  v_add_f32 v114, v114, v106
  v_add_f32 v115, v115, v107
  v_add_f32 v112, v112, v40
  v_add_f32 v113, v113, v41
  v_add_f32 v114, v114, v42
  buffer_load_dwordx4 v5, s[24:27], s67 offen offset:3072 lds
  v_add_f32 v115, v115, v43
  v_lshlrev_b32 v104, 16, v44
  v_lshlrev_b32 v105, 16, v45
  v_lshlrev_b32 v106, 16, v46
  v_lshlrev_b32 v107, 16, v47
  v_and_b32 v44, 0xffff0000, v44
  v_and_b32 v45, 0xffff0000, v45
  v_and_b32 v46, 0xffff0000, v46
  s_add_u32 m0, s65, 4096
  s_add_u32 s60, s60, 1
  buffer_load_dwordx4 v6, s[24:27], s67 offen offset:0 lds
  v_and_b32 v47, 0xffff0000, v47
  v_add_f32 v112, v112, v104
  v_add_f32 v113, v113, v105
  v_add_f32 v114, v114, v106
  v_add_f32 v115, v115, v107
  v_add_f32 v112, v112, v44
  v_add_f32 v113, v113, v45
  v_add_f32 v114, v114, v46
  buffer_load_dwordx4 v7, s[24:27], s67 offen offset:1024 lds
  v_add_f32 v115, v115, v47
  v_lshlrev_b32 v104, 16, v48
  v_lshlrev_b32 v105, 16, v49
  v_lshlrev_b32 v106, 16, v50
  v_lshlrev_b32 v107, 16, v51
  v_and_b32 v48, 0xffff0000, v48
  v_and_b32 v49, 0xffff0000, v49
  v_and_b32 v50, 0xffff0000, v50
  buffer_load_dwordx4 v8, s[24:27], s67 offen offset:2048 lds
  v_and_b32 v51, 0xffff0000, v51
  v_add_f32 v116, v116, v104
  v_add_f32 v117, v117, v105
  v_add_f32 v118, v118, v106
  v_add_f32 v119, v119, v107
  v_add_f32 v116, v116, v48
  v_add_f32 v117, v117, v49
  v_add_f32 v118, v118, v50
  buffer_load_dwordx4 v9, s[24:27], s67 offen offset:3072 lds
  v_add_f32 v119, v119, v51
  s_add_u32 m0, s66, s61
  s_add_u32 s65, s65, 8192
  buffer_load_dwordx4 v14, s[32:35], s69 offen lds
  s_cmp_eq_u32 s64, 16
  s_cselect_b32 s64, 2, s64
  s_add_u32 s66, s66, 20480
  s_cmp_eq_u32 s60, 3
  s_cselect_b32 s57, 24576, 0
  s_cselect_b32 s58, 61440, 0
  s_cselect_b32 s60, 0, s60
  s_sub_u32 s65, s65, s57
  s_sub_u32 s66, s66, s58
  s_branch parallel_sum__grouped_kv_mqa__mixer_channel_mlp__prompt_kernel_ld_csret
parallel_sum__grouped_kv_mqa__mixer_channel_mlp__prompt_kernel_ld_sp:
  s_cmp_eq_u32 s63, 4
  s_cbranch_scc0 parallel_sum__grouped_kv_mqa__mixer_channel_mlp__prompt_kernel_ld_n3
  v_add_f32 v26, v112, v113
  v_add_f32 v27, v114, v115
  v_add_f32 v28, v116, v117
  v_add_f32 v29, v118, v119
  v_add_f32 v26, v26, v27
  v_add_f32 v28, v28, v29
  v_mov_b32 v27, v26
  v_mov_b32 v29, v28
  v_and_b32 v97, 31, v0
  v_lshlrev_b32 v97, 2, v97
  s_lshl_b32 s57, s62, 7
  v_permlane32_swap_b32 v26, v27
  v_permlane32_swap_b32 v28, v29
  s_add_u32 s59, s57, 161792
  v_add_u32 v98, s59, v97
  v_mov_b32 v96, 0
  ds_write_b32 v98, v96
  s_lshl_b32 s58, s49, 3
  s_add_u32 s58, s58, s48
  s_lshl_b32 s58, s58, 10
  s_add_u32 s57, s57, s58
  s_add_u32 s57, s57, 23363584
  v_add_f32 v26, v26, v27
  v_add_f32 v28, v28, v29
  buffer_store_dword v26, v97, s[36:39], s57 offen sc1
  buffer_store_dword v28, v97, s[36:39], s57 offen offset:512 sc1
  s_branch parallel_sum__grouped_kv_mqa__mixer_channel_mlp__prompt_kernel_ld_spret
parallel_sum__grouped_kv_mqa__mixer_channel_mlp__prompt_kernel_ld_n3:
  s_cmp_eq_u32 s63, 6
  s_cbranch_scc0 parallel_sum__grouped_kv_mqa__mixer_channel_mlp__prompt_kernel_ld_n5
  s_lshl_b32 s57, s49, 2
  v_mov_b32 v96, 1
  v_lshlrev_b32 v97, 8, v0
  buffer_atomic_add v96, v97, s[44:47], s57 offen offset:128 sc1
  s_lshl_b32 s57, s49, 8
  v_lshlrev_b32 v98, 3, v0
  buffer_load_dwordx2 v[64:65], v98, s[40:43], s57 offen
  s_add_u32 s57, s49, 32
  v_cmp_eq_u32 vcc, s57, v0
  s_nop 1
  v_cndmask_b32 v85, 0, 8, vcc
  s_branch parallel_sum__grouped_kv_mqa__mixer_channel_mlp__prompt_kernel_ld_spret
parallel_sum__grouped_kv_mqa__mixer_channel_mlp__prompt_kernel_ld_n5:
  s_cmp_eq_u32 s63, 11
  s_cbranch_scc0 parallel_sum__grouped_kv_mqa__mixer_channel_mlp__prompt_kernel_ld_n11
  s_waitcnt vmcnt(14)
  s_mov_b32 s59, 0
parallel_sum__grouped_kv_mqa__mixer_channel_mlp__prompt_kernel_ld_p11:
  v_cmp_gt_u32 vcc, v85, v82
  s_nop 1
  s_cbranch_vccz parallel_sum__grouped_kv_mqa__mixer_channel_mlp__prompt_kernel_ld_p11_ok
  s_cmp_eq_u32 s59, 0
  s_cbranch_scc1 parallel_sum__grouped_kv_mqa__mixer_channel_mlp__prompt_kernel_ld_p11_ns
  s_sleep 16
parallel_sum__grouped_kv_mqa__mixer_channel_mlp__prompt_kernel_ld_p11_ns:
  buffer_load_dword v82, v86, s[44:47], 0 offen sc1
  s_waitcnt vmcnt(0)
  s_add_u32 s59, s59, 1
  s_cmp_lt_u32 s59, 0x40000
  s_cbranch_scc1 parallel_sum__grouped_kv_mqa__mixer_channel_mlp__prompt_kernel_ld_p11
parallel_sum__grouped_kv_mqa__mixer_channel_mlp__prompt_kernel_ld_p11_ok:
  v_lshlrev_b32 v96, 4, v0
  s_lshl_b32 s57, s49, 13
  s_add_u32 s57, s57, 23363584
  s_add_u32 s58, s57, 4096
  buffer_load_dwordx4 v[32:35], v96, s[36:39], s57 offen offset:0 sc1
  buffer_load_dwordx4 v[36:39], v96, s[36:39], s57 offen offset:1024 sc1
  buffer_load_dwordx4 v[40:43], v96, s[36:39], s57 offen offset:2048 sc1
  buffer_load_dwordx4 v[44:47], v96, s[36:39], s57 offen offset:3072 sc1
  buffer_load_dwordx4 v[48:51], v96, s[36:39], s58 offen offset:0 sc1
  buffer_load_dwordx4 v[52:55], v96, s[36:39], s58 offen offset:1024 sc1
  buffer_load_dwordx4 v[56:59], v96, s[36:39], s58 offen offset:2048 sc1
  buffer_load_dwordx4 v[60:63], v96, s[36:39], s58 offen offset:3072 sc1
  s_branch parallel_sum__grouped_kv_mqa__mixer_channel_mlp__prompt_kernel_ld_spret
parallel_sum__grouped_kv_mqa__mixer_channel_mlp__prompt_kernel_ld_n11:
  s_cmp_eq_u32 s63, 12
  s_cbranch_scc0 parallel_sum__grouped_kv_mqa__mixer_channel_mlp__prompt_kernel_ld_n12
  s_waitcnt vmcnt(14)
  v_add_f32 v32, v32, v48
  v_add_f32 v33, v33, v49
  v_add_f32 v34, v34, v50
  v_add_f32 v35, v35, v51
  v_add_f32 v36, v36, v52
  v_add_f32 v37, v37, v53
  v_add_f32 v38, v38, v54
  v_add_f32 v39, v39, v55
  v_add_f32 v40, v40, v56
  v_add_f32 v41, v41, v57
  v_add_f32 v42, v42, v58
  v_add_f32 v43, v43, v59
  v_add_f32 v44, v44, v60
  v_add_f32 v45, v45, v61
  v_add_f32 v46, v46, v62
  v_add_f32 v47, v47, v63
  v_add_f32 v32, v32, v40
  v_add_f32 v33, v33, v41
  v_add_f32 v34, v34, v42
  v_add_f32 v35, v35, v43
  v_add_f32 v36, v36, v44
  v_add_f32 v37, v37, v45
  v_add_f32 v38, v38, v46
  v_add_f32 v39, v39, v47
  v_add_f32 v32, v32, v36
  v_add_f32 v33, v33, v37
  v_add_f32 v34, v34, v38
  v_add_f32 v35, v35, v39
  v_lshlrev_b32 v68, 16, v64
  v_and_b32 v69, 0xffff0000, v64
  v_lshlrev_b32 v70, 16, v65
  v_and_b32 v71, 0xffff0000, v65
  v_lshlrev_b32 v96, 4, v0
  v_add_u32 v96, 159744, v96
  ds_write_b128 v96, v[32:35]
  ds_write_b128 v96, v[68:71] offset:1024
  s_branch parallel_sum__grouped_kv_mqa__mixer_channel_mlp__prompt_kernel_ld_spret
parallel_sum__grouped_kv_mqa__mixer_channel_mlp__prompt_kernel_ld_n12:
  s_cmp_eq_u32 s63, 14
  s_cbranch_scc1 parallel_sum__grouped_kv_mqa__mixer_channel_mlp__prompt_kernel_ld_n14
  buffer_load_dword v82, v86, s[44:47], 0 offen sc1
  s_branch parallel_sum__grouped_kv_mqa__mixer_channel_mlp__prompt_kernel_ld_spret
parallel_sum__grouped_kv_mqa__mixer_channel_mlp__prompt_kernel_ld_n14:
  buffer_load_dword v82, v81, s[44:47], 0 offen sc1
  s_branch parallel_sum__grouped_kv_mqa__mixer_channel_mlp__prompt_kernel_ld_spret
parallel_sum__grouped_kv_mqa__mixer_channel_mlp__prompt_kernel_ld_ck:
  s_mov_b32 s59, 0
parallel_sum__grouped_kv_mqa__mixer_channel_mlp__prompt_kernel_ld_p14:
  v_cmp_gt_u32 vcc, v84, v82
  s_nop 1
  s_cbranch_vccz parallel_sum__grouped_kv_mqa__mixer_channel_mlp__prompt_kernel_ld_ckret
  s_cmp_eq_u32 s59, 0
  s_cbranch_scc1 parallel_sum__grouped_kv_mqa__mixer_channel_mlp__prompt_kernel_ld_p14_ns
  s_sleep 16
parallel_sum__grouped_kv_mqa__mixer_channel_mlp__prompt_kernel_ld_p14_ns:
  buffer_load_dword v82, v81, s[44:47], 0 offen sc1
  s_waitcnt vmcnt(0)
  s_add_u32 s59, s59, 1
  s_cmp_lt_u32 s59, 0x40000
  s_cbranch_scc1 parallel_sum__grouped_kv_mqa__mixer_channel_mlp__prompt_kernel_ld_p14
  s_branch parallel_sum__grouped_kv_mqa__mixer_channel_mlp__prompt_kernel_ld_ckret
parallel_sum__grouped_kv_mqa__mixer_channel_mlp__prompt_kernel_ll:
  s_and_b32 s56, s49, 1
  s_add_u32 s56, s56, 1
  s_bfe_u32 s50, s49, 0x10001
  v_lshrrev_b32 v96, 3, v0
  v_and_b32 v97, 7, v0
  v_lshrrev_b32 v98, 4, v0
  v_xor_b32 v98, v97, v98
  v_lshlrev_b32 v99, 11, v96
  v_lshl_add_u32 v99, v98, 4, v99
  s_lshl_b32 s57, s48, 19
  s_lshl_b32 s58, s62, 17
  s_add_u32 s57, s57, s58
  v_add_u32 v99, s57, v99
  v_xor_b32 v98, 64, v99
  s_lshl_b32 s58, s50, 16
  s_xor_b32 s59, s58, 0
  s_sub_u32 s59, s59, 0
  v_add_u32 v2, s59, v99
  s_xor_b32 s59, s58, 16384
  s_sub_u32 s59, s59, 1024
  v_add_u32 v3, s59, v98
  s_xor_b32 s59, s58, 32768
  s_sub_u32 s59, s59, 2048
  v_add_u32 v4, s59, v99
  s_xor_b32 s59, s58, 49152
  s_sub_u32 s59, s59, 3072
  v_add_u32 v5, s59, v98
  s_xor_b32 s59, s58, 65536
  s_sub_u32 s59, s59, 0
  v_add_u32 v6, s59, v99
  s_xor_b32 s59, s58, 81920
  s_sub_u32 s59, s59, 1024
  v_add_u32 v7, s59, v98
  s_xor_b32 s59, s58, 98304
  s_sub_u32 s59, s59, 2048
  v_add_u32 v8, s59, v99
  s_xor_b32 s59, s58, 114688
  s_sub_u32 s59, s59, 3072
  v_add_u32 v9, s59, v98
  s_lshl_b32 s57, s62, 10
  v_lshlrev_b32 v10, 4, v0
  v_add_u32 v10, s57, v10
  s_add_u32 s66, s57, 98304
  v_lshrrev_b32 v96, 2, v0
  v_lshlrev_b32 v96, 11, v96
  v_and_b32 v97, 3, v0
  v_lshl_add_u32 v96, v97, 4, v96
  s_lshl_b32 s57, s49, 6
  s_lshl_b32 s58, s62, 15
  s_add_u32 s57, s57, s58
  v_add_u32 v14, s57, v96
  s_lshl_b32 s64, s49, 1
  s_add_u32 s64, s64, s48
  s_lshl_b32 s64, s64, 1
  s_add_u32 s64, s64, 4
  s_and_b32 s64, s64, 15
  s_mul_i32 s65, s62, 24576
  s_mov_b32 s60, 0
  s_waitcnt lgkmcnt(0)
  s_mov_b32 s24, s8
  s_mov_b32 s25, s9
  s_mov_b32 s26, 4194304
  s_mov_b32 s27, 0x20000
  s_cmp_eq_u32 s56, 2
  s_cselect_b32 s28, s14, s12
  s_cselect_b32 s29, s15, s13
  s_mov_b32 s30, 65536
  s_mov_b32 s31, 0x20000
  s_mov_b32 s32, s10
  s_mov_b32 s33, s11
  s_mov_b32 s34, 2097152
  s_mov_b32 s35, 0x20000
  s_mov_b32 s36, s22
  s_mov_b32 s37, s23
  s_mov_b32 s38, 24215552
  s_mov_b32 s39, 0x20000
  s_mov_b32 s40, s18
  s_mov_b32 s41, s19
  s_mov_b32 s42, 7168
  s_mov_b32 s43, 0x20000
  s_mov_b32 s44, s20
  s_mov_b32 s45, s21
  s_mov_b32 s46, 256
  s_mov_b32 s47, 0x20000
  s_lshl_b32 s67, s64, 7
  s_lshl_b32 s68, s64, 12
  s_mov_b32 m0, s66
  s_lshl_b32 s69, s64, 17
  buffer_load_dwordx4 v10, s[28:31], s68 offen offset:0 lds
  s_mov_b32 m0, s65
  s_add_u32 s64, s64, 1
  buffer_load_dwordx4 v2, s[24:27], s67 offen offset:0 lds
  buffer_load_dwordx4 v3, s[24:27], s67 offen offset:1024 lds
  buffer_load_dwordx4 v4, s[24:27], s67 offen offset:2048 lds
  buffer_load_dwordx4 v5, s[24:27], s67 offen offset:3072 lds
  s_add_u32 m0, s65, 4096
  s_add_u32 s60, s60, 1
  buffer_load_dwordx4 v6, s[24:27], s67 offen offset:0 lds
  buffer_load_dwordx4 v7, s[24:27], s67 offen offset:1024 lds
  buffer_load_dwordx4 v8, s[24:27], s67 offen offset:2048 lds
  buffer_load_dwordx4 v9, s[24:27], s67 offen offset:3072 lds
  s_add_u32 m0, s66, 16384
  s_add_u32 s65, s65, 8192
  buffer_load_dwordx4 v14, s[32:35], s69 offen lds
  s_cmp_eq_u32 s64, 16
  s_cselect_b32 s64, 0, s64
  s_add_u32 s66, s66, 20480
  s_cmp_eq_u32 s60, 3
  s_cselect_b32 s57, 24576, 0
  s_cselect_b32 s58, 61440, 0
  s_cselect_b32 s60, 0, s60
  s_sub_u32 s65, s65, s57
  s_sub_u32 s66, s66, s58
  s_lshl_b32 s67, s64, 7
  s_lshl_b32 s68, s64, 12
  s_mov_b32 m0, s66
  s_lshl_b32 s69, s64, 17
  buffer_load_dwordx4 v10, s[28:31], s68 offen offset:0 lds
  s_mov_b32 m0, s65
  s_add_u32 s64, s64, 1
  buffer_load_dwordx4 v2, s[24:27], s67 offen offset:0 lds
  buffer_load_dwordx4 v3, s[24:27], s67 offen offset:1024 lds
  buffer_load_dwordx4 v4, s[24:27], s67 offen offset:2048 lds
  buffer_load_dwordx4 v5, s[24:27], s67 offen offset:3072 lds
  s_add_u32 m0, s65, 4096
  s_add_u32 s60, s60, 1
  buffer_load_dwordx4 v6, s[24:27], s67 offen offset:0 lds
  buffer_load_dwordx4 v7, s[24:27], s67 offen offset:1024 lds
  buffer_load_dwordx4 v8, s[24:27], s67 offen offset:2048 lds
  buffer_load_dwordx4 v9, s[24:27], s67 offen offset:3072 lds
  s_add_u32 m0, s66, 16384
  s_add_u32 s65, s65, 8192
  buffer_load_dwordx4 v14, s[32:35], s69 offen lds
  s_cmp_eq_u32 s64, 16
  s_cselect_b32 s64, 0, s64
  s_add_u32 s66, s66, 20480
  s_cmp_eq_u32 s60, 3
  s_cselect_b32 s57, 24576, 0
  s_cselect_b32 s58, 61440, 0
  s_cselect_b32 s60, 0, s60
  s_sub_u32 s65, s65, s57
  s_sub_u32 s66, s66, s58
  v_bfe_u32 v96, v0, 4, 1
  v_and_b32 v97, 3, v0
  v_lshlrev_b32 v96, 5, v96
  v_lshl_add_u32 v96, v97, 3, v96
  v_bfe_u32 v98, v0, 2, 2
  v_lshrrev_b32 v97, 5, v0
  v_lshl_add_u32 v97, v97, 3, v98
  v_lshl_add_u32 v99, v97, 6, v96
  s_lshl_b32 s57, s62, 10
  s_add_u32 s57, s57, 98304
  v_add_u32 v17, s57, v99
  v_mov_b32 v112, 0
  v_mov_b32 v113, 0
  v_mov_b32 v114, 0
  v_mov_b32 v115, 0
  v_mov_b32 v116, 0
  v_mov_b32 v117, 0
  v_mov_b32 v118, 0
  v_mov_b32 v119, 0
  v_mov_b32 v32, 0
  v_mov_b32 v33, 0
  v_mov_b32 v34, 0
  v_mov_b32 v35, 0
  v_mov_b32 v36, 0
  v_mov_b32 v37, 0
  v_mov_b32 v38, 0
  v_mov_b32 v39, 0
  v_mov_b32 v40, 0
  v_mov_b32 v41, 0
  v_mov_b32 v42, 0
  v_mov_b32 v43, 0
  v_mov_b32 v44, 0
  v_mov_b32 v45, 0
  v_mov_b32 v46, 0
  v_mov_b32 v47, 0
  v_mov_b32 v96, 0x3f803f80
  v_and_b32 v97, 4, v0
  v_cmp_eq_u32 vcc, 0, v97
  v_mov_b32 v108, 0xeeee
  v_and_b32 v97, 1, v0
  v_cndmask_b32 v104, 0, v96, vcc
  v_cndmask_b32 v105, 0, v96, vcc
  v_cndmask_b32 v106, v96, 0, vcc
  v_cndmask_b32 v107, v96, 0, vcc
  v_mov_b32 v96, 0x4444
  v_cmp_eq_u32 vcc, 0, v97
  s_nop 1
  v_cndmask_b32 v108, v108, v96, vcc
  s_mov_b32 s74, 0
  s_cmp_eq_u32 s49, 31
  s_cselect_b32 s75, 2, 0
  v_lshlrev_b32 v86, 2, v0
  v_mov_b32 v87, 0x1000
  v_cmp_gt_u32 vcc, 32, v0
  s_nop 1
  v_cndmask_b32 v81, v87, v86, vcc
  v_cndmask_b32 v86, v86, v87, vcc
  v_cndmask_b32 v84, 0, 1, vcc
  s_waitcnt vmcnt(10)
  s_barrier
  s_mov_b32 s63, 0
parallel_sum__grouped_kv_mqa__mixer_channel_mlp__prompt_kernel_ll_loop:
  ds_read_b64_tr_b16 v[32:33], v17 offset:0
  ds_read_b64_tr_b16 v[34:35], v17 offset:256
  ds_read_b64_tr_b16 v[40:41], v17 offset:16384
  ds_read_b64_tr_b16 v[42:43], v17 offset:16640
  s_add_u32 s74, s74, 1
  s_cmp_eq_u32 s74, 3
  s_cselect_b32 s57, 61440, 0
  s_cselect_b32 s74, 0, s74
  s_sub_u32 s57, 20480, s57
  v_add_u32 v17, s57, v17
  s_bitcmp1_b32 s75, s63
  s_cbranch_scc1 parallel_sum__grouped_kv_mqa__mixer_channel_mlp__prompt_kernel_ll_sp
parallel_sum__grouped_kv_mqa__mixer_channel_mlp__prompt_kernel_ll_spret:
  s_cmp_lt_u32 s63, 14
  s_cbranch_scc0 parallel_sum__grouped_kv_mqa__mixer_channel_mlp__prompt_kernel_ll_noiss
  s_lshl_b32 s67, s64, 7
  s_lshl_b32 s68, s64, 12
  s_mov_b32 m0, s66
  s_lshl_b32 s69, s64, 17
  buffer_load_dwordx4 v10, s[28:31], s68 offen offset:0 lds
  s_mov_b32 m0, s65
  s_add_u32 s64, s64, 1
  buffer_load_dwordx4 v2, s[24:27], s67 offen offset:0 lds
  buffer_load_dwordx4 v3, s[24:27], s67 offen offset:1024 lds
  buffer_load_dwordx4 v4, s[24:27], s67 offen offset:2048 lds
  buffer_load_dwordx4 v5, s[24:27], s67 offen offset:3072 lds
  s_add_u32 m0, s65, 4096
  s_add_u32 s60, s60, 1
  buffer_load_dwordx4 v6, s[24:27], s67 offen offset:0 lds
  buffer_load_dwordx4 v7, s[24:27], s67 offen offset:1024 lds
  buffer_load_dwordx4 v8, s[24:27], s67 offen offset:2048 lds
  buffer_load_dwordx4 v9, s[24:27], s67 offen offset:3072 lds
  s_add_u32 m0, s66, 16384
  s_add_u32 s65, s65, 8192
  buffer_load_dwordx4 v14, s[32:35], s69 offen lds
  s_cmp_eq_u32 s64, 16
  s_cselect_b32 s64, 0, s64
  s_add_u32 s66, s66, 20480
  s_cmp_eq_u32 s60, 3
  s_cselect_b32 s57, 24576, 0
  s_cselect_b32 s58, 61440, 0
  s_cselect_b32 s60, 0, s60
  s_sub_u32 s65, s65, s57
  s_sub_u32 s66, s66, s58
  s_waitcnt lgkmcnt(0)
  v_smfmac_f32_16x16x64_bf16 v[112:115], v[104:107], v[32:39], v108
  v_smfmac_f32_16x16x64_bf16 v[116:119], v[104:107], v[40:47], v108
  s_waitcnt vmcnt(10) lgkmcnt(0)
parallel_sum__grouped_kv_mqa__mixer_channel_mlp__prompt_kernel_ll_w0:
  s_barrier
  s_add_u32 s63, s63, 1
  s_branch parallel_sum__grouped_kv_mqa__mixer_channel_mlp__prompt_kernel_ll_loop
parallel_sum__grouped_kv_mqa__mixer_channel_mlp__prompt_kernel_ll_noiss:
  s_waitcnt lgkmcnt(0)
  v_smfmac_f32_16x16x64_bf16 v[112:115], v[104:107], v[32:39], v108
  v_smfmac_f32_16x16x64_bf16 v[116:119], v[104:107], v[40:47], v108
  s_cmp_eq_u32 s63, 15
  s_cbranch_scc1 parallel_sum__grouped_kv_mqa__mixer_channel_mlp__prompt_kernel_ll_fin
  s_waitcnt vmcnt(0)
  s_barrier
  s_add_u32 s63, s63, 1
  s_branch parallel_sum__grouped_kv_mqa__mixer_channel_mlp__prompt_kernel_ll_loop
parallel_sum__grouped_kv_mqa__mixer_channel_mlp__prompt_kernel_ll_fin:
  v_and_b32 v97, 31, v0
  v_lshlrev_b32 v97, 2, v97
  s_lshl_b32 s57, s62, 7
  s_add_u32 s57, s57, 159744
  v_add_u32 v97, s57, v97
  s_nop 3
  v_add_f32 v26, v112, v113
  v_add_f32 v28, v116, v117
  ds_write_b32 v97, v26
  ds_write_b32 v97, v28 offset:512
  v_mov_b32 v96, 0
  ds_write_b32 v97, v96 offset:2048
  s_waitcnt lgkmcnt(0)
  s_barrier
  s_branch parallel_sum__grouped_kv_mqa__mixer_channel_mlp__prompt_kernel_att
parallel_sum__grouped_kv_mqa__mixer_channel_mlp__prompt_kernel_ll_sp:
  s_lshl_b32 s57, s48, 2
  s_add_u32 s57, s57, s62
  s_lshl_b32 s57, s57, 10
  s_add_u32 s57, s57, 23625728
  v_lshlrev_b32 v98, 4, v0
  v_mov_b32 v64, 0
  v_mov_b32 v65, 0
  v_mov_b32 v66, 0
  v_mov_b32 v67, 0
  buffer_store_dwordx4 v[64:67], v98, s[36:39], s57 offen sc1
  s_branch parallel_sum__grouped_kv_mqa__mixer_channel_mlp__prompt_kernel_ll_spret
parallel_sum__grouped_kv_mqa__mixer_channel_mlp__prompt_kernel_comp:
  s_lshl_b32 s51, s49, 2
  s_mov_b32 s50, 0
  s_cmp_eq_u32 s56, 0
  s_cbranch_scc1 parallel_sum__grouped_kv_mqa__mixer_channel_mlp__prompt_kernel_comp2
  s_and_b32 s56, s49, 1
  s_add_u32 s56, s56, 1
  s_bfe_u32 s50, s49, 0x10001
parallel_sum__grouped_kv_mqa__mixer_channel_mlp__prompt_kernel_comp2:
  s_waitcnt lgkmcnt(0)
  s_mov_b32 s24, s8
  s_mov_b32 s25, s9
  s_mov_b32 s26, 4194304
  s_mov_b32 s27, 0x20000
  s_mov_b32 s36, s22
  s_mov_b32 s37, s23
  s_mov_b32 s38, 24215552
  s_mov_b32 s39, 0x20000
  s_mov_b32 s44, s20
  s_mov_b32 s45, s21
  s_mov_b32 s46, 256
  s_mov_b32 s47, 0x20000
  s_getpc_b64 s[72:73]
parallel_sum__grouped_kv_mqa__mixer_channel_mlp__prompt_kernel_pc:
  s_sub_u32 s72, s72, parallel_sum__grouped_kv_mqa__mixer_channel_mlp__prompt_kernel_pc-code_begin
  s_subb_u32 s73, s73, 0
  s_lshr_b32 s57, s2, 3
  s_and_b32 s57, s57, 7
  s_lshl_b32 s57, s57, 2
  s_add_u32 s57, s57, s55
  s_lshl_b32 s57, s57, 11
  v_and_b32 v48, 31, v0
  v_lshlrev_b32 v48, 6, v48
  v_add_u32 v48, s57, v48
  v_min_u32 v11, code_end-code_begin-4, v48
  global_load_dword v10, v11, s[72:73]
  v_mov_b32 v96, 0
  v_mov_b32 v97, 0
  v_mov_b32 v98, 0
  v_mov_b32 v99, 0
  v_mov_b32 v100, 0
  v_mov_b32 v101, 0
  v_mov_b32 v102, 0
  v_mov_b32 v103, 0
  v_mov_b32 v104, 0
  v_mov_b32 v105, 0
  v_mov_b32 v106, 0
  v_mov_b32 v107, 0
  v_mov_b32 v108, 0
  v_mov_b32 v109, 0
  v_mov_b32 v110, 0
  v_mov_b32 v111, 0
  v_mov_b32 v112, 0
  v_mov_b32 v113, 0
  v_mov_b32 v114, 0
  v_mov_b32 v115, 0
  v_mov_b32 v116, 0
  v_mov_b32 v117, 0
  v_mov_b32 v118, 0
  v_mov_b32 v119, 0
  v_mov_b32 v120, 0
  v_mov_b32 v121, 0
  v_mov_b32 v122, 0
  v_mov_b32 v123, 0
  v_mov_b32 v124, 0
  v_mov_b32 v125, 0
  v_mov_b32 v126, 0
  v_mov_b32 v127, 0
  v_mov_b32 v128, 0
  v_mov_b32 v129, 0
  v_mov_b32 v130, 0
  v_mov_b32 v131, 0
  v_mov_b32 v132, 0
  v_mov_b32 v133, 0
  v_mov_b32 v134, 0
  v_mov_b32 v135, 0
  v_mov_b32 v136, 0
  v_mov_b32 v137, 0
  v_mov_b32 v138, 0
  v_mov_b32 v139, 0
  v_mov_b32 v140, 0
  v_mov_b32 v141, 0
  v_mov_b32 v142, 0
  v_mov_b32 v143, 0
  v_mov_b32 v144, 0
  v_mov_b32 v145, 0
  v_mov_b32 v146, 0
  v_mov_b32 v147, 0
  v_mov_b32 v148, 0
  v_mov_b32 v149, 0
  v_mov_b32 v150, 0
  v_mov_b32 v151, 0
  v_mov_b32 v152, 0
  v_mov_b32 v153, 0
  v_mov_b32 v154, 0
  v_mov_b32 v155, 0
  v_mov_b32 v156, 0
  v_mov_b32 v157, 0
  v_mov_b32 v158, 0
  v_mov_b32 v159, 0
  v_mov_b32 v160, 0
  v_mov_b32 v161, 0
  v_mov_b32 v162, 0
  v_mov_b32 v163, 0
  v_mov_b32 v164, 0
  v_mov_b32 v165, 0
  v_mov_b32 v166, 0
  v_mov_b32 v167, 0
  v_mov_b32 v168, 0
  v_mov_b32 v169, 0
  v_mov_b32 v170, 0
  v_mov_b32 v171, 0
  v_mov_b32 v172, 0
  v_mov_b32 v173, 0
  v_mov_b32 v174, 0
  v_mov_b32 v175, 0
  v_mov_b32 v176, 0
  v_mov_b32 v177, 0
  v_mov_b32 v178, 0
  v_mov_b32 v179, 0
  v_mov_b32 v180, 0
  v_mov_b32 v181, 0
  v_mov_b32 v182, 0
  v_mov_b32 v183, 0
  v_mov_b32 v184, 0
  v_mov_b32 v185, 0
  v_mov_b32 v186, 0
  v_mov_b32 v187, 0
  v_mov_b32 v188, 0
  v_mov_b32 v189, 0
  v_mov_b32 v190, 0
  v_mov_b32 v191, 0
  v_mov_b32 v192, 0
  v_mov_b32 v193, 0
  v_mov_b32 v194, 0
  v_mov_b32 v195, 0
  v_mov_b32 v196, 0
  v_mov_b32 v197, 0
  v_mov_b32 v198, 0
  v_mov_b32 v199, 0
  v_mov_b32 v200, 0
  v_mov_b32 v201, 0
  v_mov_b32 v202, 0
  v_mov_b32 v203, 0
  v_mov_b32 v204, 0
  v_mov_b32 v205, 0
  v_mov_b32 v206, 0
  v_mov_b32 v207, 0
  v_mov_b32 v208, 0
  v_mov_b32 v209, 0
  v_mov_b32 v210, 0
  v_mov_b32 v211, 0
  v_mov_b32 v212, 0
  v_mov_b32 v213, 0
  v_mov_b32 v214, 0
  v_mov_b32 v215, 0
  v_mov_b32 v216, 0
  v_mov_b32 v217, 0
  v_mov_b32 v218, 0
  v_mov_b32 v219, 0
  v_mov_b32 v220, 0
  v_mov_b32 v221, 0
  v_mov_b32 v222, 0
  v_mov_b32 v223, 0
  v_mov_b32 v224, 0
  v_mov_b32 v225, 0
  v_mov_b32 v226, 0
  v_mov_b32 v227, 0
  v_mov_b32 v228, 0
  v_mov_b32 v229, 0
  v_mov_b32 v230, 0
  v_mov_b32 v231, 0
  v_mov_b32 v232, 0
  v_mov_b32 v233, 0
  v_mov_b32 v234, 0
  v_mov_b32 v235, 0
  v_mov_b32 v236, 0
  v_mov_b32 v237, 0
  v_mov_b32 v238, 0
  v_mov_b32 v239, 0
  v_mov_b32 v240, 0
  v_mov_b32 v241, 0
  v_mov_b32 v242, 0
  v_mov_b32 v243, 0
  v_mov_b32 v244, 0
  v_mov_b32 v245, 0
  v_mov_b32 v246, 0
  v_mov_b32 v247, 0
  v_mov_b32 v248, 0
  v_mov_b32 v249, 0
  v_mov_b32 v250, 0
  v_mov_b32 v251, 0
  v_mov_b32 v252, 0
  v_mov_b32 v253, 0
  v_mov_b32 v254, 0
  v_mov_b32 v255, 0
  s_cmp_eq_u32 s56, 0
  s_cbranch_scc0 parallel_sum__grouped_kv_mqa__mixer_channel_mlp__prompt_kernel_cl
  v_and_b32 v84, 15, v0
  v_lshrrev_b32 v85, 4, v0
  v_bfe_u32 v86, v0, 1, 3
  v_xor_b32 v86, v86, v85
  v_lshlrev_b32 v86, 4, v86
  v_lshl_add_u32 v86, v84, 7, v86
  s_mul_i32 s57, s55, 24576
  v_add_u32 v2, s57, v86
  v_xor_b32 v3, 64, v2
  v_bfe_u32 v84, v0, 2, 2
  v_lshl_add_u32 v85, v85, 3, v84
  v_and_b32 v84, 3, v0
  v_lshlrev_b32 v84, 3, v84
  v_bfe_u32 v86, v0, 4, 1
  v_lshl_add_u32 v84, v86, 5, v84
  v_lshl_add_u32 v86, v85, 6, v84
  v_add_u32 v8, 114688, v86
  v_xor_b32 v9, 32, v8
  v_bfe_u32 v86, v0, 3, 1
  v_lshl_add_u32 v84, v86, 6, v84
  v_lshl_add_u32 v84, v85, 7, v84
  v_add_u32 v4, 98304, v84
  v_xor_b32 v5, 32, v4
  v_xor_b32 v6, 64, v4
  v_xor_b32 v7, 96, v4
  s_lshl_b32 s57, s2, 2
  s_add_u32 s57, s57, s55
  s_lshl_b32 s57, s57, 12
  v_and_b32 v1, 31, v0
  v_lshlrev_b32 v1, 7, v1
  s_barrier
  ds_read_b128 v[52:55], v2 offset:0
  ds_read_b128 v[56:59], v2 offset:2048
  ds_read_b128 v[60:63], v2 offset:4096
  ds_read_b128 v[64:67], v2 offset:6144
  ds_read_b64_tr_b16 v[12:13], v4 offset:0
  ds_read_b64_tr_b16 v[14:15], v4 offset:512
  ds_read_b64_tr_b16 v[16:17], v5 offset:0
  ds_read_b64_tr_b16 v[18:19], v5 offset:512
  ds_read_b64_tr_b16 v[20:21], v6 offset:0
  ds_read_b64_tr_b16 v[22:23], v6 offset:512
  ds_read_b64_tr_b16 v[24:25], v7 offset:0
  ds_read_b64_tr_b16 v[26:27], v7 offset:512
  s_waitcnt lgkmcnt(4)
  ds_read_b64_tr_b16 v[28:29], v4 offset:8192
  ds_read_b64_tr_b16 v[30:31], v4 offset:8704
  ds_read_b64_tr_b16 v[32:33], v5 offset:8192
  ds_read_b64_tr_b16 v[34:35], v5 offset:8704
  ds_read_b64_tr_b16 v[36:37], v6 offset:8192
  ds_read_b64_tr_b16 v[38:39], v6 offset:8704
  ds_read_b64_tr_b16 v[40:41], v7 offset:8192
  ds_read_b64_tr_b16 v[42:43], v7 offset:8704
  ds_read_b64_tr_b16 v[44:45], v8 offset:0
  ds_read_b64_tr_b16 v[46:47], v8 offset:256
  ds_read_b64_tr_b16 v[48:49], v9 offset:0
  s_waitcnt lgkmcnt(0)
  s_mov_b32 s63, 5
  .p2align 6
parallel_sum__grouped_kv_mqa__mixer_channel_mlp__prompt_kernel_h_loop:
  s_waitcnt lgkmcnt(14)
  v_mfma_f32_16x16x32_bf16 v[96:99], v[12:15], v[52:55], v[96:99]
  ds_read_b64_tr_b16 v[50:51], v9 offset:256
  v_mfma_f32_16x16x32_bf16 v[104:107], v[12:15], v[56:59], v[104:107]
  ds_read_b128 v[68:71], v3 offset:0
  v_mfma_f32_16x16x32_bf16 v[112:115], v[12:15], v[60:63], v[112:115]
  ds_read_b128 v[72:75], v3 offset:2048
  v_mfma_f32_16x16x32_bf16 v[120:123], v[12:15], v[64:67], v[120:123]
  ds_read_b128 v[76:79], v3 offset:4096
  v_mfma_f32_16x16x32_bf16 v[100:103], v[16:19], v[52:55], v[100:103]
  ds_read_b128 v[80:83], v3 offset:6144
  v_mfma_f32_16x16x32_bf16 v[108:111], v[16:19], v[56:59], v[108:111]
  ds_read_b64_tr_b16 v[12:13], v4 offset:4096
  v_mfma_f32_16x16x32_bf16 v[116:119], v[16:19], v[60:63], v[116:119]
  ds_read_b64_tr_b16 v[14:15], v4 offset:4608
  v_mfma_f32_16x16x32_bf16 v[124:127], v[16:19], v[64:67], v[124:127]
  ds_read_b64_tr_b16 v[16:17], v5 offset:4096
  s_waitcnt lgkmcnt(14)
  v_mfma_f32_16x16x32_bf16 v[128:131], v[20:23], v[52:55], v[128:131]
  ds_read_b64_tr_b16 v[18:19], v5 offset:4608
  v_mfma_f32_16x16x32_bf16 v[136:139], v[20:23], v[56:59], v[136:139]
  v_mfma_f32_16x16x32_bf16 v[144:147], v[20:23], v[60:63], v[144:147]
  v_mfma_f32_16x16x32_bf16 v[152:155], v[20:23], v[64:67], v[152:155]
  ds_read_b64_tr_b16 v[20:21], v6 offset:4096
  v_mfma_f32_16x16x32_bf16 v[132:135], v[24:27], v[52:55], v[132:135]
  ds_read_b64_tr_b16 v[22:23], v6 offset:4608
  v_mfma_f32_16x16x32_bf16 v[140:143], v[24:27], v[56:59], v[140:143]
  v_mfma_f32_16x16x32_bf16 v[148:151], v[24:27], v[60:63], v[148:151]
  v_mfma_f32_16x16x32_bf16 v[156:159], v[24:27], v[64:67], v[156:159]
  ds_read_b64_tr_b16 v[24:25], v7 offset:4096
  v_mfma_f32_16x16x32_bf16 v[160:163], v[28:31], v[52:55], v[160:163]
  ds_read_b64_tr_b16 v[26:27], v7 offset:4608
  v_mfma_f32_16x16x32_bf16 v[168:171], v[28:31], v[56:59], v[168:171]
  v_mfma_f32_16x16x32_bf16 v[176:179], v[28:31], v[60:63], v[176:179]
  v_mfma_f32_16x16x32_bf16 v[184:187], v[28:31], v[64:67], v[184:187]
  ds_read_b64_tr_b16 v[28:29], v4 offset:12288
  v_mfma_f32_16x16x32_bf16 v[164:167], v[32:35], v[52:55], v[164:167]
  ds_read_b64_tr_b16 v[30:31], v4 offset:12800
  v_mfma_f32_16x16x32_bf16 v[172:175], v[32:35], v[56:59], v[172:175]
  v_mfma_f32_16x16x32_bf16 v[180:183], v[32:35], v[60:63], v[180:183]
  v_mfma_f32_16x16x32_bf16 v[188:191], v[32:35], v[64:67], v[188:191]
  ds_read_b64_tr_b16 v[32:33], v5 offset:12288
  s_waitcnt lgkmcnt(14)
  v_mfma_f32_16x16x32_bf16 v[192:195], v[36:39], v[52:55], v[192:195]
  ds_read_b64_tr_b16 v[34:35], v5 offset:12800
  v_mfma_f32_16x16x32_bf16 v[200:203], v[36:39], v[56:59], v[200:203]
  v_mfma_f32_16x16x32_bf16 v[208:211], v[36:39], v[60:63], v[208:211]
  v_mfma_f32_16x16x32_bf16 v[216:219], v[36:39], v[64:67], v[216:219]
  ds_read_b64_tr_b16 v[36:37], v6 offset:12288
  v_mfma_f32_16x16x32_bf16 v[196:199], v[40:43], v[52:55], v[196:199]
  ds_read_b64_tr_b16 v[38:39], v6 offset:12800
  v_mfma_f32_16x16x32_bf16 v[204:207], v[40:43], v[56:59], v[204:207]
  v_mfma_f32_16x16x32_bf16 v[212:215], v[40:43], v[60:63], v[212:215]
  v_mfma_f32_16x16x32_bf16 v[220:223], v[40:43], v[64:67], v[220:223]
  ds_read_b64_tr_b16 v[40:41], v7 offset:12288
  v_mfma_f32_16x16x32_bf16 v[224:227], v[44:47], v[52:55], v[224:227]
  ds_read_b64_tr_b16 v[42:43], v7 offset:12800
  v_mfma_f32_16x16x32_bf16 v[232:235], v[44:47], v[56:59], v[232:235]
  v_mfma_f32_16x16x32_bf16 v[240:243], v[44:47], v[60:63], v[240:243]
  v_mfma_f32_16x16x32_bf16 v[248:251], v[44:47], v[64:67], v[248:251]
  ds_read_b64_tr_b16 v[44:45], v8 offset:2048
  v_mfma_f32_16x16x32_bf16 v[228:231], v[48:51], v[52:55], v[228:231]
  ds_read_b64_tr_b16 v[46:47], v8 offset:2304
  v_mfma_f32_16x16x32_bf16 v[236:239], v[48:51], v[56:59], v[236:239]
  v_mfma_f32_16x16x32_bf16 v[244:247], v[48:51], v[60:63], v[244:247]
  v_mfma_f32_16x16x32_bf16 v[252:255], v[48:51], v[64:67], v[252:255]
  ds_read_b64_tr_b16 v[48:49], v9 offset:2048
  s_waitcnt lgkmcnt(14)
  v_mfma_f32_16x16x32_bf16 v[96:99], v[12:15], v[68:71], v[96:99]
  ds_read_b64_tr_b16 v[50:51], v9 offset:2304
  v_mfma_f32_16x16x32_bf16 v[104:107], v[12:15], v[72:75], v[104:107]
  v_mfma_f32_16x16x32_bf16 v[112:115], v[12:15], v[76:79], v[112:115]
  v_mfma_f32_16x16x32_bf16 v[120:123], v[12:15], v[80:83], v[120:123]
  v_mfma_f32_16x16x32_bf16 v[100:103], v[16:19], v[68:71], v[100:103]
  v_mfma_f32_16x16x32_bf16 v[108:111], v[16:19], v[72:75], v[108:111]
  s_waitcnt lgkmcnt(0)
  s_barrier
  ds_read_b128 v[52:55], v2 offset:8192
  v_mfma_f32_16x16x32_bf16 v[116:119], v[16:19], v[76:79], v[116:119]
  ds_read_b128 v[56:59], v2 offset:10240
  v_mfma_f32_16x16x32_bf16 v[124:127], v[16:19], v[80:83], v[124:127]
  ds_read_b128 v[60:63], v2 offset:12288
  v_mfma_f32_16x16x32_bf16 v[128:131], v[20:23], v[68:71], v[128:131]
  ds_read_b128 v[64:67], v2 offset:14336
  v_mfma_f32_16x16x32_bf16 v[136:139], v[20:23], v[72:75], v[136:139]
  ds_read_b64_tr_b16 v[12:13], v4 offset:20480
  v_mfma_f32_16x16x32_bf16 v[144:147], v[20:23], v[76:79], v[144:147]
  ds_read_b64_tr_b16 v[14:15], v4 offset:20992
  v_mfma_f32_16x16x32_bf16 v[152:155], v[20:23], v[80:83], v[152:155]
  ds_read_b64_tr_b16 v[16:17], v5 offset:20480
  v_mfma_f32_16x16x32_bf16 v[132:135], v[24:27], v[68:71], v[132:135]
  ds_read_b64_tr_b16 v[18:19], v5 offset:20992
  v_mfma_f32_16x16x32_bf16 v[140:143], v[24:27], v[72:75], v[140:143]
  ds_read_b64_tr_b16 v[20:21], v6 offset:20480
  v_mfma_f32_16x16x32_bf16 v[148:151], v[24:27], v[76:79], v[148:151]
  ds_read_b64_tr_b16 v[22:23], v6 offset:20992
  v_mfma_f32_16x16x32_bf16 v[156:159], v[24:27], v[80:83], v[156:159]
  ds_read_b64_tr_b16 v[24:25], v7 offset:20480
  v_mfma_f32_16x16x32_bf16 v[160:163], v[28:31], v[68:71], v[160:163]
  ds_read_b64_tr_b16 v[26:27], v7 offset:20992
  v_mfma_f32_16x16x32_bf16 v[168:171], v[28:31], v[72:75], v[168:171]
  v_mfma_f32_16x16x32_bf16 v[176:179], v[28:31], v[76:79], v[176:179]
  v_mfma_f32_16x16x32_bf16 v[184:187], v[28:31], v[80:83], v[184:187]
  ds_read_b64_tr_b16 v[28:29], v4 offset:28672
  v_mfma_f32_16x16x32_bf16 v[164:167], v[32:35], v[68:71], v[164:167]
  ds_read_b64_tr_b16 v[30:31], v4 offset:29184
  v_mfma_f32_16x16x32_bf16 v[172:175], v[32:35], v[72:75], v[172:175]
  v_mfma_f32_16x16x32_bf16 v[180:183], v[32:35], v[76:79], v[180:183]
  v_mfma_f32_16x16x32_bf16 v[188:191], v[32:35], v[80:83], v[188:191]
  ds_read_b64_tr_b16 v[32:33], v5 offset:28672
  v_mfma_f32_16x16x32_bf16 v[192:195], v[36:39], v[68:71], v[192:195]
  ds_read_b64_tr_b16 v[34:35], v5 offset:29184
  v_mfma_f32_16x16x32_bf16 v[200:203], v[36:39], v[72:75], v[200:203]
  v_mfma_f32_16x16x32_bf16 v[208:211], v[36:39], v[76:79], v[208:211]
  v_mfma_f32_16x16x32_bf16 v[216:219], v[36:39], v[80:83], v[216:219]
  ds_read_b64_tr_b16 v[36:37], v6 offset:28672
  v_mfma_f32_16x16x32_bf16 v[196:199], v[40:43], v[68:71], v[196:199]
  ds_read_b64_tr_b16 v[38:39], v6 offset:29184
  v_mfma_f32_16x16x32_bf16 v[204:207], v[40:43], v[72:75], v[204:207]
  v_mfma_f32_16x16x32_bf16 v[212:215], v[40:43], v[76:79], v[212:215]
  v_mfma_f32_16x16x32_bf16 v[220:223], v[40:43], v[80:83], v[220:223]
  ds_read_b64_tr_b16 v[40:41], v7 offset:28672
  v_mfma_f32_16x16x32_bf16 v[224:227], v[44:47], v[68:71], v[224:227]
  ds_read_b64_tr_b16 v[42:43], v7 offset:29184
  v_mfma_f32_16x16x32_bf16 v[232:235], v[44:47], v[72:75], v[232:235]
  v_mfma_f32_16x16x32_bf16 v[240:243], v[44:47], v[76:79], v[240:243]
  v_mfma_f32_16x16x32_bf16 v[248:251], v[44:47], v[80:83], v[248:251]
  ds_read_b64_tr_b16 v[44:45], v8 offset:20480
  v_mfma_f32_16x16x32_bf16 v[228:231], v[48:51], v[68:71], v[228:231]
  ds_read_b64_tr_b16 v[46:47], v8 offset:20736
  v_mfma_f32_16x16x32_bf16 v[236:239], v[48:51], v[72:75], v[236:239]
  v_mfma_f32_16x16x32_bf16 v[244:247], v[48:51], v[76:79], v[244:247]
  v_mfma_f32_16x16x32_bf16 v[252:255], v[48:51], v[80:83], v[252:255]
  ds_read_b64_tr_b16 v[48:49], v9 offset:20480
  s_waitcnt lgkmcnt(14)
  v_mfma_f32_16x16x32_bf16 v[96:99], v[12:15], v[52:55], v[96:99]
  ds_read_b64_tr_b16 v[50:51], v9 offset:20736
  v_mfma_f32_16x16x32_bf16 v[104:107], v[12:15], v[56:59], v[104:107]
  ds_read_b128 v[68:71], v3 offset:8192
  v_mfma_f32_16x16x32_bf16 v[112:115], v[12:15], v[60:63], v[112:115]
  ds_read_b128 v[72:75], v3 offset:10240
  v_mfma_f32_16x16x32_bf16 v[120:123], v[12:15], v[64:67], v[120:123]
  ds_read_b128 v[76:79], v3 offset:12288
  v_mfma_f32_16x16x32_bf16 v[100:103], v[16:19], v[52:55], v[100:103]
  ds_read_b128 v[80:83], v3 offset:14336
  v_mfma_f32_16x16x32_bf16 v[108:111], v[16:19], v[56:59], v[108:111]
  ds_read_b64_tr_b16 v[12:13], v4 offset:24576
  v_mfma_f32_16x16x32_bf16 v[116:119], v[16:19], v[60:63], v[116:119]
  ds_read_b64_tr_b16 v[14:15], v4 offset:25088
  v_mfma_f32_16x16x32_bf16 v[124:127], v[16:19], v[64:67], v[124:127]
  ds_read_b64_tr_b16 v[16:17], v5 offset:24576
  s_waitcnt lgkmcnt(14)
  v_mfma_f32_16x16x32_bf16 v[128:131], v[20:23], v[52:55], v[128:131]
  ds_read_b64_tr_b16 v[18:19], v5 offset:25088
  v_mfma_f32_16x16x32_bf16 v[136:139], v[20:23], v[56:59], v[136:139]
  v_mfma_f32_16x16x32_bf16 v[144:147], v[20:23], v[60:63], v[144:147]
  v_mfma_f32_16x16x32_bf16 v[152:155], v[20:23], v[64:67], v[152:155]
  ds_read_b64_tr_b16 v[20:21], v6 offset:24576
  v_mfma_f32_16x16x32_bf16 v[132:135], v[24:27], v[52:55], v[132:135]
  ds_read_b64_tr_b16 v[22:23], v6 offset:25088
  v_mfma_f32_16x16x32_bf16 v[140:143], v[24:27], v[56:59], v[140:143]
  v_mfma_f32_16x16x32_bf16 v[148:151], v[24:27], v[60:63], v[148:151]
  v_mfma_f32_16x16x32_bf16 v[156:159], v[24:27], v[64:67], v[156:159]
  ds_read_b64_tr_b16 v[24:25], v7 offset:24576
  v_mfma_f32_16x16x32_bf16 v[160:163], v[28:31], v[52:55], v[160:163]
  ds_read_b64_tr_b16 v[26:27], v7 offset:25088
  v_mfma_f32_16x16x32_bf16 v[168:171], v[28:31], v[56:59], v[168:171]
  v_mfma_f32_16x16x32_bf16 v[176:179], v[28:31], v[60:63], v[176:179]
  v_mfma_f32_16x16x32_bf16 v[184:187], v[28:31], v[64:67], v[184:187]
  ds_read_b64_tr_b16 v[28:29], v4 offset:32768
  v_mfma_f32_16x16x32_bf16 v[164:167], v[32:35], v[52:55], v[164:167]
  ds_read_b64_tr_b16 v[30:31], v4 offset:33280
  v_mfma_f32_16x16x32_bf16 v[172:175], v[32:35], v[56:59], v[172:175]
  v_mfma_f32_16x16x32_bf16 v[180:183], v[32:35], v[60:63], v[180:183]
  v_mfma_f32_16x16x32_bf16 v[188:191], v[32:35], v[64:67], v[188:191]
  ds_read_b64_tr_b16 v[32:33], v5 offset:32768
  s_waitcnt lgkmcnt(14)
  v_mfma_f32_16x16x32_bf16 v[192:195], v[36:39], v[52:55], v[192:195]
  ds_read_b64_tr_b16 v[34:35], v5 offset:33280
  v_mfma_f32_16x16x32_bf16 v[200:203], v[36:39], v[56:59], v[200:203]
  v_mfma_f32_16x16x32_bf16 v[208:211], v[36:39], v[60:63], v[208:211]
  v_mfma_f32_16x16x32_bf16 v[216:219], v[36:39], v[64:67], v[216:219]
  ds_read_b64_tr_b16 v[36:37], v6 offset:32768
  v_mfma_f32_16x16x32_bf16 v[196:199], v[40:43], v[52:55], v[196:199]
  ds_read_b64_tr_b16 v[38:39], v6 offset:33280
  v_mfma_f32_16x16x32_bf16 v[204:207], v[40:43], v[56:59], v[204:207]
  v_mfma_f32_16x16x32_bf16 v[212:215], v[40:43], v[60:63], v[212:215]
  v_mfma_f32_16x16x32_bf16 v[220:223], v[40:43], v[64:67], v[220:223]
  ds_read_b64_tr_b16 v[40:41], v7 offset:32768
  v_mfma_f32_16x16x32_bf16 v[224:227], v[44:47], v[52:55], v[224:227]
  ds_read_b64_tr_b16 v[42:43], v7 offset:33280
  v_mfma_f32_16x16x32_bf16 v[232:235], v[44:47], v[56:59], v[232:235]
  v_mfma_f32_16x16x32_bf16 v[240:243], v[44:47], v[60:63], v[240:243]
  v_mfma_f32_16x16x32_bf16 v[248:251], v[44:47], v[64:67], v[248:251]
  ds_read_b64_tr_b16 v[44:45], v8 offset:22528
  v_mfma_f32_16x16x32_bf16 v[228:231], v[48:51], v[52:55], v[228:231]
  ds_read_b64_tr_b16 v[46:47], v8 offset:22784
  v_mfma_f32_16x16x32_bf16 v[236:239], v[48:51], v[56:59], v[236:239]
  v_mfma_f32_16x16x32_bf16 v[244:247], v[48:51], v[60:63], v[244:247]
  v_mfma_f32_16x16x32_bf16 v[252:255], v[48:51], v[64:67], v[252:255]
  ds_read_b64_tr_b16 v[48:49], v9 offset:22528
  s_waitcnt lgkmcnt(14)
  v_mfma_f32_16x16x32_bf16 v[96:99], v[12:15], v[68:71], v[96:99]
  ds_read_b64_tr_b16 v[50:51], v9 offset:22784
  v_mfma_f32_16x16x32_bf16 v[104:107], v[12:15], v[72:75], v[104:107]
  v_mfma_f32_16x16x32_bf16 v[112:115], v[12:15], v[76:79], v[112:115]
  v_mfma_f32_16x16x32_bf16 v[120:123], v[12:15], v[80:83], v[120:123]
  v_mfma_f32_16x16x32_bf16 v[100:103], v[16:19], v[68:71], v[100:103]
  v_mfma_f32_16x16x32_bf16 v[108:111], v[16:19], v[72:75], v[108:111]
  s_waitcnt lgkmcnt(0)
  s_barrier
  ds_read_b128 v[52:55], v2 offset:16384
  v_mfma_f32_16x16x32_bf16 v[116:119], v[16:19], v[76:79], v[116:119]
  ds_read_b128 v[56:59], v2 offset:18432
  v_mfma_f32_16x16x32_bf16 v[124:127], v[16:19], v[80:83], v[124:127]
  ds_read_b128 v[60:63], v2 offset:20480
  v_mfma_f32_16x16x32_bf16 v[128:131], v[20:23], v[68:71], v[128:131]
  ds_read_b128 v[64:67], v2 offset:22528
  v_mfma_f32_16x16x32_bf16 v[136:139], v[20:23], v[72:75], v[136:139]
  ds_read_b64_tr_b16 v[12:13], v4 offset:40960
  v_mfma_f32_16x16x32_bf16 v[144:147], v[20:23], v[76:79], v[144:147]
  ds_read_b64_tr_b16 v[14:15], v4 offset:41472
  v_mfma_f32_16x16x32_bf16 v[152:155], v[20:23], v[80:83], v[152:155]
  ds_read_b64_tr_b16 v[16:17], v5 offset:40960
  v_mfma_f32_16x16x32_bf16 v[132:135], v[24:27], v[68:71], v[132:135]
  ds_read_b64_tr_b16 v[18:19], v5 offset:41472
  v_mfma_f32_16x16x32_bf16 v[140:143], v[24:27], v[72:75], v[140:143]
  ds_read_b64_tr_b16 v[20:21], v6 offset:40960
  v_mfma_f32_16x16x32_bf16 v[148:151], v[24:27], v[76:79], v[148:151]
  ds_read_b64_tr_b16 v[22:23], v6 offset:41472
  v_mfma_f32_16x16x32_bf16 v[156:159], v[24:27], v[80:83], v[156:159]
  ds_read_b64_tr_b16 v[24:25], v7 offset:40960
  v_mfma_f32_16x16x32_bf16 v[160:163], v[28:31], v[68:71], v[160:163]
  ds_read_b64_tr_b16 v[26:27], v7 offset:41472
  v_mfma_f32_16x16x32_bf16 v[168:171], v[28:31], v[72:75], v[168:171]
  v_mfma_f32_16x16x32_bf16 v[176:179], v[28:31], v[76:79], v[176:179]
  v_mfma_f32_16x16x32_bf16 v[184:187], v[28:31], v[80:83], v[184:187]
  ds_read_b64_tr_b16 v[28:29], v4 offset:49152
  v_mfma_f32_16x16x32_bf16 v[164:167], v[32:35], v[68:71], v[164:167]
  ds_read_b64_tr_b16 v[30:31], v4 offset:49664
  v_mfma_f32_16x16x32_bf16 v[172:175], v[32:35], v[72:75], v[172:175]
  v_mfma_f32_16x16x32_bf16 v[180:183], v[32:35], v[76:79], v[180:183]
  v_mfma_f32_16x16x32_bf16 v[188:191], v[32:35], v[80:83], v[188:191]
  ds_read_b64_tr_b16 v[32:33], v5 offset:49152
  v_mfma_f32_16x16x32_bf16 v[192:195], v[36:39], v[68:71], v[192:195]
  ds_read_b64_tr_b16 v[34:35], v5 offset:49664
  v_mfma_f32_16x16x32_bf16 v[200:203], v[36:39], v[72:75], v[200:203]
  v_mfma_f32_16x16x32_bf16 v[208:211], v[36:39], v[76:79], v[208:211]
  v_mfma_f32_16x16x32_bf16 v[216:219], v[36:39], v[80:83], v[216:219]
  ds_read_b64_tr_b16 v[36:37], v6 offset:49152
  v_mfma_f32_16x16x32_bf16 v[196:199], v[40:43], v[68:71], v[196:199]
  ds_read_b64_tr_b16 v[38:39], v6 offset:49664
  v_mfma_f32_16x16x32_bf16 v[204:207], v[40:43], v[72:75], v[204:207]
  v_mfma_f32_16x16x32_bf16 v[212:215], v[40:43], v[76:79], v[212:215]
  v_mfma_f32_16x16x32_bf16 v[220:223], v[40:43], v[80:83], v[220:223]
  ds_read_b64_tr_b16 v[40:41], v7 offset:49152
  v_mfma_f32_16x16x32_bf16 v[224:227], v[44:47], v[68:71], v[224:227]
  ds_read_b64_tr_b16 v[42:43], v7 offset:49664
  v_mfma_f32_16x16x32_bf16 v[232:235], v[44:47], v[72:75], v[232:235]
  v_mfma_f32_16x16x32_bf16 v[240:243], v[44:47], v[76:79], v[240:243]
  v_mfma_f32_16x16x32_bf16 v[248:251], v[44:47], v[80:83], v[248:251]
  ds_read_b64_tr_b16 v[44:45], v8 offset:40960
  v_mfma_f32_16x16x32_bf16 v[228:231], v[48:51], v[68:71], v[228:231]
  ds_read_b64_tr_b16 v[46:47], v8 offset:41216
  v_mfma_f32_16x16x32_bf16 v[236:239], v[48:51], v[72:75], v[236:239]
  v_mfma_f32_16x16x32_bf16 v[244:247], v[48:51], v[76:79], v[244:247]
  v_mfma_f32_16x16x32_bf16 v[252:255], v[48:51], v[80:83], v[252:255]
  ds_read_b64_tr_b16 v[48:49], v9 offset:40960
  s_waitcnt lgkmcnt(14)
  v_mfma_f32_16x16x32_bf16 v[96:99], v[12:15], v[52:55], v[96:99]
  ds_read_b64_tr_b16 v[50:51], v9 offset:41216
  v_mfma_f32_16x16x32_bf16 v[104:107], v[12:15], v[56:59], v[104:107]
  ds_read_b128 v[68:71], v3 offset:16384
  v_mfma_f32_16x16x32_bf16 v[112:115], v[12:15], v[60:63], v[112:115]
  ds_read_b128 v[72:75], v3 offset:18432
  v_mfma_f32_16x16x32_bf16 v[120:123], v[12:15], v[64:67], v[120:123]
  ds_read_b128 v[76:79], v3 offset:20480
  v_mfma_f32_16x16x32_bf16 v[100:103], v[16:19], v[52:55], v[100:103]
  ds_read_b128 v[80:83], v3 offset:22528
  v_mfma_f32_16x16x32_bf16 v[108:111], v[16:19], v[56:59], v[108:111]
  ds_read_b64_tr_b16 v[12:13], v4 offset:45056
  v_mfma_f32_16x16x32_bf16 v[116:119], v[16:19], v[60:63], v[116:119]
  ds_read_b64_tr_b16 v[14:15], v4 offset:45568
  v_mfma_f32_16x16x32_bf16 v[124:127], v[16:19], v[64:67], v[124:127]
  ds_read_b64_tr_b16 v[16:17], v5 offset:45056
  s_waitcnt lgkmcnt(14)
  v_mfma_f32_16x16x32_bf16 v[128:131], v[20:23], v[52:55], v[128:131]
  ds_read_b64_tr_b16 v[18:19], v5 offset:45568
  v_mfma_f32_16x16x32_bf16 v[136:139], v[20:23], v[56:59], v[136:139]
  v_mfma_f32_16x16x32_bf16 v[144:147], v[20:23], v[60:63], v[144:147]
  v_mfma_f32_16x16x32_bf16 v[152:155], v[20:23], v[64:67], v[152:155]
  ds_read_b64_tr_b16 v[20:21], v6 offset:45056
  v_mfma_f32_16x16x32_bf16 v[132:135], v[24:27], v[52:55], v[132:135]
  ds_read_b64_tr_b16 v[22:23], v6 offset:45568
  v_mfma_f32_16x16x32_bf16 v[140:143], v[24:27], v[56:59], v[140:143]
  v_mfma_f32_16x16x32_bf16 v[148:151], v[24:27], v[60:63], v[148:151]
  v_mfma_f32_16x16x32_bf16 v[156:159], v[24:27], v[64:67], v[156:159]
  ds_read_b64_tr_b16 v[24:25], v7 offset:45056
  v_mfma_f32_16x16x32_bf16 v[160:163], v[28:31], v[52:55], v[160:163]
  ds_read_b64_tr_b16 v[26:27], v7 offset:45568
  v_mfma_f32_16x16x32_bf16 v[168:171], v[28:31], v[56:59], v[168:171]
  v_mfma_f32_16x16x32_bf16 v[176:179], v[28:31], v[60:63], v[176:179]
  v_mfma_f32_16x16x32_bf16 v[184:187], v[28:31], v[64:67], v[184:187]
  ds_read_b64_tr_b16 v[28:29], v4 offset:53248
  v_mfma_f32_16x16x32_bf16 v[164:167], v[32:35], v[52:55], v[164:167]
  ds_read_b64_tr_b16 v[30:31], v4 offset:53760
  v_mfma_f32_16x16x32_bf16 v[172:175], v[32:35], v[56:59], v[172:175]
  v_mfma_f32_16x16x32_bf16 v[180:183], v[32:35], v[60:63], v[180:183]
  v_mfma_f32_16x16x32_bf16 v[188:191], v[32:35], v[64:67], v[188:191]
  ds_read_b64_tr_b16 v[32:33], v5 offset:53248
  s_waitcnt lgkmcnt(14)
  v_mfma_f32_16x16x32_bf16 v[192:195], v[36:39], v[52:55], v[192:195]
  ds_read_b64_tr_b16 v[34:35], v5 offset:53760
  v_mfma_f32_16x16x32_bf16 v[200:203], v[36:39], v[56:59], v[200:203]
  v_mfma_f32_16x16x32_bf16 v[208:211], v[36:39], v[60:63], v[208:211]
  v_mfma_f32_16x16x32_bf16 v[216:219], v[36:39], v[64:67], v[216:219]
  ds_read_b64_tr_b16 v[36:37], v6 offset:53248
  v_mfma_f32_16x16x32_bf16 v[196:199], v[40:43], v[52:55], v[196:199]
  ds_read_b64_tr_b16 v[38:39], v6 offset:53760
  v_mfma_f32_16x16x32_bf16 v[204:207], v[40:43], v[56:59], v[204:207]
  v_mfma_f32_16x16x32_bf16 v[212:215], v[40:43], v[60:63], v[212:215]
  v_mfma_f32_16x16x32_bf16 v[220:223], v[40:43], v[64:67], v[220:223]
  ds_read_b64_tr_b16 v[40:41], v7 offset:53248
  v_mfma_f32_16x16x32_bf16 v[224:227], v[44:47], v[52:55], v[224:227]
  ds_read_b64_tr_b16 v[42:43], v7 offset:53760
  v_mfma_f32_16x16x32_bf16 v[232:235], v[44:47], v[56:59], v[232:235]
  v_mfma_f32_16x16x32_bf16 v[240:243], v[44:47], v[60:63], v[240:243]
  v_mfma_f32_16x16x32_bf16 v[248:251], v[44:47], v[64:67], v[248:251]
  ds_read_b64_tr_b16 v[44:45], v8 offset:43008
  v_mfma_f32_16x16x32_bf16 v[228:231], v[48:51], v[52:55], v[228:231]
  ds_read_b64_tr_b16 v[46:47], v8 offset:43264
  v_mfma_f32_16x16x32_bf16 v[236:239], v[48:51], v[56:59], v[236:239]
  v_mfma_f32_16x16x32_bf16 v[244:247], v[48:51], v[60:63], v[244:247]
  v_mfma_f32_16x16x32_bf16 v[252:255], v[48:51], v[64:67], v[252:255]
  ds_read_b64_tr_b16 v[48:49], v9 offset:43008
  s_waitcnt lgkmcnt(14)
  v_mfma_f32_16x16x32_bf16 v[96:99], v[12:15], v[68:71], v[96:99]
  ds_read_b64_tr_b16 v[50:51], v9 offset:43264
  v_mfma_f32_16x16x32_bf16 v[104:107], v[12:15], v[72:75], v[104:107]
  v_mfma_f32_16x16x32_bf16 v[112:115], v[12:15], v[76:79], v[112:115]
  v_mfma_f32_16x16x32_bf16 v[120:123], v[12:15], v[80:83], v[120:123]
  v_mfma_f32_16x16x32_bf16 v[100:103], v[16:19], v[68:71], v[100:103]
  v_mfma_f32_16x16x32_bf16 v[108:111], v[16:19], v[72:75], v[108:111]
  s_waitcnt lgkmcnt(0)
  s_barrier
  ds_read_b128 v[52:55], v2 offset:0
  v_mfma_f32_16x16x32_bf16 v[116:119], v[16:19], v[76:79], v[116:119]
  ds_read_b128 v[56:59], v2 offset:2048
  v_mfma_f32_16x16x32_bf16 v[124:127], v[16:19], v[80:83], v[124:127]
  ds_read_b128 v[60:63], v2 offset:4096
  v_mfma_f32_16x16x32_bf16 v[128:131], v[20:23], v[68:71], v[128:131]
  ds_read_b128 v[64:67], v2 offset:6144
  v_mfma_f32_16x16x32_bf16 v[136:139], v[20:23], v[72:75], v[136:139]
  ds_read_b64_tr_b16 v[12:13], v4 offset:0
  v_mfma_f32_16x16x32_bf16 v[144:147], v[20:23], v[76:79], v[144:147]
  ds_read_b64_tr_b16 v[14:15], v4 offset:512
  v_mfma_f32_16x16x32_bf16 v[152:155], v[20:23], v[80:83], v[152:155]
  ds_read_b64_tr_b16 v[16:17], v5 offset:0
  v_mfma_f32_16x16x32_bf16 v[132:135], v[24:27], v[68:71], v[132:135]
  ds_read_b64_tr_b16 v[18:19], v5 offset:512
  v_mfma_f32_16x16x32_bf16 v[140:143], v[24:27], v[72:75], v[140:143]
  ds_read_b64_tr_b16 v[20:21], v6 offset:0
  v_mfma_f32_16x16x32_bf16 v[148:151], v[24:27], v[76:79], v[148:151]
  ds_read_b64_tr_b16 v[22:23], v6 offset:512
  v_mfma_f32_16x16x32_bf16 v[156:159], v[24:27], v[80:83], v[156:159]
  ds_read_b64_tr_b16 v[24:25], v7 offset:0
  v_mfma_f32_16x16x32_bf16 v[160:163], v[28:31], v[68:71], v[160:163]
  ds_read_b64_tr_b16 v[26:27], v7 offset:512
  v_mfma_f32_16x16x32_bf16 v[168:171], v[28:31], v[72:75], v[168:171]
  v_mfma_f32_16x16x32_bf16 v[176:179], v[28:31], v[76:79], v[176:179]
  v_mfma_f32_16x16x32_bf16 v[184:187], v[28:31], v[80:83], v[184:187]
  ds_read_b64_tr_b16 v[28:29], v4 offset:8192
  v_mfma_f32_16x16x32_bf16 v[164:167], v[32:35], v[68:71], v[164:167]
  ds_read_b64_tr_b16 v[30:31], v4 offset:8704
  v_mfma_f32_16x16x32_bf16 v[172:175], v[32:35], v[72:75], v[172:175]
  v_mfma_f32_16x16x32_bf16 v[180:183], v[32:35], v[76:79], v[180:183]
  v_mfma_f32_16x16x32_bf16 v[188:191], v[32:35], v[80:83], v[188:191]
  ds_read_b64_tr_b16 v[32:33], v5 offset:8192
  v_mfma_f32_16x16x32_bf16 v[192:195], v[36:39], v[68:71], v[192:195]
  ds_read_b64_tr_b16 v[34:35], v5 offset:8704
  v_mfma_f32_16x16x32_bf16 v[200:203], v[36:39], v[72:75], v[200:203]
  v_mfma_f32_16x16x32_bf16 v[208:211], v[36:39], v[76:79], v[208:211]
  v_mfma_f32_16x16x32_bf16 v[216:219], v[36:39], v[80:83], v[216:219]
  ds_read_b64_tr_b16 v[36:37], v6 offset:8192
  v_mfma_f32_16x16x32_bf16 v[196:199], v[40:43], v[68:71], v[196:199]
  ds_read_b64_tr_b16 v[38:39], v6 offset:8704
  v_mfma_f32_16x16x32_bf16 v[204:207], v[40:43], v[72:75], v[204:207]
  v_mfma_f32_16x16x32_bf16 v[212:215], v[40:43], v[76:79], v[212:215]
  v_mfma_f32_16x16x32_bf16 v[220:223], v[40:43], v[80:83], v[220:223]
  ds_read_b64_tr_b16 v[40:41], v7 offset:8192
  v_mfma_f32_16x16x32_bf16 v[224:227], v[44:47], v[68:71], v[224:227]
  ds_read_b64_tr_b16 v[42:43], v7 offset:8704
  v_mfma_f32_16x16x32_bf16 v[232:235], v[44:47], v[72:75], v[232:235]
  v_mfma_f32_16x16x32_bf16 v[240:243], v[44:47], v[76:79], v[240:243]
  v_mfma_f32_16x16x32_bf16 v[248:251], v[44:47], v[80:83], v[248:251]
  ds_read_b64_tr_b16 v[44:45], v8 offset:0
  v_mfma_f32_16x16x32_bf16 v[228:231], v[48:51], v[68:71], v[228:231]
  ds_read_b64_tr_b16 v[46:47], v8 offset:256
  v_mfma_f32_16x16x32_bf16 v[236:239], v[48:51], v[72:75], v[236:239]
  v_mfma_f32_16x16x32_bf16 v[244:247], v[48:51], v[76:79], v[244:247]
  v_mfma_f32_16x16x32_bf16 v[252:255], v[48:51], v[80:83], v[252:255]
  ds_read_b64_tr_b16 v[48:49], v9 offset:0
  s_sub_u32 s63, s63, 1
  s_cmp_lg_u32 s63, 0
  s_cbranch_scc1 parallel_sum__grouped_kv_mqa__mixer_channel_mlp__prompt_kernel_h_loop
  s_lshl_b32 s57, s48, 8
  s_lshl_b32 s58, s55, 6
  s_add_u32 s57, s57, s58
  s_lshl_b32 s57, s57, 4
  s_add_u32 s57, s57, 23330816
  v_and_b32 v1, 15, v0
  v_lshlrev_b32 v1, 4, v1
  s_waitcnt lgkmcnt(14)
  v_mfma_f32_16x16x32_bf16 v[96:99], v[12:15], v[52:55], v[96:99]
  ds_read_b64_tr_b16 v[50:51], v9 offset:256
  v_mfma_f32_16x16x32_bf16 v[104:107], v[12:15], v[56:59], v[104:107]
  ds_read_b128 v[68:71], v3 offset:0
  v_mfma_f32_16x16x32_bf16 v[112:115], v[12:15], v[60:63], v[112:115]
  ds_read_b128 v[72:75], v3 offset:2048
  v_mfma_f32_16x16x32_bf16 v[120:123], v[12:15], v[64:67], v[120:123]
  ds_read_b128 v[76:79], v3 offset:4096
  v_mfma_f32_16x16x32_bf16 v[100:103], v[16:19], v[52:55], v[100:103]
  ds_read_b128 v[80:83], v3 offset:6144
  v_mfma_f32_16x16x32_bf16 v[108:111], v[16:19], v[56:59], v[108:111]
  ds_read_b64_tr_b16 v[12:13], v4 offset:4096
  v_mfma_f32_16x16x32_bf16 v[116:119], v[16:19], v[60:63], v[116:119]
  ds_read_b64_tr_b16 v[14:15], v4 offset:4608
  buffer_load_dwordx2 v[84:85], v1, s[36:39], s57 offen offset:0 sc1
  v_mfma_f32_16x16x32_bf16 v[124:127], v[16:19], v[64:67], v[124:127]
  ds_read_b64_tr_b16 v[16:17], v5 offset:4096
  s_waitcnt lgkmcnt(14)
  v_mfma_f32_16x16x32_bf16 v[128:131], v[20:23], v[52:55], v[128:131]
  ds_read_b64_tr_b16 v[18:19], v5 offset:4608
  v_mfma_f32_16x16x32_bf16 v[136:139], v[20:23], v[56:59], v[136:139]
  v_mfma_f32_16x16x32_bf16 v[144:147], v[20:23], v[60:63], v[144:147]
  buffer_load_dwordx2 v[86:87], v1, s[36:39], s57 offen offset:256 sc1
  v_mfma_f32_16x16x32_bf16 v[152:155], v[20:23], v[64:67], v[152:155]
  ds_read_b64_tr_b16 v[20:21], v6 offset:4096
  v_mfma_f32_16x16x32_bf16 v[132:135], v[24:27], v[52:55], v[132:135]
  ds_read_b64_tr_b16 v[22:23], v6 offset:4608
  v_mfma_f32_16x16x32_bf16 v[140:143], v[24:27], v[56:59], v[140:143]
  v_mfma_f32_16x16x32_bf16 v[148:151], v[24:27], v[60:63], v[148:151]
  buffer_load_dwordx2 v[88:89], v1, s[36:39], s57 offen offset:512 sc1
  v_mfma_f32_16x16x32_bf16 v[156:159], v[24:27], v[64:67], v[156:159]
  ds_read_b64_tr_b16 v[24:25], v7 offset:4096
  v_mfma_f32_16x16x32_bf16 v[160:163], v[28:31], v[52:55], v[160:163]
  ds_read_b64_tr_b16 v[26:27], v7 offset:4608
  v_mfma_f32_16x16x32_bf16 v[168:171], v[28:31], v[56:59], v[168:171]
  v_mfma_f32_16x16x32_bf16 v[176:179], v[28:31], v[60:63], v[176:179]
  buffer_load_dwordx2 v[90:91], v1, s[36:39], s57 offen offset:768 sc1
  v_mfma_f32_16x16x32_bf16 v[184:187], v[28:31], v[64:67], v[184:187]
  ds_read_b64_tr_b16 v[28:29], v4 offset:12288
  v_mfma_f32_16x16x32_bf16 v[164:167], v[32:35], v[52:55], v[164:167]
  ds_read_b64_tr_b16 v[30:31], v4 offset:12800
  v_mfma_f32_16x16x32_bf16 v[172:175], v[32:35], v[56:59], v[172:175]
  v_mfma_f32_16x16x32_bf16 v[180:183], v[32:35], v[60:63], v[180:183]
  buffer_load_dwordx2 v[92:93], v1, s[36:39], s57 offen offset:8 sc1
  v_mfma_f32_16x16x32_bf16 v[188:191], v[32:35], v[64:67], v[188:191]
  ds_read_b64_tr_b16 v[32:33], v5 offset:12288
  s_waitcnt lgkmcnt(14)
  v_mfma_f32_16x16x32_bf16 v[192:195], v[36:39], v[52:55], v[192:195]
  ds_read_b64_tr_b16 v[34:35], v5 offset:12800
  v_mfma_f32_16x16x32_bf16 v[200:203], v[36:39], v[56:59], v[200:203]
  v_mfma_f32_16x16x32_bf16 v[208:211], v[36:39], v[60:63], v[208:211]
  buffer_load_dwordx2 v[94:95], v1, s[36:39], s57 offen offset:264 sc1
  v_mfma_f32_16x16x32_bf16 v[216:219], v[36:39], v[64:67], v[216:219]
  ds_read_b64_tr_b16 v[36:37], v6 offset:12288
  v_mfma_f32_16x16x32_bf16 v[196:199], v[40:43], v[52:55], v[196:199]
  ds_read_b64_tr_b16 v[38:39], v6 offset:12800
  v_mfma_f32_16x16x32_bf16 v[204:207], v[40:43], v[56:59], v[204:207]
  v_mfma_f32_16x16x32_bf16 v[212:215], v[40:43], v[60:63], v[212:215]
  v_mfma_f32_16x16x32_bf16 v[220:223], v[40:43], v[64:67], v[220:223]
  ds_read_b64_tr_b16 v[40:41], v7 offset:12288
  v_mfma_f32_16x16x32_bf16 v[224:227], v[44:47], v[52:55], v[224:227]
  ds_read_b64_tr_b16 v[42:43], v7 offset:12800
  v_mfma_f32_16x16x32_bf16 v[232:235], v[44:47], v[56:59], v[232:235]
  v_mfma_f32_16x16x32_bf16 v[240:243], v[44:47], v[60:63], v[240:243]
  v_mfma_f32_16x16x32_bf16 v[248:251], v[44:47], v[64:67], v[248:251]
  ds_read_b64_tr_b16 v[44:45], v8 offset:2048
  v_mfma_f32_16x16x32_bf16 v[228:231], v[48:51], v[52:55], v[228:231]
  ds_read_b64_tr_b16 v[46:47], v8 offset:2304
  v_mfma_f32_16x16x32_bf16 v[236:239], v[48:51], v[56:59], v[236:239]
  v_mfma_f32_16x16x32_bf16 v[244:247], v[48:51], v[60:63], v[244:247]
  v_mfma_f32_16x16x32_bf16 v[252:255], v[48:51], v[64:67], v[252:255]
  ds_read_b64_tr_b16 v[48:49], v9 offset:2048
  s_waitcnt lgkmcnt(14)
  v_mfma_f32_16x16x32_bf16 v[96:99], v[12:15], v[68:71], v[96:99]
  ds_read_b64_tr_b16 v[50:51], v9 offset:2304
  v_mfma_f32_16x16x32_bf16 v[104:107], v[12:15], v[72:75], v[104:107]
  v_mfma_f32_16x16x32_bf16 v[112:115], v[12:15], v[76:79], v[112:115]
  v_mfma_f32_16x16x32_bf16 v[120:123], v[12:15], v[80:83], v[120:123]
  v_mfma_f32_16x16x32_bf16 v[100:103], v[16:19], v[68:71], v[100:103]
  buffer_load_dwordx2 v[52:53], v1, s[36:39], s57 offen offset:520 sc1
  v_mfma_f32_16x16x32_bf16 v[108:111], v[16:19], v[72:75], v[108:111]
  v_mfma_f32_16x16x32_bf16 v[116:119], v[16:19], v[76:79], v[116:119]
  buffer_load_dwordx2 v[54:55], v1, s[36:39], s57 offen offset:776 sc1
  v_mfma_f32_16x16x32_bf16 v[124:127], v[16:19], v[80:83], v[124:127]
  s_waitcnt lgkmcnt(12)
  v_mfma_f32_16x16x32_bf16 v[128:131], v[20:23], v[68:71], v[128:131]
  v_mfma_f32_16x16x32_bf16 v[136:139], v[20:23], v[72:75], v[136:139]
  v_mfma_f32_16x16x32_bf16 v[144:147], v[20:23], v[76:79], v[144:147]
  global_load_dword v10, v11, s[72:73]
  v_mfma_f32_16x16x32_bf16 v[152:155], v[20:23], v[80:83], v[152:155]
  v_mfma_f32_16x16x32_bf16 v[132:135], v[24:27], v[68:71], v[132:135]
  s_lshr_b32 s59, s55, 1
  s_lshl_b32 s58, s48, 1
  v_mfma_f32_16x16x32_bf16 v[140:143], v[24:27], v[72:75], v[140:143]
  v_mfma_f32_16x16x32_bf16 v[148:151], v[24:27], v[76:79], v[148:151]
  s_add_u32 s68, s59, s58
  s_mul_i32 s67, s68, 1179648
  v_mfma_f32_16x16x32_bf16 v[156:159], v[24:27], v[80:83], v[156:159]
  s_waitcnt lgkmcnt(8)
  v_mfma_f32_16x16x32_bf16 v[160:163], v[28:31], v[68:71], v[160:163]
  s_lshl_b32 s58, s49, 15
  s_add_u32 s67, s67, s58
  v_mfma_f32_16x16x32_bf16 v[168:171], v[28:31], v[72:75], v[168:171]
  v_mfma_f32_16x16x32_bf16 v[176:179], v[28:31], v[76:79], v[176:179]
  s_and_b32 s58, s55, 1
  s_lshl_b32 s58, s58, 12
  v_mfma_f32_16x16x32_bf16 v[184:187], v[28:31], v[80:83], v[184:187]
  v_mfma_f32_16x16x32_bf16 v[164:167], v[32:35], v[68:71], v[164:167]
  s_add_u32 s67, s67, s58
  s_add_u32 s67, s67, 262144
  v_mfma_f32_16x16x32_bf16 v[172:175], v[32:35], v[72:75], v[172:175]
  v_mfma_f32_16x16x32_bf16 v[180:183], v[32:35], v[76:79], v[180:183]
  v_lshrrev_b32 v2, 4, v0
  v_mfma_f32_16x16x32_bf16 v[188:191], v[32:35], v[80:83], v[188:191]
  v_lshlrev_b32 v2, 4, v2
  s_waitcnt lgkmcnt(4)
  v_mfma_f32_16x16x32_bf16 v[192:195], v[36:39], v[68:71], v[192:195]
  v_add_u32 v2, 159744, v2
  v_mfma_f32_16x16x32_bf16 v[200:203], v[36:39], v[72:75], v[200:203]
  v_bfe_u32 v4, v0, 4, 1
  v_mfma_f32_16x16x32_bf16 v[208:211], v[36:39], v[76:79], v[208:211]
  v_lshl_add_u32 v3, v4, 9, v1
  v_mfma_f32_16x16x32_bf16 v[216:219], v[36:39], v[80:83], v[216:219]
  v_lshrrev_b32 v4, 5, v0
  v_mfma_f32_16x16x32_bf16 v[196:199], v[40:43], v[68:71], v[196:199]
  v_lshl_add_u32 v3, v4, 3, v3
  s_lshl_b32 s58, s55, 12
  v_mfma_f32_16x16x32_bf16 v[204:207], v[40:43], v[72:75], v[204:207]
  s_add_u32 s58, s58, 49152
  v_mfma_f32_16x16x32_bf16 v[212:215], v[40:43], v[76:79], v[212:215]
  v_add_u32 v3, s58, v3
  v_mfma_f32_16x16x32_bf16 v[220:223], v[40:43], v[80:83], v[220:223]
  v_lshlrev_b32 v1, 4, v0
  s_waitcnt lgkmcnt(0)
  v_mfma_f32_16x16x32_bf16 v[224:227], v[44:47], v[68:71], v[224:227]
  v_mfma_f32_16x16x32_bf16 v[232:235], v[44:47], v[72:75], v[232:235]
  v_mfma_f32_16x16x32_bf16 v[240:243], v[44:47], v[76:79], v[240:243]
  v_mfma_f32_16x16x32_bf16 v[248:251], v[44:47], v[80:83], v[248:251]
  v_mfma_f32_16x16x32_bf16 v[228:231], v[48:51], v[68:71], v[228:231]
  v_mfma_f32_16x16x32_bf16 v[236:239], v[48:51], v[72:75], v[236:239]
  v_mfma_f32_16x16x32_bf16 v[244:247], v[48:51], v[76:79], v[244:247]
  v_mfma_f32_16x16x32_bf16 v[252:255], v[48:51], v[80:83], v[252:255]
  s_barrier
  s_setprio 3
  ds_read_b128 v[44:47], v2 offset:512
  ds_read_b128 v[48:51], v2 offset:576
  ds_read_b128 v[56:59], v2 offset:640
  ds_read_b128 v[60:63], v2 offset:704
  ds_read_b128 v[64:67], v2 offset:768
  ds_read_b128 v[68:71], v2 offset:832
  ds_read_b128 v[72:75], v2 offset:896
  ds_read_b128 v[76:79], v2 offset:960
  ds_read_b128 v[12:15], v2 offset:0
  ds_read_b128 v[16:19], v2 offset:64
  ds_read_b128 v[20:23], v2 offset:128
  ds_read_b128 v[24:27], v2 offset:192
  ds_read_b128 v[28:31], v2 offset:256
  ds_read_b128 v[32:35], v2 offset:320
  v_mov_b32 v80, 0xc0135761
  v_mov_b32 v82, 0xbdd2d3e8
  s_waitcnt vmcnt(5) lgkmcnt(6)
  ds_read_b128 v[36:39], v2 offset:384
  ds_read_b128 v[40:43], v2 offset:448
  v_pk_add_f32 v[44:45], v[44:45], v[56:57]
  v_pk_add_f32 v[64:65], v[64:65], v[72:73]
  v_pk_add_f32 v[46:47], v[46:47], v[58:59]
  v_pk_add_f32 v[66:67], v[66:67], v[74:75]
  v_pk_add_f32 v[48:49], v[48:49], v[60:61]
  v_pk_add_f32 v[68:69], v[68:69], v[76:77]
  v_pk_add_f32 v[50:51], v[50:51], v[62:63]
  v_pk_add_f32 v[70:71], v[70:71], v[78:79]
  v_pk_mul_f32 v[224:225], v[224:225], v[84:85] op_sel:[0,0] op_sel_hi:[1,0]
  v_pk_mul_f32 v[226:227], v[226:227], v[84:85] op_sel:[0,0] op_sel_hi:[1,0]
  v_pk_mul_f32 v[228:229], v[228:229], v[84:85] op_sel:[0,0] op_sel_hi:[1,0]
  v_pk_mul_f32 v[230:231], v[230:231], v[84:85] op_sel:[0,0] op_sel_hi:[1,0]
  v_pk_mul_f32 v[232:233], v[232:233], v[86:87] op_sel:[0,0] op_sel_hi:[1,0]
  v_pk_mul_f32 v[234:235], v[234:235], v[86:87] op_sel:[0,0] op_sel_hi:[1,0]
  v_pk_mul_f32 v[236:237], v[236:237], v[86:87] op_sel:[0,0] op_sel_hi:[1,0]
  v_pk_mul_f32 v[238:239], v[238:239], v[86:87] op_sel:[0,0] op_sel_hi:[1,0]
  v_pk_mul_f32 v[240:241], v[240:241], v[88:89] op_sel:[0,0] op_sel_hi:[1,0]
  v_pk_mul_f32 v[242:243], v[242:243], v[88:89] op_sel:[0,0] op_sel_hi:[1,0]
  v_pk_mul_f32 v[244:245], v[244:245], v[88:89] op_sel:[0,0] op_sel_hi:[1,0]
  v_pk_mul_f32 v[246:247], v[246:247], v[88:89] op_sel:[0,0] op_sel_hi:[1,0]
  v_pk_mul_f32 v[248:249], v[248:249], v[90:91] op_sel:[0,0] op_sel_hi:[1,0]
  v_pk_mul_f32 v[250:251], v[250:251], v[90:91] op_sel:[0,0] op_sel_hi:[1,0]
  v_pk_mul_f32 v[252:253], v[252:253], v[90:91] op_sel:[0,0] op_sel_hi:[1,0]
  v_pk_mul_f32 v[254:255], v[254:255], v[90:91] op_sel:[0,0] op_sel_hi:[1,0]
  v_pk_add_f32 v[44:45], v[44:45], v[64:65]
  v_pk_add_f32 v[46:47], v[46:47], v[66:67]
  v_pk_add_f32 v[48:49], v[48:49], v[68:69]
  v_pk_add_f32 v[50:51], v[50:51], v[70:71]
  v_pk_fma_f32 v[224:225], v[44:45], v[84:85], v[224:225] op_sel:[0,1,0] op_sel_hi:[1,1,1]
  v_pk_fma_f32 v[226:227], v[46:47], v[84:85], v[226:227] op_sel:[0,1,0] op_sel_hi:[1,1,1]
  v_pk_fma_f32 v[228:229], v[48:49], v[84:85], v[228:229] op_sel:[0,1,0] op_sel_hi:[1,1,1]
  v_pk_fma_f32 v[230:231], v[50:51], v[84:85], v[230:231] op_sel:[0,1,0] op_sel_hi:[1,1,1]
  v_pk_fma_f32 v[232:233], v[44:45], v[86:87], v[232:233] op_sel:[0,1,0] op_sel_hi:[1,1,1]
  v_pk_fma_f32 v[234:235], v[46:47], v[86:87], v[234:235] op_sel:[0,1,0] op_sel_hi:[1,1,1]
  v_pk_fma_f32 v[236:237], v[48:49], v[86:87], v[236:237] op_sel:[0,1,0] op_sel_hi:[1,1,1]
  v_pk_fma_f32 v[238:239], v[50:51], v[86:87], v[238:239] op_sel:[0,1,0] op_sel_hi:[1,1,1]
  v_pk_fma_f32 v[240:241], v[44:45], v[88:89], v[240:241] op_sel:[0,1,0] op_sel_hi:[1,1,1]
  v_pk_fma_f32 v[242:243], v[46:47], v[88:89], v[242:243] op_sel:[0,1,0] op_sel_hi:[1,1,1]
  v_pk_fma_f32 v[244:245], v[48:49], v[88:89], v[244:245] op_sel:[0,1,0] op_sel_hi:[1,1,1]
  v_pk_fma_f32 v[246:247], v[50:51], v[88:89], v[246:247] op_sel:[0,1,0] op_sel_hi:[1,1,1]
  v_pk_fma_f32 v[248:249], v[44:45], v[90:91], v[248:249] op_sel:[0,1,0] op_sel_hi:[1,1,1]
  v_pk_fma_f32 v[250:251], v[46:47], v[90:91], v[250:251] op_sel:[0,1,0] op_sel_hi:[1,1,1]
  v_pk_fma_f32 v[252:253], v[48:49], v[90:91], v[252:253] op_sel:[0,1,0] op_sel_hi:[1,1,1]
  v_pk_fma_f32 v[254:255], v[50:51], v[90:91], v[254:255] op_sel:[0,1,0] op_sel_hi:[1,1,1]
  s_waitcnt lgkmcnt(0)
  v_cvt_pk_bf16_f32 v56, v224, v225
  v_cvt_pk_bf16_f32 v57, v226, v227
  v_cvt_pk_bf16_f32 v58, v228, v229
  v_cvt_pk_bf16_f32 v59, v230, v231
  ds_write_b64 v3, v[56:57] offset:0
  ds_write_b64 v3, v[58:59] offset:1024
  v_cvt_pk_bf16_f32 v60, v232, v233
  v_cvt_pk_bf16_f32 v61, v234, v235
  v_cvt_pk_bf16_f32 v62, v236, v237
  v_cvt_pk_bf16_f32 v63, v238, v239
  ds_write_b64 v3, v[60:61] offset:256
  ds_write_b64 v3, v[62:63] offset:1280
  v_cvt_pk_bf16_f32 v64, v240, v241
  v_cvt_pk_bf16_f32 v65, v242, v243
  v_cvt_pk_bf16_f32 v66, v244, v245
  v_cvt_pk_bf16_f32 v67, v246, v247
  ds_write_b64 v3, v[64:65] offset:2048
  ds_write_b64 v3, v[66:67] offset:3072
  v_cvt_pk_bf16_f32 v68, v248, v249
  v_cvt_pk_bf16_f32 v69, v250, v251
  v_cvt_pk_bf16_f32 v70, v252, v253
  v_cvt_pk_bf16_f32 v71, v254, v255
  ds_write_b64 v3, v[68:69] offset:2304
  ds_write_b64 v3, v[70:71] offset:3328
  s_lshl_b32 s57, s55, 7
  s_add_u32 s57, s57, 161808
  v_mov_b32 v4, s57
  v_mov_b32 v5, 1
  ds_write_b32 v4, v5
  s_waitcnt lgkmcnt(6)
  ds_read_b128 v[224:227], v2 offset:1024
  ds_read_b128 v[228:231], v2 offset:1088
  ds_read_b128 v[232:235], v2 offset:1152
  ds_read_b128 v[236:239], v2 offset:1216
  ds_read_b128 v[240:243], v2 offset:1280
  ds_read_b128 v[244:247], v2 offset:1344
  ds_read_b128 v[248:251], v2 offset:1408
  ds_read_b128 v[252:255], v2 offset:1472
  s_waitcnt vmcnt(3) lgkmcnt(6)
  v_pk_fma_f32 v[44:45], v[12:13], v[92:93], v[224:225] op_sel:[0,1,0] op_sel_hi:[1,1,1]
  v_pk_fma_f32 v[46:47], v[14:15], v[92:93], v[226:227] op_sel:[0,1,0] op_sel_hi:[1,1,1]
  v_pk_fma_f32 v[48:49], v[16:17], v[92:93], v[228:229] op_sel:[0,1,0] op_sel_hi:[1,1,1]
  v_pk_fma_f32 v[50:51], v[18:19], v[92:93], v[230:231] op_sel:[0,1,0] op_sel_hi:[1,1,1]
  v_pk_fma_f32 v[96:97], v[96:97], v[92:93], v[44:45] op_sel:[0,0,0] op_sel_hi:[1,0,1]
  v_pk_fma_f32 v[98:99], v[98:99], v[92:93], v[46:47] op_sel:[0,0,0] op_sel_hi:[1,0,1]
  v_pk_fma_f32 v[100:101], v[100:101], v[92:93], v[48:49] op_sel:[0,0,0] op_sel_hi:[1,0,1]
  v_pk_fma_f32 v[102:103], v[102:103], v[92:93], v[50:51] op_sel:[0,0,0] op_sel_hi:[1,0,1]
  v_pk_mul_f32 v[44:45], v[96:97], v[96:97]
  v_pk_mul_f32 v[46:47], v[98:99], v[98:99]
  v_pk_mul_f32 v[48:49], v[100:101], v[100:101]
  v_pk_mul_f32 v[50:51], v[102:103], v[102:103]
  v_pk_fma_f32 v[44:45], v[44:45], v[82:83], v[80:81] op_sel:[0,0,0] op_sel_hi:[1,0,0]
  v_pk_fma_f32 v[46:47], v[46:47], v[82:83], v[80:81] op_sel:[0,0,0] op_sel_hi:[1,0,0]
  v_pk_fma_f32 v[48:49], v[48:49], v[82:83], v[80:81] op_sel:[0,0,0] op_sel_hi:[1,0,0]
  v_pk_fma_f32 v[50:51], v[50:51], v[82:83], v[80:81] op_sel:[0,0,0] op_sel_hi:[1,0,0]
  v_pk_mul_f32 v[44:45], v[44:45], v[96:97]
  v_pk_mul_f32 v[46:47], v[46:47], v[98:99]
  v_pk_mul_f32 v[48:49], v[48:49], v[100:101]
  v_pk_mul_f32 v[50:51], v[50:51], v[102:103]
  v_exp_f32 v44, v44
  v_exp_f32 v45, v45
  v_exp_f32 v46, v46
  v_exp_f32 v47, v47
  v_exp_f32 v48, v48
  v_exp_f32 v49, v49
  v_exp_f32 v50, v50
  v_exp_f32 v51, v51
  v_pk_add_f32 v[44:45], v[44:45], 1.0 op_sel_hi:[1,0]
  v_pk_add_f32 v[46:47], v[46:47], 1.0 op_sel_hi:[1,0]
  v_pk_add_f32 v[48:49], v[48:49], 1.0 op_sel_hi:[1,0]
  v_pk_add_f32 v[50:51], v[50:51], 1.0 op_sel_hi:[1,0]
  v_rcp_f32 v44, v44
  v_rcp_f32 v45, v45
  v_rcp_f32 v46, v46
  v_rcp_f32 v47, v47
  v_rcp_f32 v48, v48
  v_rcp_f32 v49, v49
  v_rcp_f32 v50, v50
  v_rcp_f32 v51, v51
  v_pk_mul_f32 v[96:97], v[96:97], v[44:45]
  v_pk_mul_f32 v[98:99], v[98:99], v[46:47]
  v_pk_mul_f32 v[100:101], v[100:101], v[48:49]
  v_pk_mul_f32 v[102:103], v[102:103], v[50:51]
  v_cvt_pk_bf16_f32 v96, v96, v97
  v_cvt_pk_bf16_f32 v97, v98, v99
  v_cvt_pk_bf16_f32 v98, v100, v101
  v_cvt_pk_bf16_f32 v99, v102, v103
  s_add_u32 s57, s67, 0
  buffer_store_dwordx4 v[96:99], v1, s[36:39], s57 offen offset:0 sc1
  s_waitcnt lgkmcnt(4)
  v_pk_fma_f32 v[44:45], v[20:21], v[92:93], v[232:233] op_sel:[0,1,0] op_sel_hi:[1,1,1]
  v_pk_fma_f32 v[46:47], v[22:23], v[92:93], v[234:235] op_sel:[0,1,0] op_sel_hi:[1,1,1]
  v_pk_fma_f32 v[48:49], v[24:25], v[92:93], v[236:237] op_sel:[0,1,0] op_sel_hi:[1,1,1]
  v_pk_fma_f32 v[50:51], v[26:27], v[92:93], v[238:239] op_sel:[0,1,0] op_sel_hi:[1,1,1]
  v_pk_fma_f32 v[128:129], v[128:129], v[92:93], v[44:45] op_sel:[0,0,0] op_sel_hi:[1,0,1]
  v_pk_fma_f32 v[130:131], v[130:131], v[92:93], v[46:47] op_sel:[0,0,0] op_sel_hi:[1,0,1]
  v_pk_fma_f32 v[132:133], v[132:133], v[92:93], v[48:49] op_sel:[0,0,0] op_sel_hi:[1,0,1]
  v_pk_fma_f32 v[134:135], v[134:135], v[92:93], v[50:51] op_sel:[0,0,0] op_sel_hi:[1,0,1]
  v_pk_mul_f32 v[44:45], v[128:129], v[128:129]
  v_pk_mul_f32 v[46:47], v[130:131], v[130:131]
  v_pk_mul_f32 v[48:49], v[132:133], v[132:133]
  v_pk_mul_f32 v[50:51], v[134:135], v[134:135]
  v_pk_fma_f32 v[44:45], v[44:45], v[82:83], v[80:81] op_sel:[0,0,0] op_sel_hi:[1,0,0]
  v_pk_fma_f32 v[46:47], v[46:47], v[82:83], v[80:81] op_sel:[0,0,0] op_sel_hi:[1,0,0]
  v_pk_fma_f32 v[48:49], v[48:49], v[82:83], v[80:81] op_sel:[0,0,0] op_sel_hi:[1,0,0]
  v_pk_fma_f32 v[50:51], v[50:51], v[82:83], v[80:81] op_sel:[0,0,0] op_sel_hi:[1,0,0]
  v_pk_mul_f32 v[44:45], v[44:45], v[128:129]
  v_pk_mul_f32 v[46:47], v[46:47], v[130:131]
  v_pk_mul_f32 v[48:49], v[48:49], v[132:133]
  v_pk_mul_f32 v[50:51], v[50:51], v[134:135]
  v_exp_f32 v44, v44
  v_exp_f32 v45, v45
  v_exp_f32 v46, v46
  v_exp_f32 v47, v47
  v_exp_f32 v48, v48
  v_exp_f32 v49, v49
  v_exp_f32 v50, v50
  v_exp_f32 v51, v51
  v_pk_add_f32 v[44:45], v[44:45], 1.0 op_sel_hi:[1,0]
  v_pk_add_f32 v[46:47], v[46:47], 1.0 op_sel_hi:[1,0]
  v_pk_add_f32 v[48:49], v[48:49], 1.0 op_sel_hi:[1,0]
  v_pk_add_f32 v[50:51], v[50:51], 1.0 op_sel_hi:[1,0]
  v_rcp_f32 v44, v44
  v_rcp_f32 v45, v45
  v_rcp_f32 v46, v46
  v_rcp_f32 v47, v47
  v_rcp_f32 v48, v48
  v_rcp_f32 v49, v49
  v_rcp_f32 v50, v50
  v_rcp_f32 v51, v51
  v_pk_mul_f32 v[128:129], v[128:129], v[44:45]
  v_pk_mul_f32 v[130:131], v[130:131], v[46:47]
  v_pk_mul_f32 v[132:133], v[132:133], v[48:49]
  v_pk_mul_f32 v[134:135], v[134:135], v[50:51]
  v_cvt_pk_bf16_f32 v128, v128, v129
  v_cvt_pk_bf16_f32 v129, v130, v131
  v_cvt_pk_bf16_f32 v130, v132, v133
  v_cvt_pk_bf16_f32 v131, v134, v135
  s_add_u32 s57, s67, 8192
  buffer_store_dwordx4 v[128:131], v1, s[36:39], s57 offen offset:0 sc1
  s_waitcnt lgkmcnt(2)
  v_pk_fma_f32 v[44:45], v[28:29], v[92:93], v[240:241] op_sel:[0,1,0] op_sel_hi:[1,1,1]
  v_pk_fma_f32 v[46:47], v[30:31], v[92:93], v[242:243] op_sel:[0,1,0] op_sel_hi:[1,1,1]
  v_pk_fma_f32 v[48:49], v[32:33], v[92:93], v[244:245] op_sel:[0,1,0] op_sel_hi:[1,1,1]
  v_pk_fma_f32 v[50:51], v[34:35], v[92:93], v[246:247] op_sel:[0,1,0] op_sel_hi:[1,1,1]
  v_pk_fma_f32 v[160:161], v[160:161], v[92:93], v[44:45] op_sel:[0,0,0] op_sel_hi:[1,0,1]
  v_pk_fma_f32 v[162:163], v[162:163], v[92:93], v[46:47] op_sel:[0,0,0] op_sel_hi:[1,0,1]
  v_pk_fma_f32 v[164:165], v[164:165], v[92:93], v[48:49] op_sel:[0,0,0] op_sel_hi:[1,0,1]
  v_pk_fma_f32 v[166:167], v[166:167], v[92:93], v[50:51] op_sel:[0,0,0] op_sel_hi:[1,0,1]
  v_pk_mul_f32 v[44:45], v[160:161], v[160:161]
  v_pk_mul_f32 v[46:47], v[162:163], v[162:163]
  v_pk_mul_f32 v[48:49], v[164:165], v[164:165]
  v_pk_mul_f32 v[50:51], v[166:167], v[166:167]
  v_pk_fma_f32 v[44:45], v[44:45], v[82:83], v[80:81] op_sel:[0,0,0] op_sel_hi:[1,0,0]
  v_pk_fma_f32 v[46:47], v[46:47], v[82:83], v[80:81] op_sel:[0,0,0] op_sel_hi:[1,0,0]
  v_pk_fma_f32 v[48:49], v[48:49], v[82:83], v[80:81] op_sel:[0,0,0] op_sel_hi:[1,0,0]
  v_pk_fma_f32 v[50:51], v[50:51], v[82:83], v[80:81] op_sel:[0,0,0] op_sel_hi:[1,0,0]
  v_pk_mul_f32 v[44:45], v[44:45], v[160:161]
  v_pk_mul_f32 v[46:47], v[46:47], v[162:163]
  v_pk_mul_f32 v[48:49], v[48:49], v[164:165]
  v_pk_mul_f32 v[50:51], v[50:51], v[166:167]
  v_exp_f32 v44, v44
  v_exp_f32 v45, v45
  v_exp_f32 v46, v46
  v_exp_f32 v47, v47
  v_exp_f32 v48, v48
  v_exp_f32 v49, v49
  v_exp_f32 v50, v50
  v_exp_f32 v51, v51
  v_pk_add_f32 v[44:45], v[44:45], 1.0 op_sel_hi:[1,0]
  v_pk_add_f32 v[46:47], v[46:47], 1.0 op_sel_hi:[1,0]
  v_pk_add_f32 v[48:49], v[48:49], 1.0 op_sel_hi:[1,0]
  v_pk_add_f32 v[50:51], v[50:51], 1.0 op_sel_hi:[1,0]
  v_rcp_f32 v44, v44
  v_rcp_f32 v45, v45
  v_rcp_f32 v46, v46
  v_rcp_f32 v47, v47
  v_rcp_f32 v48, v48
  v_rcp_f32 v49, v49
  v_rcp_f32 v50, v50
  v_rcp_f32 v51, v51
  v_pk_mul_f32 v[160:161], v[160:161], v[44:45]
  v_pk_mul_f32 v[162:163], v[162:163], v[46:47]
  v_pk_mul_f32 v[164:165], v[164:165], v[48:49]
  v_pk_mul_f32 v[166:167], v[166:167], v[50:51]
  v_cvt_pk_bf16_f32 v160, v160, v161
  v_cvt_pk_bf16_f32 v161, v162, v163
  v_cvt_pk_bf16_f32 v162, v164, v165
  v_cvt_pk_bf16_f32 v163, v166, v167
  s_add_u32 s57, s67, 16384
  buffer_store_dwordx4 v[160:163], v1, s[36:39], s57 offen offset:0 sc1
  s_waitcnt lgkmcnt(0)
  v_pk_fma_f32 v[44:45], v[36:37], v[92:93], v[248:249] op_sel:[0,1,0] op_sel_hi:[1,1,1]
  v_pk_fma_f32 v[46:47], v[38:39], v[92:93], v[250:251] op_sel:[0,1,0] op_sel_hi:[1,1,1]
  v_pk_fma_f32 v[48:49], v[40:41], v[92:93], v[252:253] op_sel:[0,1,0] op_sel_hi:[1,1,1]
  v_pk_fma_f32 v[50:51], v[42:43], v[92:93], v[254:255] op_sel:[0,1,0] op_sel_hi:[1,1,1]
  v_pk_fma_f32 v[192:193], v[192:193], v[92:93], v[44:45] op_sel:[0,0,0] op_sel_hi:[1,0,1]
  v_pk_fma_f32 v[194:195], v[194:195], v[92:93], v[46:47] op_sel:[0,0,0] op_sel_hi:[1,0,1]
  v_pk_fma_f32 v[196:197], v[196:197], v[92:93], v[48:49] op_sel:[0,0,0] op_sel_hi:[1,0,1]
  v_pk_fma_f32 v[198:199], v[198:199], v[92:93], v[50:51] op_sel:[0,0,0] op_sel_hi:[1,0,1]
  v_pk_mul_f32 v[44:45], v[192:193], v[192:193]
  v_pk_mul_f32 v[46:47], v[194:195], v[194:195]
  v_pk_mul_f32 v[48:49], v[196:197], v[196:197]
  v_pk_mul_f32 v[50:51], v[198:199], v[198:199]
  v_pk_fma_f32 v[44:45], v[44:45], v[82:83], v[80:81] op_sel:[0,0,0] op_sel_hi:[1,0,0]
  v_pk_fma_f32 v[46:47], v[46:47], v[82:83], v[80:81] op_sel:[0,0,0] op_sel_hi:[1,0,0]
  v_pk_fma_f32 v[48:49], v[48:49], v[82:83], v[80:81] op_sel:[0,0,0] op_sel_hi:[1,0,0]
  v_pk_fma_f32 v[50:51], v[50:51], v[82:83], v[80:81] op_sel:[0,0,0] op_sel_hi:[1,0,0]
  v_pk_mul_f32 v[44:45], v[44:45], v[192:193]
  v_pk_mul_f32 v[46:47], v[46:47], v[194:195]
  v_pk_mul_f32 v[48:49], v[48:49], v[196:197]
  v_pk_mul_f32 v[50:51], v[50:51], v[198:199]
  v_exp_f32 v44, v44
  v_exp_f32 v45, v45
  v_exp_f32 v46, v46
  v_exp_f32 v47, v47
  v_exp_f32 v48, v48
  v_exp_f32 v49, v49
  v_exp_f32 v50, v50
  v_exp_f32 v51, v51
  v_pk_add_f32 v[44:45], v[44:45], 1.0 op_sel_hi:[1,0]
  v_pk_add_f32 v[46:47], v[46:47], 1.0 op_sel_hi:[1,0]
  v_pk_add_f32 v[48:49], v[48:49], 1.0 op_sel_hi:[1,0]
  v_pk_add_f32 v[50:51], v[50:51], 1.0 op_sel_hi:[1,0]
  v_rcp_f32 v44, v44
  v_rcp_f32 v45, v45
  v_rcp_f32 v46, v46
  v_rcp_f32 v47, v47
  v_rcp_f32 v48, v48
  v_rcp_f32 v49, v49
  v_rcp_f32 v50, v50
  v_rcp_f32 v51, v51
  v_pk_mul_f32 v[192:193], v[192:193], v[44:45]
  v_pk_mul_f32 v[194:195], v[194:195], v[46:47]
  v_pk_mul_f32 v[196:197], v[196:197], v[48:49]
  v_pk_mul_f32 v[198:199], v[198:199], v[50:51]
  v_cvt_pk_bf16_f32 v192, v192, v193
  v_cvt_pk_bf16_f32 v193, v194, v195
  v_cvt_pk_bf16_f32 v194, v196, v197
  v_cvt_pk_bf16_f32 v195, v198, v199
  s_add_u32 s57, s67, 24576
  buffer_store_dwordx4 v[192:195], v1, s[36:39], s57 offen offset:0 sc1
  v_pk_fma_f32 v[44:45], v[12:13], v[94:95], v[224:225] op_sel:[0,1,0] op_sel_hi:[1,1,1]
  v_pk_fma_f32 v[46:47], v[14:15], v[94:95], v[226:227] op_sel:[0,1,0] op_sel_hi:[1,1,1]
  v_pk_fma_f32 v[48:49], v[16:17], v[94:95], v[228:229] op_sel:[0,1,0] op_sel_hi:[1,1,1]
  v_pk_fma_f32 v[50:51], v[18:19], v[94:95], v[230:231] op_sel:[0,1,0] op_sel_hi:[1,1,1]
  v_pk_fma_f32 v[104:105], v[104:105], v[94:95], v[44:45] op_sel:[0,0,0] op_sel_hi:[1,0,1]
  v_pk_fma_f32 v[106:107], v[106:107], v[94:95], v[46:47] op_sel:[0,0,0] op_sel_hi:[1,0,1]
  v_pk_fma_f32 v[108:109], v[108:109], v[94:95], v[48:49] op_sel:[0,0,0] op_sel_hi:[1,0,1]
  v_pk_fma_f32 v[110:111], v[110:111], v[94:95], v[50:51] op_sel:[0,0,0] op_sel_hi:[1,0,1]
  v_pk_mul_f32 v[44:45], v[104:105], v[104:105]
  v_pk_mul_f32 v[46:47], v[106:107], v[106:107]
  v_pk_mul_f32 v[48:49], v[108:109], v[108:109]
  v_pk_mul_f32 v[50:51], v[110:111], v[110:111]
  v_pk_fma_f32 v[44:45], v[44:45], v[82:83], v[80:81] op_sel:[0,0,0] op_sel_hi:[1,0,0]
  v_pk_fma_f32 v[46:47], v[46:47], v[82:83], v[80:81] op_sel:[0,0,0] op_sel_hi:[1,0,0]
  v_pk_fma_f32 v[48:49], v[48:49], v[82:83], v[80:81] op_sel:[0,0,0] op_sel_hi:[1,0,0]
  v_pk_fma_f32 v[50:51], v[50:51], v[82:83], v[80:81] op_sel:[0,0,0] op_sel_hi:[1,0,0]
  v_pk_mul_f32 v[44:45], v[44:45], v[104:105]
  v_pk_mul_f32 v[46:47], v[46:47], v[106:107]
  v_pk_mul_f32 v[48:49], v[48:49], v[108:109]
  v_pk_mul_f32 v[50:51], v[50:51], v[110:111]
  v_exp_f32 v44, v44
  v_exp_f32 v45, v45
  v_exp_f32 v46, v46
  v_exp_f32 v47, v47
  v_exp_f32 v48, v48
  v_exp_f32 v49, v49
  v_exp_f32 v50, v50
  v_exp_f32 v51, v51
  v_pk_add_f32 v[44:45], v[44:45], 1.0 op_sel_hi:[1,0]
  v_pk_add_f32 v[46:47], v[46:47], 1.0 op_sel_hi:[1,0]
  v_pk_add_f32 v[48:49], v[48:49], 1.0 op_sel_hi:[1,0]
  v_pk_add_f32 v[50:51], v[50:51], 1.0 op_sel_hi:[1,0]
  v_rcp_f32 v44, v44
  v_rcp_f32 v45, v45
  v_rcp_f32 v46, v46
  v_rcp_f32 v47, v47
  v_rcp_f32 v48, v48
  v_rcp_f32 v49, v49
  v_rcp_f32 v50, v50
  v_rcp_f32 v51, v51
  v_pk_mul_f32 v[104:105], v[104:105], v[44:45]
  v_pk_mul_f32 v[106:107], v[106:107], v[46:47]
  v_pk_mul_f32 v[108:109], v[108:109], v[48:49]
  v_pk_mul_f32 v[110:111], v[110:111], v[50:51]
  v_cvt_pk_bf16_f32 v104, v104, v105
  v_cvt_pk_bf16_f32 v105, v106, v107
  v_cvt_pk_bf16_f32 v106, v108, v109
  v_cvt_pk_bf16_f32 v107, v110, v111
  s_add_u32 s57, s67, 0
  buffer_store_dwordx4 v[104:107], v1, s[36:39], s57 offen offset:1024 sc1
  v_pk_fma_f32 v[44:45], v[20:21], v[94:95], v[232:233] op_sel:[0,1,0] op_sel_hi:[1,1,1]
  v_pk_fma_f32 v[46:47], v[22:23], v[94:95], v[234:235] op_sel:[0,1,0] op_sel_hi:[1,1,1]
  v_pk_fma_f32 v[48:49], v[24:25], v[94:95], v[236:237] op_sel:[0,1,0] op_sel_hi:[1,1,1]
  v_pk_fma_f32 v[50:51], v[26:27], v[94:95], v[238:239] op_sel:[0,1,0] op_sel_hi:[1,1,1]
  v_pk_fma_f32 v[136:137], v[136:137], v[94:95], v[44:45] op_sel:[0,0,0] op_sel_hi:[1,0,1]
  v_pk_fma_f32 v[138:139], v[138:139], v[94:95], v[46:47] op_sel:[0,0,0] op_sel_hi:[1,0,1]
  v_pk_fma_f32 v[140:141], v[140:141], v[94:95], v[48:49] op_sel:[0,0,0] op_sel_hi:[1,0,1]
  v_pk_fma_f32 v[142:143], v[142:143], v[94:95], v[50:51] op_sel:[0,0,0] op_sel_hi:[1,0,1]
  v_pk_mul_f32 v[44:45], v[136:137], v[136:137]
  v_pk_mul_f32 v[46:47], v[138:139], v[138:139]
  v_pk_mul_f32 v[48:49], v[140:141], v[140:141]
  v_pk_mul_f32 v[50:51], v[142:143], v[142:143]
  v_pk_fma_f32 v[44:45], v[44:45], v[82:83], v[80:81] op_sel:[0,0,0] op_sel_hi:[1,0,0]
  v_pk_fma_f32 v[46:47], v[46:47], v[82:83], v[80:81] op_sel:[0,0,0] op_sel_hi:[1,0,0]
  v_pk_fma_f32 v[48:49], v[48:49], v[82:83], v[80:81] op_sel:[0,0,0] op_sel_hi:[1,0,0]
  v_pk_fma_f32 v[50:51], v[50:51], v[82:83], v[80:81] op_sel:[0,0,0] op_sel_hi:[1,0,0]
  v_pk_mul_f32 v[44:45], v[44:45], v[136:137]
  v_pk_mul_f32 v[46:47], v[46:47], v[138:139]
  v_pk_mul_f32 v[48:49], v[48:49], v[140:141]
  v_pk_mul_f32 v[50:51], v[50:51], v[142:143]
  v_exp_f32 v44, v44
  v_exp_f32 v45, v45
  v_exp_f32 v46, v46
  v_exp_f32 v47, v47
  v_exp_f32 v48, v48
  v_exp_f32 v49, v49
  v_exp_f32 v50, v50
  v_exp_f32 v51, v51
  v_pk_add_f32 v[44:45], v[44:45], 1.0 op_sel_hi:[1,0]
  v_pk_add_f32 v[46:47], v[46:47], 1.0 op_sel_hi:[1,0]
  v_pk_add_f32 v[48:49], v[48:49], 1.0 op_sel_hi:[1,0]
  v_pk_add_f32 v[50:51], v[50:51], 1.0 op_sel_hi:[1,0]
  v_rcp_f32 v44, v44
  v_rcp_f32 v45, v45
  v_rcp_f32 v46, v46
  v_rcp_f32 v47, v47
  v_rcp_f32 v48, v48
  v_rcp_f32 v49, v49
  v_rcp_f32 v50, v50
  v_rcp_f32 v51, v51
  v_pk_mul_f32 v[136:137], v[136:137], v[44:45]
  v_pk_mul_f32 v[138:139], v[138:139], v[46:47]
  v_pk_mul_f32 v[140:141], v[140:141], v[48:49]
  v_pk_mul_f32 v[142:143], v[142:143], v[50:51]
  v_cvt_pk_bf16_f32 v136, v136, v137
  v_cvt_pk_bf16_f32 v137, v138, v139
  v_cvt_pk_bf16_f32 v138, v140, v141
  v_cvt_pk_bf16_f32 v139, v142, v143
  s_add_u32 s57, s67, 8192
  buffer_store_dwordx4 v[136:139], v1, s[36:39], s57 offen offset:1024 sc1
  v_pk_fma_f32 v[44:45], v[28:29], v[94:95], v[240:241] op_sel:[0,1,0] op_sel_hi:[1,1,1]
  v_pk_fma_f32 v[46:47], v[30:31], v[94:95], v[242:243] op_sel:[0,1,0] op_sel_hi:[1,1,1]
  v_pk_fma_f32 v[48:49], v[32:33], v[94:95], v[244:245] op_sel:[0,1,0] op_sel_hi:[1,1,1]
  v_pk_fma_f32 v[50:51], v[34:35], v[94:95], v[246:247] op_sel:[0,1,0] op_sel_hi:[1,1,1]
  v_pk_fma_f32 v[168:169], v[168:169], v[94:95], v[44:45] op_sel:[0,0,0] op_sel_hi:[1,0,1]
  v_pk_fma_f32 v[170:171], v[170:171], v[94:95], v[46:47] op_sel:[0,0,0] op_sel_hi:[1,0,1]
  v_pk_fma_f32 v[172:173], v[172:173], v[94:95], v[48:49] op_sel:[0,0,0] op_sel_hi:[1,0,1]
  v_pk_fma_f32 v[174:175], v[174:175], v[94:95], v[50:51] op_sel:[0,0,0] op_sel_hi:[1,0,1]
  v_pk_mul_f32 v[44:45], v[168:169], v[168:169]
  v_pk_mul_f32 v[46:47], v[170:171], v[170:171]
  v_pk_mul_f32 v[48:49], v[172:173], v[172:173]
  v_pk_mul_f32 v[50:51], v[174:175], v[174:175]
  v_pk_fma_f32 v[44:45], v[44:45], v[82:83], v[80:81] op_sel:[0,0,0] op_sel_hi:[1,0,0]
  v_pk_fma_f32 v[46:47], v[46:47], v[82:83], v[80:81] op_sel:[0,0,0] op_sel_hi:[1,0,0]
  v_pk_fma_f32 v[48:49], v[48:49], v[82:83], v[80:81] op_sel:[0,0,0] op_sel_hi:[1,0,0]
  v_pk_fma_f32 v[50:51], v[50:51], v[82:83], v[80:81] op_sel:[0,0,0] op_sel_hi:[1,0,0]
  v_pk_mul_f32 v[44:45], v[44:45], v[168:169]
  v_pk_mul_f32 v[46:47], v[46:47], v[170:171]
  v_pk_mul_f32 v[48:49], v[48:49], v[172:173]
  v_pk_mul_f32 v[50:51], v[50:51], v[174:175]
  v_exp_f32 v44, v44
  v_exp_f32 v45, v45
  v_exp_f32 v46, v46
  v_exp_f32 v47, v47
  v_exp_f32 v48, v48
  v_exp_f32 v49, v49
  v_exp_f32 v50, v50
  v_exp_f32 v51, v51
  v_pk_add_f32 v[44:45], v[44:45], 1.0 op_sel_hi:[1,0]
  v_pk_add_f32 v[46:47], v[46:47], 1.0 op_sel_hi:[1,0]
  v_pk_add_f32 v[48:49], v[48:49], 1.0 op_sel_hi:[1,0]
  v_pk_add_f32 v[50:51], v[50:51], 1.0 op_sel_hi:[1,0]
  v_rcp_f32 v44, v44
  v_rcp_f32 v45, v45
  v_rcp_f32 v46, v46
  v_rcp_f32 v47, v47
  v_rcp_f32 v48, v48
  v_rcp_f32 v49, v49
  v_rcp_f32 v50, v50
  v_rcp_f32 v51, v51
  v_pk_mul_f32 v[168:169], v[168:169], v[44:45]
  v_pk_mul_f32 v[170:171], v[170:171], v[46:47]
  v_pk_mul_f32 v[172:173], v[172:173], v[48:49]
  v_pk_mul_f32 v[174:175], v[174:175], v[50:51]
  v_cvt_pk_bf16_f32 v168, v168, v169
  v_cvt_pk_bf16_f32 v169, v170, v171
  v_cvt_pk_bf16_f32 v170, v172, v173
  v_cvt_pk_bf16_f32 v171, v174, v175
  s_add_u32 s57, s67, 16384
  buffer_store_dwordx4 v[168:171], v1, s[36:39], s57 offen offset:1024 sc1
  v_pk_fma_f32 v[44:45], v[36:37], v[94:95], v[248:249] op_sel:[0,1,0] op_sel_hi:[1,1,1]
  v_pk_fma_f32 v[46:47], v[38:39], v[94:95], v[250:251] op_sel:[0,1,0] op_sel_hi:[1,1,1]
  v_pk_fma_f32 v[48:49], v[40:41], v[94:95], v[252:253] op_sel:[0,1,0] op_sel_hi:[1,1,1]
  v_pk_fma_f32 v[50:51], v[42:43], v[94:95], v[254:255] op_sel:[0,1,0] op_sel_hi:[1,1,1]
  v_pk_fma_f32 v[200:201], v[200:201], v[94:95], v[44:45] op_sel:[0,0,0] op_sel_hi:[1,0,1]
  v_pk_fma_f32 v[202:203], v[202:203], v[94:95], v[46:47] op_sel:[0,0,0] op_sel_hi:[1,0,1]
  v_pk_fma_f32 v[204:205], v[204:205], v[94:95], v[48:49] op_sel:[0,0,0] op_sel_hi:[1,0,1]
  v_pk_fma_f32 v[206:207], v[206:207], v[94:95], v[50:51] op_sel:[0,0,0] op_sel_hi:[1,0,1]
  v_pk_mul_f32 v[44:45], v[200:201], v[200:201]
  v_pk_mul_f32 v[46:47], v[202:203], v[202:203]
  v_pk_mul_f32 v[48:49], v[204:205], v[204:205]
  v_pk_mul_f32 v[50:51], v[206:207], v[206:207]
  v_pk_fma_f32 v[44:45], v[44:45], v[82:83], v[80:81] op_sel:[0,0,0] op_sel_hi:[1,0,0]
  v_pk_fma_f32 v[46:47], v[46:47], v[82:83], v[80:81] op_sel:[0,0,0] op_sel_hi:[1,0,0]
  v_pk_fma_f32 v[48:49], v[48:49], v[82:83], v[80:81] op_sel:[0,0,0] op_sel_hi:[1,0,0]
  v_pk_fma_f32 v[50:51], v[50:51], v[82:83], v[80:81] op_sel:[0,0,0] op_sel_hi:[1,0,0]
  v_pk_mul_f32 v[44:45], v[44:45], v[200:201]
  v_pk_mul_f32 v[46:47], v[46:47], v[202:203]
  v_pk_mul_f32 v[48:49], v[48:49], v[204:205]
  v_pk_mul_f32 v[50:51], v[50:51], v[206:207]
  v_exp_f32 v44, v44
  v_exp_f32 v45, v45
  v_exp_f32 v46, v46
  v_exp_f32 v47, v47
  v_exp_f32 v48, v48
  v_exp_f32 v49, v49
  v_exp_f32 v50, v50
  v_exp_f32 v51, v51
  v_pk_add_f32 v[44:45], v[44:45], 1.0 op_sel_hi:[1,0]
  v_pk_add_f32 v[46:47], v[46:47], 1.0 op_sel_hi:[1,0]
  v_pk_add_f32 v[48:49], v[48:49], 1.0 op_sel_hi:[1,0]
  v_pk_add_f32 v[50:51], v[50:51], 1.0 op_sel_hi:[1,0]
  v_rcp_f32 v44, v44
  v_rcp_f32 v45, v45
  v_rcp_f32 v46, v46
  v_rcp_f32 v47, v47
  v_rcp_f32 v48, v48
  v_rcp_f32 v49, v49
  v_rcp_f32 v50, v50
  v_rcp_f32 v51, v51
  v_pk_mul_f32 v[200:201], v[200:201], v[44:45]
  v_pk_mul_f32 v[202:203], v[202:203], v[46:47]
  v_pk_mul_f32 v[204:205], v[204:205], v[48:49]
  v_pk_mul_f32 v[206:207], v[206:207], v[50:51]
  v_cvt_pk_bf16_f32 v200, v200, v201
  v_cvt_pk_bf16_f32 v201, v202, v203
  v_cvt_pk_bf16_f32 v202, v204, v205
  v_cvt_pk_bf16_f32 v203, v206, v207
  s_add_u32 s57, s67, 24576
  buffer_store_dwordx4 v[200:203], v1, s[36:39], s57 offen offset:1024 sc1
  s_waitcnt vmcnt(9)
  v_pk_fma_f32 v[44:45], v[12:13], v[52:53], v[224:225] op_sel:[0,1,0] op_sel_hi:[1,1,1]
  v_pk_fma_f32 v[46:47], v[14:15], v[52:53], v[226:227] op_sel:[0,1,0] op_sel_hi:[1,1,1]
  v_pk_fma_f32 v[48:49], v[16:17], v[52:53], v[228:229] op_sel:[0,1,0] op_sel_hi:[1,1,1]
  v_pk_fma_f32 v[50:51], v[18:19], v[52:53], v[230:231] op_sel:[0,1,0] op_sel_hi:[1,1,1]
  v_pk_fma_f32 v[112:113], v[112:113], v[52:53], v[44:45] op_sel:[0,0,0] op_sel_hi:[1,0,1]
  v_pk_fma_f32 v[114:115], v[114:115], v[52:53], v[46:47] op_sel:[0,0,0] op_sel_hi:[1,0,1]
  v_pk_fma_f32 v[116:117], v[116:117], v[52:53], v[48:49] op_sel:[0,0,0] op_sel_hi:[1,0,1]
  v_pk_fma_f32 v[118:119], v[118:119], v[52:53], v[50:51] op_sel:[0,0,0] op_sel_hi:[1,0,1]
  v_pk_mul_f32 v[44:45], v[112:113], v[112:113]
  v_pk_mul_f32 v[46:47], v[114:115], v[114:115]
  v_pk_mul_f32 v[48:49], v[116:117], v[116:117]
  v_pk_mul_f32 v[50:51], v[118:119], v[118:119]
  v_pk_fma_f32 v[44:45], v[44:45], v[82:83], v[80:81] op_sel:[0,0,0] op_sel_hi:[1,0,0]
  v_pk_fma_f32 v[46:47], v[46:47], v[82:83], v[80:81] op_sel:[0,0,0] op_sel_hi:[1,0,0]
  v_pk_fma_f32 v[48:49], v[48:49], v[82:83], v[80:81] op_sel:[0,0,0] op_sel_hi:[1,0,0]
  v_pk_fma_f32 v[50:51], v[50:51], v[82:83], v[80:81] op_sel:[0,0,0] op_sel_hi:[1,0,0]
  v_pk_mul_f32 v[44:45], v[44:45], v[112:113]
  v_pk_mul_f32 v[46:47], v[46:47], v[114:115]
  v_pk_mul_f32 v[48:49], v[48:49], v[116:117]
  v_pk_mul_f32 v[50:51], v[50:51], v[118:119]
  v_exp_f32 v44, v44
  v_exp_f32 v45, v45
  v_exp_f32 v46, v46
  v_exp_f32 v47, v47
  v_exp_f32 v48, v48
  v_exp_f32 v49, v49
  v_exp_f32 v50, v50
  v_exp_f32 v51, v51
  v_pk_add_f32 v[44:45], v[44:45], 1.0 op_sel_hi:[1,0]
  v_pk_add_f32 v[46:47], v[46:47], 1.0 op_sel_hi:[1,0]
  v_pk_add_f32 v[48:49], v[48:49], 1.0 op_sel_hi:[1,0]
  v_pk_add_f32 v[50:51], v[50:51], 1.0 op_sel_hi:[1,0]
  v_rcp_f32 v44, v44
  v_rcp_f32 v45, v45
  v_rcp_f32 v46, v46
  v_rcp_f32 v47, v47
  v_rcp_f32 v48, v48
  v_rcp_f32 v49, v49
  v_rcp_f32 v50, v50
  v_rcp_f32 v51, v51
  v_pk_mul_f32 v[112:113], v[112:113], v[44:45]
  v_pk_mul_f32 v[114:115], v[114:115], v[46:47]
  v_pk_mul_f32 v[116:117], v[116:117], v[48:49]
  v_pk_mul_f32 v[118:119], v[118:119], v[50:51]
  v_cvt_pk_bf16_f32 v112, v112, v113
  v_cvt_pk_bf16_f32 v113, v114, v115
  v_cvt_pk_bf16_f32 v114, v116, v117
  v_cvt_pk_bf16_f32 v115, v118, v119
  s_add_u32 s57, s67, 0
  buffer_store_dwordx4 v[112:115], v1, s[36:39], s57 offen offset:2048 sc1
  v_pk_fma_f32 v[44:45], v[20:21], v[52:53], v[232:233] op_sel:[0,1,0] op_sel_hi:[1,1,1]
  v_pk_fma_f32 v[46:47], v[22:23], v[52:53], v[234:235] op_sel:[0,1,0] op_sel_hi:[1,1,1]
  v_pk_fma_f32 v[48:49], v[24:25], v[52:53], v[236:237] op_sel:[0,1,0] op_sel_hi:[1,1,1]
  v_pk_fma_f32 v[50:51], v[26:27], v[52:53], v[238:239] op_sel:[0,1,0] op_sel_hi:[1,1,1]
  v_pk_fma_f32 v[144:145], v[144:145], v[52:53], v[44:45] op_sel:[0,0,0] op_sel_hi:[1,0,1]
  v_pk_fma_f32 v[146:147], v[146:147], v[52:53], v[46:47] op_sel:[0,0,0] op_sel_hi:[1,0,1]
  v_pk_fma_f32 v[148:149], v[148:149], v[52:53], v[48:49] op_sel:[0,0,0] op_sel_hi:[1,0,1]
  v_pk_fma_f32 v[150:151], v[150:151], v[52:53], v[50:51] op_sel:[0,0,0] op_sel_hi:[1,0,1]
  v_pk_mul_f32 v[44:45], v[144:145], v[144:145]
  v_pk_mul_f32 v[46:47], v[146:147], v[146:147]
  v_pk_mul_f32 v[48:49], v[148:149], v[148:149]
  v_pk_mul_f32 v[50:51], v[150:151], v[150:151]
  v_pk_fma_f32 v[44:45], v[44:45], v[82:83], v[80:81] op_sel:[0,0,0] op_sel_hi:[1,0,0]
  v_pk_fma_f32 v[46:47], v[46:47], v[82:83], v[80:81] op_sel:[0,0,0] op_sel_hi:[1,0,0]
  v_pk_fma_f32 v[48:49], v[48:49], v[82:83], v[80:81] op_sel:[0,0,0] op_sel_hi:[1,0,0]
  v_pk_fma_f32 v[50:51], v[50:51], v[82:83], v[80:81] op_sel:[0,0,0] op_sel_hi:[1,0,0]
  v_pk_mul_f32 v[44:45], v[44:45], v[144:145]
  v_pk_mul_f32 v[46:47], v[46:47], v[146:147]
  v_pk_mul_f32 v[48:49], v[48:49], v[148:149]
  v_pk_mul_f32 v[50:51], v[50:51], v[150:151]
  v_exp_f32 v44, v44
  v_exp_f32 v45, v45
  v_exp_f32 v46, v46
  v_exp_f32 v47, v47
  v_exp_f32 v48, v48
  v_exp_f32 v49, v49
  v_exp_f32 v50, v50
  v_exp_f32 v51, v51
  v_pk_add_f32 v[44:45], v[44:45], 1.0 op_sel_hi:[1,0]
  v_pk_add_f32 v[46:47], v[46:47], 1.0 op_sel_hi:[1,0]
  v_pk_add_f32 v[48:49], v[48:49], 1.0 op_sel_hi:[1,0]
  v_pk_add_f32 v[50:51], v[50:51], 1.0 op_sel_hi:[1,0]
  v_rcp_f32 v44, v44
  v_rcp_f32 v45, v45
  v_rcp_f32 v46, v46
  v_rcp_f32 v47, v47
  v_rcp_f32 v48, v48
  v_rcp_f32 v49, v49
  v_rcp_f32 v50, v50
  v_rcp_f32 v51, v51
  v_pk_mul_f32 v[144:145], v[144:145], v[44:45]
  v_pk_mul_f32 v[146:147], v[146:147], v[46:47]
  v_pk_mul_f32 v[148:149], v[148:149], v[48:49]
  v_pk_mul_f32 v[150:151], v[150:151], v[50:51]
  v_cvt_pk_bf16_f32 v144, v144, v145
  v_cvt_pk_bf16_f32 v145, v146, v147
  v_cvt_pk_bf16_f32 v146, v148, v149
  v_cvt_pk_bf16_f32 v147, v150, v151
  s_add_u32 s57, s67, 8192
  buffer_store_dwordx4 v[144:147], v1, s[36:39], s57 offen offset:2048 sc1
  v_pk_fma_f32 v[44:45], v[28:29], v[52:53], v[240:241] op_sel:[0,1,0] op_sel_hi:[1,1,1]
  v_pk_fma_f32 v[46:47], v[30:31], v[52:53], v[242:243] op_sel:[0,1,0] op_sel_hi:[1,1,1]
  v_pk_fma_f32 v[48:49], v[32:33], v[52:53], v[244:245] op_sel:[0,1,0] op_sel_hi:[1,1,1]
  v_pk_fma_f32 v[50:51], v[34:35], v[52:53], v[246:247] op_sel:[0,1,0] op_sel_hi:[1,1,1]
  v_pk_fma_f32 v[176:177], v[176:177], v[52:53], v[44:45] op_sel:[0,0,0] op_sel_hi:[1,0,1]
  v_pk_fma_f32 v[178:179], v[178:179], v[52:53], v[46:47] op_sel:[0,0,0] op_sel_hi:[1,0,1]
  v_pk_fma_f32 v[180:181], v[180:181], v[52:53], v[48:49] op_sel:[0,0,0] op_sel_hi:[1,0,1]
  v_pk_fma_f32 v[182:183], v[182:183], v[52:53], v[50:51] op_sel:[0,0,0] op_sel_hi:[1,0,1]
  v_pk_mul_f32 v[44:45], v[176:177], v[176:177]
  v_pk_mul_f32 v[46:47], v[178:179], v[178:179]
  v_pk_mul_f32 v[48:49], v[180:181], v[180:181]
  v_pk_mul_f32 v[50:51], v[182:183], v[182:183]
  v_pk_fma_f32 v[44:45], v[44:45], v[82:83], v[80:81] op_sel:[0,0,0] op_sel_hi:[1,0,0]
  v_pk_fma_f32 v[46:47], v[46:47], v[82:83], v[80:81] op_sel:[0,0,0] op_sel_hi:[1,0,0]
  v_pk_fma_f32 v[48:49], v[48:49], v[82:83], v[80:81] op_sel:[0,0,0] op_sel_hi:[1,0,0]
  v_pk_fma_f32 v[50:51], v[50:51], v[82:83], v[80:81] op_sel:[0,0,0] op_sel_hi:[1,0,0]
  v_pk_mul_f32 v[44:45], v[44:45], v[176:177]
  v_pk_mul_f32 v[46:47], v[46:47], v[178:179]
  v_pk_mul_f32 v[48:49], v[48:49], v[180:181]
  v_pk_mul_f32 v[50:51], v[50:51], v[182:183]
  v_exp_f32 v44, v44
  v_exp_f32 v45, v45
  v_exp_f32 v46, v46
  v_exp_f32 v47, v47
  v_exp_f32 v48, v48
  v_exp_f32 v49, v49
  v_exp_f32 v50, v50
  v_exp_f32 v51, v51
  v_pk_add_f32 v[44:45], v[44:45], 1.0 op_sel_hi:[1,0]
  v_pk_add_f32 v[46:47], v[46:47], 1.0 op_sel_hi:[1,0]
  v_pk_add_f32 v[48:49], v[48:49], 1.0 op_sel_hi:[1,0]
  v_pk_add_f32 v[50:51], v[50:51], 1.0 op_sel_hi:[1,0]
  v_rcp_f32 v44, v44
  v_rcp_f32 v45, v45
  v_rcp_f32 v46, v46
  v_rcp_f32 v47, v47
  v_rcp_f32 v48, v48
  v_rcp_f32 v49, v49
  v_rcp_f32 v50, v50
  v_rcp_f32 v51, v51
  v_pk_mul_f32 v[176:177], v[176:177], v[44:45]
  v_pk_mul_f32 v[178:179], v[178:179], v[46:47]
  v_pk_mul_f32 v[180:181], v[180:181], v[48:49]
  v_pk_mul_f32 v[182:183], v[182:183], v[50:51]
  v_cvt_pk_bf16_f32 v176, v176, v177
  v_cvt_pk_bf16_f32 v177, v178, v179
  v_cvt_pk_bf16_f32 v178, v180, v181
  v_cvt_pk_bf16_f32 v179, v182, v183
  s_add_u32 s57, s67, 16384
  buffer_store_dwordx4 v[176:179], v1, s[36:39], s57 offen offset:2048 sc1
  v_pk_fma_f32 v[44:45], v[36:37], v[52:53], v[248:249] op_sel:[0,1,0] op_sel_hi:[1,1,1]
  v_pk_fma_f32 v[46:47], v[38:39], v[52:53], v[250:251] op_sel:[0,1,0] op_sel_hi:[1,1,1]
  v_pk_fma_f32 v[48:49], v[40:41], v[52:53], v[252:253] op_sel:[0,1,0] op_sel_hi:[1,1,1]
  v_pk_fma_f32 v[50:51], v[42:43], v[52:53], v[254:255] op_sel:[0,1,0] op_sel_hi:[1,1,1]
  v_pk_fma_f32 v[208:209], v[208:209], v[52:53], v[44:45] op_sel:[0,0,0] op_sel_hi:[1,0,1]
  v_pk_fma_f32 v[210:211], v[210:211], v[52:53], v[46:47] op_sel:[0,0,0] op_sel_hi:[1,0,1]
  v_pk_fma_f32 v[212:213], v[212:213], v[52:53], v[48:49] op_sel:[0,0,0] op_sel_hi:[1,0,1]
  v_pk_fma_f32 v[214:215], v[214:215], v[52:53], v[50:51] op_sel:[0,0,0] op_sel_hi:[1,0,1]
  v_pk_mul_f32 v[44:45], v[208:209], v[208:209]
  v_pk_mul_f32 v[46:47], v[210:211], v[210:211]
  v_pk_mul_f32 v[48:49], v[212:213], v[212:213]
  v_pk_mul_f32 v[50:51], v[214:215], v[214:215]
  v_pk_fma_f32 v[44:45], v[44:45], v[82:83], v[80:81] op_sel:[0,0,0] op_sel_hi:[1,0,0]
  v_pk_fma_f32 v[46:47], v[46:47], v[82:83], v[80:81] op_sel:[0,0,0] op_sel_hi:[1,0,0]
  v_pk_fma_f32 v[48:49], v[48:49], v[82:83], v[80:81] op_sel:[0,0,0] op_sel_hi:[1,0,0]
  v_pk_fma_f32 v[50:51], v[50:51], v[82:83], v[80:81] op_sel:[0,0,0] op_sel_hi:[1,0,0]
  v_pk_mul_f32 v[44:45], v[44:45], v[208:209]
  v_pk_mul_f32 v[46:47], v[46:47], v[210:211]
  v_pk_mul_f32 v[48:49], v[48:49], v[212:213]
  v_pk_mul_f32 v[50:51], v[50:51], v[214:215]
  v_exp_f32 v44, v44
  v_exp_f32 v45, v45
  v_exp_f32 v46, v46
  v_exp_f32 v47, v47
  v_exp_f32 v48, v48
  v_exp_f32 v49, v49
  v_exp_f32 v50, v50
  v_exp_f32 v51, v51
  v_pk_add_f32 v[44:45], v[44:45], 1.0 op_sel_hi:[1,0]
  v_pk_add_f32 v[46:47], v[46:47], 1.0 op_sel_hi:[1,0]
  v_pk_add_f32 v[48:49], v[48:49], 1.0 op_sel_hi:[1,0]
  v_pk_add_f32 v[50:51], v[50:51], 1.0 op_sel_hi:[1,0]
  v_rcp_f32 v44, v44
  v_rcp_f32 v45, v45
  v_rcp_f32 v46, v46
  v_rcp_f32 v47, v47
  v_rcp_f32 v48, v48
  v_rcp_f32 v49, v49
  v_rcp_f32 v50, v50
  v_rcp_f32 v51, v51
  v_pk_mul_f32 v[208:209], v[208:209], v[44:45]
  v_pk_mul_f32 v[210:211], v[210:211], v[46:47]
  v_pk_mul_f32 v[212:213], v[212:213], v[48:49]
  v_pk_mul_f32 v[214:215], v[214:215], v[50:51]
  v_cvt_pk_bf16_f32 v208, v208, v209
  v_cvt_pk_bf16_f32 v209, v210, v211
  v_cvt_pk_bf16_f32 v210, v212, v213
  v_cvt_pk_bf16_f32 v211, v214, v215
  s_add_u32 s57, s67, 24576
  buffer_store_dwordx4 v[208:211], v1, s[36:39], s57 offen offset:2048 sc1
  v_pk_fma_f32 v[44:45], v[12:13], v[54:55], v[224:225] op_sel:[0,1,0] op_sel_hi:[1,1,1]
  v_pk_fma_f32 v[46:47], v[14:15], v[54:55], v[226:227] op_sel:[0,1,0] op_sel_hi:[1,1,1]
  v_pk_fma_f32 v[48:49], v[16:17], v[54:55], v[228:229] op_sel:[0,1,0] op_sel_hi:[1,1,1]
  v_pk_fma_f32 v[50:51], v[18:19], v[54:55], v[230:231] op_sel:[0,1,0] op_sel_hi:[1,1,1]
  v_pk_fma_f32 v[120:121], v[120:121], v[54:55], v[44:45] op_sel:[0,0,0] op_sel_hi:[1,0,1]
  v_pk_fma_f32 v[122:123], v[122:123], v[54:55], v[46:47] op_sel:[0,0,0] op_sel_hi:[1,0,1]
  v_pk_fma_f32 v[124:125], v[124:125], v[54:55], v[48:49] op_sel:[0,0,0] op_sel_hi:[1,0,1]
  v_pk_fma_f32 v[126:127], v[126:127], v[54:55], v[50:51] op_sel:[0,0,0] op_sel_hi:[1,0,1]
  v_pk_mul_f32 v[44:45], v[120:121], v[120:121]
  v_pk_mul_f32 v[46:47], v[122:123], v[122:123]
  v_pk_mul_f32 v[48:49], v[124:125], v[124:125]
  v_pk_mul_f32 v[50:51], v[126:127], v[126:127]
  v_pk_fma_f32 v[44:45], v[44:45], v[82:83], v[80:81] op_sel:[0,0,0] op_sel_hi:[1,0,0]
  v_pk_fma_f32 v[46:47], v[46:47], v[82:83], v[80:81] op_sel:[0,0,0] op_sel_hi:[1,0,0]
  v_pk_fma_f32 v[48:49], v[48:49], v[82:83], v[80:81] op_sel:[0,0,0] op_sel_hi:[1,0,0]
  v_pk_fma_f32 v[50:51], v[50:51], v[82:83], v[80:81] op_sel:[0,0,0] op_sel_hi:[1,0,0]
  v_pk_mul_f32 v[44:45], v[44:45], v[120:121]
  v_pk_mul_f32 v[46:47], v[46:47], v[122:123]
  v_pk_mul_f32 v[48:49], v[48:49], v[124:125]
  v_pk_mul_f32 v[50:51], v[50:51], v[126:127]
  v_exp_f32 v44, v44
  v_exp_f32 v45, v45
  v_exp_f32 v46, v46
  v_exp_f32 v47, v47
  v_exp_f32 v48, v48
  v_exp_f32 v49, v49
  v_exp_f32 v50, v50
  v_exp_f32 v51, v51
  v_pk_add_f32 v[44:45], v[44:45], 1.0 op_sel_hi:[1,0]
  v_pk_add_f32 v[46:47], v[46:47], 1.0 op_sel_hi:[1,0]
  v_pk_add_f32 v[48:49], v[48:49], 1.0 op_sel_hi:[1,0]
  v_pk_add_f32 v[50:51], v[50:51], 1.0 op_sel_hi:[1,0]
  v_rcp_f32 v44, v44
  v_rcp_f32 v45, v45
  v_rcp_f32 v46, v46
  v_rcp_f32 v47, v47
  v_rcp_f32 v48, v48
  v_rcp_f32 v49, v49
  v_rcp_f32 v50, v50
  v_rcp_f32 v51, v51
  v_pk_mul_f32 v[120:121], v[120:121], v[44:45]
  v_pk_mul_f32 v[122:123], v[122:123], v[46:47]
  v_pk_mul_f32 v[124:125], v[124:125], v[48:49]
  v_pk_mul_f32 v[126:127], v[126:127], v[50:51]
  v_cvt_pk_bf16_f32 v120, v120, v121
  v_cvt_pk_bf16_f32 v121, v122, v123
  v_cvt_pk_bf16_f32 v122, v124, v125
  v_cvt_pk_bf16_f32 v123, v126, v127
  s_add_u32 s57, s67, 0
  buffer_store_dwordx4 v[120:123], v1, s[36:39], s57 offen offset:3072 sc1
  v_pk_fma_f32 v[44:45], v[20:21], v[54:55], v[232:233] op_sel:[0,1,0] op_sel_hi:[1,1,1]
  v_pk_fma_f32 v[46:47], v[22:23], v[54:55], v[234:235] op_sel:[0,1,0] op_sel_hi:[1,1,1]
  v_pk_fma_f32 v[48:49], v[24:25], v[54:55], v[236:237] op_sel:[0,1,0] op_sel_hi:[1,1,1]
  v_pk_fma_f32 v[50:51], v[26:27], v[54:55], v[238:239] op_sel:[0,1,0] op_sel_hi:[1,1,1]
  v_pk_fma_f32 v[152:153], v[152:153], v[54:55], v[44:45] op_sel:[0,0,0] op_sel_hi:[1,0,1]
  v_pk_fma_f32 v[154:155], v[154:155], v[54:55], v[46:47] op_sel:[0,0,0] op_sel_hi:[1,0,1]
  v_pk_fma_f32 v[156:157], v[156:157], v[54:55], v[48:49] op_sel:[0,0,0] op_sel_hi:[1,0,1]
  v_pk_fma_f32 v[158:159], v[158:159], v[54:55], v[50:51] op_sel:[0,0,0] op_sel_hi:[1,0,1]
  v_pk_mul_f32 v[44:45], v[152:153], v[152:153]
  v_pk_mul_f32 v[46:47], v[154:155], v[154:155]
  v_pk_mul_f32 v[48:49], v[156:157], v[156:157]
  v_pk_mul_f32 v[50:51], v[158:159], v[158:159]
  v_pk_fma_f32 v[44:45], v[44:45], v[82:83], v[80:81] op_sel:[0,0,0] op_sel_hi:[1,0,0]
  v_pk_fma_f32 v[46:47], v[46:47], v[82:83], v[80:81] op_sel:[0,0,0] op_sel_hi:[1,0,0]
  v_pk_fma_f32 v[48:49], v[48:49], v[82:83], v[80:81] op_sel:[0,0,0] op_sel_hi:[1,0,0]
  v_pk_fma_f32 v[50:51], v[50:51], v[82:83], v[80:81] op_sel:[0,0,0] op_sel_hi:[1,0,0]
  v_pk_mul_f32 v[44:45], v[44:45], v[152:153]
  v_pk_mul_f32 v[46:47], v[46:47], v[154:155]
  v_pk_mul_f32 v[48:49], v[48:49], v[156:157]
  v_pk_mul_f32 v[50:51], v[50:51], v[158:159]
  v_exp_f32 v44, v44
  v_exp_f32 v45, v45
  v_exp_f32 v46, v46
  v_exp_f32 v47, v47
  v_exp_f32 v48, v48
  v_exp_f32 v49, v49
  v_exp_f32 v50, v50
  v_exp_f32 v51, v51
  v_pk_add_f32 v[44:45], v[44:45], 1.0 op_sel_hi:[1,0]
  v_pk_add_f32 v[46:47], v[46:47], 1.0 op_sel_hi:[1,0]
  v_pk_add_f32 v[48:49], v[48:49], 1.0 op_sel_hi:[1,0]
  v_pk_add_f32 v[50:51], v[50:51], 1.0 op_sel_hi:[1,0]
  v_rcp_f32 v44, v44
  v_rcp_f32 v45, v45
  v_rcp_f32 v46, v46
  v_rcp_f32 v47, v47
  v_rcp_f32 v48, v48
  v_rcp_f32 v49, v49
  v_rcp_f32 v50, v50
  v_rcp_f32 v51, v51
  v_pk_mul_f32 v[152:153], v[152:153], v[44:45]
  v_pk_mul_f32 v[154:155], v[154:155], v[46:47]
  v_pk_mul_f32 v[156:157], v[156:157], v[48:49]
  v_pk_mul_f32 v[158:159], v[158:159], v[50:51]
  v_cvt_pk_bf16_f32 v152, v152, v153
  v_cvt_pk_bf16_f32 v153, v154, v155
  v_cvt_pk_bf16_f32 v154, v156, v157
  v_cvt_pk_bf16_f32 v155, v158, v159
  s_add_u32 s57, s67, 8192
  buffer_store_dwordx4 v[152:155], v1, s[36:39], s57 offen offset:3072 sc1
  v_pk_fma_f32 v[44:45], v[28:29], v[54:55], v[240:241] op_sel:[0,1,0] op_sel_hi:[1,1,1]
  v_pk_fma_f32 v[46:47], v[30:31], v[54:55], v[242:243] op_sel:[0,1,0] op_sel_hi:[1,1,1]
  v_pk_fma_f32 v[48:49], v[32:33], v[54:55], v[244:245] op_sel:[0,1,0] op_sel_hi:[1,1,1]
  v_pk_fma_f32 v[50:51], v[34:35], v[54:55], v[246:247] op_sel:[0,1,0] op_sel_hi:[1,1,1]
  v_pk_fma_f32 v[184:185], v[184:185], v[54:55], v[44:45] op_sel:[0,0,0] op_sel_hi:[1,0,1]
  v_pk_fma_f32 v[186:187], v[186:187], v[54:55], v[46:47] op_sel:[0,0,0] op_sel_hi:[1,0,1]
  v_pk_fma_f32 v[188:189], v[188:189], v[54:55], v[48:49] op_sel:[0,0,0] op_sel_hi:[1,0,1]
  v_pk_fma_f32 v[190:191], v[190:191], v[54:55], v[50:51] op_sel:[0,0,0] op_sel_hi:[1,0,1]
  v_pk_mul_f32 v[44:45], v[184:185], v[184:185]
  v_pk_mul_f32 v[46:47], v[186:187], v[186:187]
  v_pk_mul_f32 v[48:49], v[188:189], v[188:189]
  v_pk_mul_f32 v[50:51], v[190:191], v[190:191]
  v_pk_fma_f32 v[44:45], v[44:45], v[82:83], v[80:81] op_sel:[0,0,0] op_sel_hi:[1,0,0]
  v_pk_fma_f32 v[46:47], v[46:47], v[82:83], v[80:81] op_sel:[0,0,0] op_sel_hi:[1,0,0]
  v_pk_fma_f32 v[48:49], v[48:49], v[82:83], v[80:81] op_sel:[0,0,0] op_sel_hi:[1,0,0]
  v_pk_fma_f32 v[50:51], v[50:51], v[82:83], v[80:81] op_sel:[0,0,0] op_sel_hi:[1,0,0]
  v_pk_mul_f32 v[44:45], v[44:45], v[184:185]
  v_pk_mul_f32 v[46:47], v[46:47], v[186:187]
  v_pk_mul_f32 v[48:49], v[48:49], v[188:189]
  v_pk_mul_f32 v[50:51], v[50:51], v[190:191]
  v_exp_f32 v44, v44
  v_exp_f32 v45, v45
  v_exp_f32 v46, v46
  v_exp_f32 v47, v47
  v_exp_f32 v48, v48
  v_exp_f32 v49, v49
  v_exp_f32 v50, v50
  v_exp_f32 v51, v51
  v_pk_add_f32 v[44:45], v[44:45], 1.0 op_sel_hi:[1,0]
  v_pk_add_f32 v[46:47], v[46:47], 1.0 op_sel_hi:[1,0]
  v_pk_add_f32 v[48:49], v[48:49], 1.0 op_sel_hi:[1,0]
  v_pk_add_f32 v[50:51], v[50:51], 1.0 op_sel_hi:[1,0]
  v_rcp_f32 v44, v44
  v_rcp_f32 v45, v45
  v_rcp_f32 v46, v46
  v_rcp_f32 v47, v47
  v_rcp_f32 v48, v48
  v_rcp_f32 v49, v49
  v_rcp_f32 v50, v50
  v_rcp_f32 v51, v51
  v_pk_mul_f32 v[184:185], v[184:185], v[44:45]
  v_pk_mul_f32 v[186:187], v[186:187], v[46:47]
  v_pk_mul_f32 v[188:189], v[188:189], v[48:49]
  v_pk_mul_f32 v[190:191], v[190:191], v[50:51]
  v_cvt_pk_bf16_f32 v184, v184, v185
  v_cvt_pk_bf16_f32 v185, v186, v187
  v_cvt_pk_bf16_f32 v186, v188, v189
  v_cvt_pk_bf16_f32 v187, v190, v191
  s_add_u32 s57, s67, 16384
  buffer_store_dwordx4 v[184:187], v1, s[36:39], s57 offen offset:3072 sc1
  v_pk_fma_f32 v[44:45], v[36:37], v[54:55], v[248:249] op_sel:[0,1,0] op_sel_hi:[1,1,1]
  v_pk_fma_f32 v[46:47], v[38:39], v[54:55], v[250:251] op_sel:[0,1,0] op_sel_hi:[1,1,1]
  v_pk_fma_f32 v[48:49], v[40:41], v[54:55], v[252:253] op_sel:[0,1,0] op_sel_hi:[1,1,1]
  v_pk_fma_f32 v[50:51], v[42:43], v[54:55], v[254:255] op_sel:[0,1,0] op_sel_hi:[1,1,1]
  v_pk_fma_f32 v[216:217], v[216:217], v[54:55], v[44:45] op_sel:[0,0,0] op_sel_hi:[1,0,1]
  v_pk_fma_f32 v[218:219], v[218:219], v[54:55], v[46:47] op_sel:[0,0,0] op_sel_hi:[1,0,1]
  v_pk_fma_f32 v[220:221], v[220:221], v[54:55], v[48:49] op_sel:[0,0,0] op_sel_hi:[1,0,1]
  v_pk_fma_f32 v[222:223], v[222:223], v[54:55], v[50:51] op_sel:[0,0,0] op_sel_hi:[1,0,1]
  v_pk_mul_f32 v[44:45], v[216:217], v[216:217]
  v_pk_mul_f32 v[46:47], v[218:219], v[218:219]
  v_pk_mul_f32 v[48:49], v[220:221], v[220:221]
  v_pk_mul_f32 v[50:51], v[222:223], v[222:223]
  v_pk_fma_f32 v[44:45], v[44:45], v[82:83], v[80:81] op_sel:[0,0,0] op_sel_hi:[1,0,0]
  v_pk_fma_f32 v[46:47], v[46:47], v[82:83], v[80:81] op_sel:[0,0,0] op_sel_hi:[1,0,0]
  v_pk_fma_f32 v[48:49], v[48:49], v[82:83], v[80:81] op_sel:[0,0,0] op_sel_hi:[1,0,0]
  v_pk_fma_f32 v[50:51], v[50:51], v[82:83], v[80:81] op_sel:[0,0,0] op_sel_hi:[1,0,0]
  v_pk_mul_f32 v[44:45], v[44:45], v[216:217]
  v_pk_mul_f32 v[46:47], v[46:47], v[218:219]
  v_pk_mul_f32 v[48:49], v[48:49], v[220:221]
  v_pk_mul_f32 v[50:51], v[50:51], v[222:223]
  v_exp_f32 v44, v44
  v_exp_f32 v45, v45
  v_exp_f32 v46, v46
  v_exp_f32 v47, v47
  v_exp_f32 v48, v48
  v_exp_f32 v49, v49
  v_exp_f32 v50, v50
  v_exp_f32 v51, v51
  v_pk_add_f32 v[44:45], v[44:45], 1.0 op_sel_hi:[1,0]
  v_pk_add_f32 v[46:47], v[46:47], 1.0 op_sel_hi:[1,0]
  v_pk_add_f32 v[48:49], v[48:49], 1.0 op_sel_hi:[1,0]
  v_pk_add_f32 v[50:51], v[50:51], 1.0 op_sel_hi:[1,0]
  v_rcp_f32 v44, v44
  v_rcp_f32 v45, v45
  v_rcp_f32 v46, v46
  v_rcp_f32 v47, v47
  v_rcp_f32 v48, v48
  v_rcp_f32 v49, v49
  v_rcp_f32 v50, v50
  v_rcp_f32 v51, v51
  v_pk_mul_f32 v[216:217], v[216:217], v[44:45]
  v_pk_mul_f32 v[218:219], v[218:219], v[46:47]
  v_pk_mul_f32 v[220:221], v[220:221], v[48:49]
  v_pk_mul_f32 v[222:223], v[222:223], v[50:51]
  v_cvt_pk_bf16_f32 v216, v216, v217
  v_cvt_pk_bf16_f32 v217, v218, v219
  v_cvt_pk_bf16_f32 v218, v220, v221
  v_cvt_pk_bf16_f32 v219, v222, v223
  s_add_u32 s57, s67, 24576
  buffer_store_dwordx4 v[216:219], v1, s[36:39], s57 offen offset:3072 sc1
  s_mul_i32 s60, s68, 1024
  s_lshr_b32 s57, s49, 2
  s_lshl_b32 s57, s57, 1
  s_and_b32 s58, s55, 1
  s_add_u32 s57, s57, s58
  s_add_u32 s60, s60, s57
  s_and_b32 s57, s49, 3
  s_lshl_b32 s57, s57, 8
  s_add_u32 s60, s60, s57
  s_add_u32 s60, s60, 23625728
  v_mov_b32 v2, 1
  v_lshlrev_b32 v3, 24, v0
  s_waitcnt vmcnt(0)
  buffer_store_byte v2, v3, s[36:39], s60 offen sc1
  s_branch parallel_sum__grouped_kv_mqa__mixer_channel_mlp__prompt_kernel_g2
parallel_sum__grouped_kv_mqa__mixer_channel_mlp__prompt_kernel_cl:
  v_and_b32 v48, 31, v0
  v_lshrrev_b32 v49, 5, v0
  v_bfe_u32 v50, v0, 1, 3
  v_xor_b32 v50, v50, v49
  v_lshlrev_b32 v50, 4, v50
  v_lshl_add_u32 v50, v48, 7, v50
  s_mul_i32 s57, s55, 24576
  v_xor_b32 v2, 0, v50
  v_add_u32 v2, s57, v2
  v_xor_b32 v3, 32, v50
  v_add_u32 v3, s57, v3
  v_xor_b32 v4, 64, v50
  v_add_u32 v4, s57, v4
  v_xor_b32 v5, 96, v50
  v_add_u32 v5, s57, v5
  v_bfe_u32 v48, v0, 4, 1
  v_and_b32 v50, 3, v0
  v_lshlrev_b32 v48, 5, v48
  v_lshl_add_u32 v48, v50, 3, v48
  v_bfe_u32 v50, v0, 2, 2
  v_lshl_add_u32 v49, v49, 3, v50
  v_bfe_u32 v51, v0, 3, 1
  v_lshlrev_b32 v51, 6, v51
  v_xor_b32 v51, v51, v48
  v_lshl_add_u32 v51, v49, 7, v51
  v_add_u32 v6, 98304, v51
  v_xor_b32 v7, 64, v6
  v_lshl_add_u32 v51, v49, 6, v48
  v_add_u32 v8, 98304, v51
  s_cmp_eq_u32 s56, 2
  s_cbranch_scc1 parallel_sum__grouped_kv_mqa__mixer_channel_mlp__prompt_kernel_ckv
  v_mov_b32 v84, 0
  v_mov_b32 v85, 0
  v_mov_b32 v86, 0
  v_mov_b32 v87, 0
  v_mov_b32 v88, 0
  v_mov_b32 v89, 0
  v_mov_b32 v90, 0
  v_mov_b32 v91, 0
  v_mov_b32 v92, 0x3f803f80
  s_barrier
  ds_read_b128 v[32:35], v2 offset:0
  ds_read_b128 v[36:39], v2 offset:4096
  ds_read_b64_tr_b16 v[12:13], v8 offset:0
  ds_read_b64_tr_b16 v[14:15], v8 offset:256
  ds_read_b64_tr_b16 v[28:29], v8 offset:16384
  ds_read_b64_tr_b16 v[30:31], v8 offset:16640
  s_waitcnt lgkmcnt(0)
  s_mov_b32 s63, 5
  .p2align 6
parallel_sum__grouped_kv_mqa__mixer_channel_mlp__prompt_kernel_k_loop:
  s_waitcnt lgkmcnt(0)
  v_mfma_f32_32x32x16_bf16 v[96:111], v[12:15], v[32:35], v[96:111]
  ds_read_b128 v[40:43], v3 offset:0
  ds_read_b128 v[44:47], v3 offset:4096
  ds_read_b64_tr_b16 v[12:13], v8 offset:1024
  v_mfma_f32_32x32x16_bf16 v[224:239], v[28:31], v[32:35], v[224:239]
  ds_read_b64_tr_b16 v[14:15], v8 offset:1280
  v_mfma_f32_32x32x16_bf16 v[240:255], v[28:31], v[36:39], v[240:255]
  ds_read_b64_tr_b16 v[28:29], v8 offset:17408
  ds_read_b64_tr_b16 v[30:31], v8 offset:17664
  v_dot2c_f32_bf16 v84, v32, v92
  v_dot2c_f32_bf16 v86, v32, v32
  v_dot2c_f32_bf16 v85, v33, v92
  v_dot2c_f32_bf16 v87, v33, v33
  v_dot2c_f32_bf16 v84, v34, v92
  v_dot2c_f32_bf16 v86, v34, v34
  v_dot2c_f32_bf16 v85, v35, v92
  v_dot2c_f32_bf16 v87, v35, v35
  s_waitcnt lgkmcnt(0)
  v_mfma_f32_32x32x16_bf16 v[96:111], v[12:15], v[40:43], v[96:111]
  ds_read_b128 v[32:35], v4 offset:0
  ds_read_b128 v[36:39], v4 offset:4096
  ds_read_b64_tr_b16 v[12:13], v8 offset:2048
  v_mfma_f32_32x32x16_bf16 v[224:239], v[28:31], v[40:43], v[224:239]
  ds_read_b64_tr_b16 v[14:15], v8 offset:2304
  v_mfma_f32_32x32x16_bf16 v[240:255], v[28:31], v[44:47], v[240:255]
  ds_read_b64_tr_b16 v[28:29], v8 offset:18432
  ds_read_b64_tr_b16 v[30:31], v8 offset:18688
  v_dot2c_f32_bf16 v84, v40, v92
  v_dot2c_f32_bf16 v86, v40, v40
  v_dot2c_f32_bf16 v85, v41, v92
  v_dot2c_f32_bf16 v87, v41, v41
  v_dot2c_f32_bf16 v84, v42, v92
  v_dot2c_f32_bf16 v86, v42, v42
  v_dot2c_f32_bf16 v85, v43, v92
  v_dot2c_f32_bf16 v87, v43, v43
  s_waitcnt lgkmcnt(0)
  v_mfma_f32_32x32x16_bf16 v[96:111], v[12:15], v[32:35], v[96:111]
  ds_read_b128 v[40:43], v5 offset:0
  ds_read_b128 v[44:47], v5 offset:4096
  ds_read_b64_tr_b16 v[12:13], v8 offset:3072
  v_mfma_f32_32x32x16_bf16 v[224:239], v[28:31], v[32:35], v[224:239]
  ds_read_b64_tr_b16 v[14:15], v8 offset:3328
  v_mfma_f32_32x32x16_bf16 v[240:255], v[28:31], v[36:39], v[240:255]
  ds_read_b64_tr_b16 v[28:29], v8 offset:19456
  ds_read_b64_tr_b16 v[30:31], v8 offset:19712
  v_dot2c_f32_bf16 v84, v32, v92
  v_dot2c_f32_bf16 v86, v32, v32
  v_dot2c_f32_bf16 v85, v33, v92
  v_dot2c_f32_bf16 v87, v33, v33
  v_dot2c_f32_bf16 v84, v34, v92
  v_dot2c_f32_bf16 v86, v34, v34
  v_dot2c_f32_bf16 v85, v35, v92
  v_dot2c_f32_bf16 v87, v35, v35
  s_waitcnt lgkmcnt(0)
  v_mfma_f32_32x32x16_bf16 v[96:111], v[12:15], v[40:43], v[96:111]
  v_mfma_f32_32x32x16_bf16 v[224:239], v[28:31], v[40:43], v[224:239]
  s_waitcnt lgkmcnt(0)
  s_barrier
  ds_read_b128 v[32:35], v2 offset:8192
  ds_read_b128 v[36:39], v2 offset:12288
  ds_read_b64_tr_b16 v[12:13], v8 offset:20480
  v_mfma_f32_32x32x16_bf16 v[240:255], v[28:31], v[44:47], v[240:255]
  ds_read_b64_tr_b16 v[14:15], v8 offset:20736
  ds_read_b64_tr_b16 v[28:29], v8 offset:36864
  ds_read_b64_tr_b16 v[30:31], v8 offset:37120
  v_dot2c_f32_bf16 v84, v40, v92
  v_dot2c_f32_bf16 v86, v40, v40
  v_dot2c_f32_bf16 v85, v41, v92
  v_dot2c_f32_bf16 v87, v41, v41
  v_dot2c_f32_bf16 v84, v42, v92
  v_dot2c_f32_bf16 v86, v42, v42
  v_dot2c_f32_bf16 v85, v43, v92
  v_dot2c_f32_bf16 v87, v43, v43
  s_waitcnt lgkmcnt(0)
  v_mfma_f32_32x32x16_bf16 v[96:111], v[12:15], v[32:35], v[96:111]
  ds_read_b128 v[40:43], v3 offset:8192
  ds_read_b128 v[44:47], v3 offset:12288
  ds_read_b64_tr_b16 v[12:13], v8 offset:21504
  v_mfma_f32_32x32x16_bf16 v[224:239], v[28:31], v[32:35], v[224:239]
  ds_read_b64_tr_b16 v[14:15], v8 offset:21760
  v_mfma_f32_32x32x16_bf16 v[240:255], v[28:31], v[36:39], v[240:255]
  ds_read_b64_tr_b16 v[28:29], v8 offset:37888
  ds_read_b64_tr_b16 v[30:31], v8 offset:38144
  v_dot2c_f32_bf16 v84, v32, v92
  v_dot2c_f32_bf16 v86, v32, v32
  v_dot2c_f32_bf16 v85, v33, v92
  v_dot2c_f32_bf16 v87, v33, v33
  v_dot2c_f32_bf16 v84, v34, v92
  v_dot2c_f32_bf16 v86, v34, v34
  v_dot2c_f32_bf16 v85, v35, v92
  v_dot2c_f32_bf16 v87, v35, v35
  s_waitcnt lgkmcnt(0)
  v_mfma_f32_32x32x16_bf16 v[96:111], v[12:15], v[40:43], v[96:111]
  ds_read_b128 v[32:35], v4 offset:8192
  ds_read_b128 v[36:39], v4 offset:12288
  ds_read_b64_tr_b16 v[12:13], v8 offset:22528
  v_mfma_f32_32x32x16_bf16 v[224:239], v[28:31], v[40:43], v[224:239]
  ds_read_b64_tr_b16 v[14:15], v8 offset:22784
  v_mfma_f32_32x32x16_bf16 v[240:255], v[28:31], v[44:47], v[240:255]
  ds_read_b64_tr_b16 v[28:29], v8 offset:38912
  ds_read_b64_tr_b16 v[30:31], v8 offset:39168
  v_dot2c_f32_bf16 v84, v40, v92
  v_dot2c_f32_bf16 v86, v40, v40
  v_dot2c_f32_bf16 v85, v41, v92
  v_dot2c_f32_bf16 v87, v41, v41
  v_dot2c_f32_bf16 v84, v42, v92
  v_dot2c_f32_bf16 v86, v42, v42
  v_dot2c_f32_bf16 v85, v43, v92
  v_dot2c_f32_bf16 v87, v43, v43
  s_waitcnt lgkmcnt(0)
  v_mfma_f32_32x32x16_bf16 v[96:111], v[12:15], v[32:35], v[96:111]
  ds_read_b128 v[40:43], v5 offset:8192
  ds_read_b128 v[44:47], v5 offset:12288
  ds_read_b64_tr_b16 v[12:13], v8 offset:23552
  v_mfma_f32_32x32x16_bf16 v[224:239], v[28:31], v[32:35], v[224:239]
  ds_read_b64_tr_b16 v[14:15], v8 offset:23808
  v_mfma_f32_32x32x16_bf16 v[240:255], v[28:31], v[36:39], v[240:255]
  ds_read_b64_tr_b16 v[28:29], v8 offset:39936
  ds_read_b64_tr_b16 v[30:31], v8 offset:40192
  v_dot2c_f32_bf16 v84, v32, v92
  v_dot2c_f32_bf16 v86, v32, v32
  v_dot2c_f32_bf16 v85, v33, v92
  v_dot2c_f32_bf16 v87, v33, v33
  v_dot2c_f32_bf16 v84, v34, v92
  v_dot2c_f32_bf16 v86, v34, v34
  v_dot2c_f32_bf16 v85, v35, v92
  v_dot2c_f32_bf16 v87, v35, v35
  s_waitcnt lgkmcnt(0)
  v_mfma_f32_32x32x16_bf16 v[96:111], v[12:15], v[40:43], v[96:111]
  v_mfma_f32_32x32x16_bf16 v[224:239], v[28:31], v[40:43], v[224:239]
  s_waitcnt lgkmcnt(0)
  s_barrier
  ds_read_b128 v[32:35], v2 offset:16384
  ds_read_b128 v[36:39], v2 offset:20480
  ds_read_b64_tr_b16 v[12:13], v8 offset:40960
  v_mfma_f32_32x32x16_bf16 v[240:255], v[28:31], v[44:47], v[240:255]
  ds_read_b64_tr_b16 v[14:15], v8 offset:41216
  ds_read_b64_tr_b16 v[28:29], v8 offset:57344
  ds_read_b64_tr_b16 v[30:31], v8 offset:57600
  v_dot2c_f32_bf16 v84, v40, v92
  v_dot2c_f32_bf16 v86, v40, v40
  v_dot2c_f32_bf16 v85, v41, v92
  v_dot2c_f32_bf16 v87, v41, v41
  v_dot2c_f32_bf16 v84, v42, v92
  v_dot2c_f32_bf16 v86, v42, v42
  v_dot2c_f32_bf16 v85, v43, v92
  v_dot2c_f32_bf16 v87, v43, v43
  s_waitcnt lgkmcnt(0)
  v_mfma_f32_32x32x16_bf16 v[96:111], v[12:15], v[32:35], v[96:111]
  ds_read_b128 v[40:43], v3 offset:16384
  ds_read_b128 v[44:47], v3 offset:20480
  ds_read_b64_tr_b16 v[12:13], v8 offset:41984
  v_mfma_f32_32x32x16_bf16 v[224:239], v[28:31], v[32:35], v[224:239]
  ds_read_b64_tr_b16 v[14:15], v8 offset:42240
  v_mfma_f32_32x32x16_bf16 v[240:255], v[28:31], v[36:39], v[240:255]
  ds_read_b64_tr_b16 v[28:29], v8 offset:58368
  ds_read_b64_tr_b16 v[30:31], v8 offset:58624
  v_dot2c_f32_bf16 v84, v32, v92
  v_dot2c_f32_bf16 v86, v32, v32
  v_dot2c_f32_bf16 v85, v33, v92
  v_dot2c_f32_bf16 v87, v33, v33
  v_dot2c_f32_bf16 v84, v34, v92
  v_dot2c_f32_bf16 v86, v34, v34
  v_dot2c_f32_bf16 v85, v35, v92
  v_dot2c_f32_bf16 v87, v35, v35
  s_waitcnt lgkmcnt(0)
  v_mfma_f32_32x32x16_bf16 v[96:111], v[12:15], v[40:43], v[96:111]
  ds_read_b128 v[32:35], v4 offset:16384
  ds_read_b128 v[36:39], v4 offset:20480
  ds_read_b64_tr_b16 v[12:13], v8 offset:43008
  v_mfma_f32_32x32x16_bf16 v[224:239], v[28:31], v[40:43], v[224:239]
  ds_read_b64_tr_b16 v[14:15], v8 offset:43264
  v_mfma_f32_32x32x16_bf16 v[240:255], v[28:31], v[44:47], v[240:255]
  ds_read_b64_tr_b16 v[28:29], v8 offset:59392
  ds_read_b64_tr_b16 v[30:31], v8 offset:59648
  v_dot2c_f32_bf16 v84, v40, v92
  v_dot2c_f32_bf16 v86, v40, v40
  v_dot2c_f32_bf16 v85, v41, v92
  v_dot2c_f32_bf16 v87, v41, v41
  v_dot2c_f32_bf16 v84, v42, v92
  v_dot2c_f32_bf16 v86, v42, v42
  v_dot2c_f32_bf16 v85, v43, v92
  v_dot2c_f32_bf16 v87, v43, v43
  s_waitcnt lgkmcnt(0)
  v_mfma_f32_32x32x16_bf16 v[96:111], v[12:15], v[32:35], v[96:111]
  ds_read_b128 v[40:43], v5 offset:16384
  ds_read_b128 v[44:47], v5 offset:20480
  ds_read_b64_tr_b16 v[12:13], v8 offset:44032
  v_mfma_f32_32x32x16_bf16 v[224:239], v[28:31], v[32:35], v[224:239]
  ds_read_b64_tr_b16 v[14:15], v8 offset:44288
  v_mfma_f32_32x32x16_bf16 v[240:255], v[28:31], v[36:39], v[240:255]
  ds_read_b64_tr_b16 v[28:29], v8 offset:60416
  ds_read_b64_tr_b16 v[30:31], v8 offset:60672
  v_dot2c_f32_bf16 v84, v32, v92
  v_dot2c_f32_bf16 v86, v32, v32
  v_dot2c_f32_bf16 v85, v33, v92
  v_dot2c_f32_bf16 v87, v33, v33
  v_dot2c_f32_bf16 v84, v34, v92
  v_dot2c_f32_bf16 v86, v34, v34
  v_dot2c_f32_bf16 v85, v35, v92
  v_dot2c_f32_bf16 v87, v35, v35
  s_waitcnt lgkmcnt(0)
  v_mfma_f32_32x32x16_bf16 v[96:111], v[12:15], v[40:43], v[96:111]
  v_mfma_f32_32x32x16_bf16 v[224:239], v[28:31], v[40:43], v[224:239]
  s_waitcnt lgkmcnt(0)
  s_barrier
  ds_read_b128 v[32:35], v2 offset:0
  ds_read_b128 v[36:39], v2 offset:4096
  ds_read_b64_tr_b16 v[12:13], v8 offset:0
  v_mfma_f32_32x32x16_bf16 v[240:255], v[28:31], v[44:47], v[240:255]
  ds_read_b64_tr_b16 v[14:15], v8 offset:256
  ds_read_b64_tr_b16 v[28:29], v8 offset:16384
  ds_read_b64_tr_b16 v[30:31], v8 offset:16640
  v_dot2c_f32_bf16 v84, v40, v92
  v_dot2c_f32_bf16 v86, v40, v40
  v_dot2c_f32_bf16 v85, v41, v92
  v_dot2c_f32_bf16 v87, v41, v41
  v_dot2c_f32_bf16 v84, v42, v92
  v_dot2c_f32_bf16 v86, v42, v42
  v_dot2c_f32_bf16 v85, v43, v92
  v_dot2c_f32_bf16 v87, v43, v43
  s_sub_u32 s63, s63, 1
  s_cmp_lg_u32 s63, 0
  s_cbranch_scc1 parallel_sum__grouped_kv_mqa__mixer_channel_mlp__prompt_kernel_k_loop
  s_waitcnt lgkmcnt(0)
  v_mfma_f32_32x32x16_bf16 v[96:111], v[12:15], v[32:35], v[96:111]
  ds_read_b128 v[40:43], v3 offset:0
  ds_read_b128 v[44:47], v3 offset:4096
  ds_read_b64_tr_b16 v[12:13], v8 offset:1024
  v_mfma_f32_32x32x16_bf16 v[224:239], v[28:31], v[32:35], v[224:239]
  ds_read_b64_tr_b16 v[14:15], v8 offset:1280
  v_mfma_f32_32x32x16_bf16 v[240:255], v[28:31], v[36:39], v[240:255]
  ds_read_b64_tr_b16 v[28:29], v8 offset:17408
  ds_read_b64_tr_b16 v[30:31], v8 offset:17664
  v_dot2c_f32_bf16 v84, v32, v92
  v_dot2c_f32_bf16 v86, v32, v32
  v_dot2c_f32_bf16 v85, v33, v92
  v_dot2c_f32_bf16 v87, v33, v33
  v_dot2c_f32_bf16 v84, v34, v92
  v_dot2c_f32_bf16 v86, v34, v34
  v_dot2c_f32_bf16 v85, v35, v92
  v_dot2c_f32_bf16 v87, v35, v35
  s_waitcnt lgkmcnt(0)
  v_mfma_f32_32x32x16_bf16 v[96:111], v[12:15], v[40:43], v[96:111]
  ds_read_b128 v[32:35], v4 offset:0
  ds_read_b128 v[36:39], v4 offset:4096
  ds_read_b64_tr_b16 v[12:13], v8 offset:2048
  v_mfma_f32_32x32x16_bf16 v[224:239], v[28:31], v[40:43], v[224:239]
  ds_read_b64_tr_b16 v[14:15], v8 offset:2304
  v_mfma_f32_32x32x16_bf16 v[240:255], v[28:31], v[44:47], v[240:255]
  ds_read_b64_tr_b16 v[28:29], v8 offset:18432
  ds_read_b64_tr_b16 v[30:31], v8 offset:18688
  v_dot2c_f32_bf16 v84, v40, v92
  v_dot2c_f32_bf16 v86, v40, v40
  v_dot2c_f32_bf16 v85, v41, v92
  v_dot2c_f32_bf16 v87, v41, v41
  v_dot2c_f32_bf16 v84, v42, v92
  v_dot2c_f32_bf16 v86, v42, v42
  v_dot2c_f32_bf16 v85, v43, v92
  v_dot2c_f32_bf16 v87, v43, v43
  s_waitcnt lgkmcnt(0)
  v_mfma_f32_32x32x16_bf16 v[96:111], v[12:15], v[32:35], v[96:111]
  ds_read_b128 v[40:43], v5 offset:0
  ds_read_b128 v[44:47], v5 offset:4096
  ds_read_b64_tr_b16 v[12:13], v8 offset:3072
  v_mfma_f32_32x32x16_bf16 v[224:239], v[28:31], v[32:35], v[224:239]
  ds_read_b64_tr_b16 v[14:15], v8 offset:3328
  v_mfma_f32_32x32x16_bf16 v[240:255], v[28:31], v[36:39], v[240:255]
  ds_read_b64_tr_b16 v[28:29], v8 offset:19456
  ds_read_b64_tr_b16 v[30:31], v8 offset:19712
  v_dot2c_f32_bf16 v84, v32, v92
  v_dot2c_f32_bf16 v86, v32, v32
  v_dot2c_f32_bf16 v85, v33, v92
  v_dot2c_f32_bf16 v87, v33, v33
  v_dot2c_f32_bf16 v84, v34, v92
  v_dot2c_f32_bf16 v86, v34, v34
  v_dot2c_f32_bf16 v85, v35, v92
  v_dot2c_f32_bf16 v87, v35, v35
  s_waitcnt lgkmcnt(0)
  v_mfma_f32_32x32x16_bf16 v[96:111], v[12:15], v[40:43], v[96:111]
  v_mfma_f32_32x32x16_bf16 v[224:239], v[28:31], v[40:43], v[224:239]
  v_mfma_f32_32x32x16_bf16 v[240:255], v[28:31], v[44:47], v[240:255]
  v_dot2c_f32_bf16 v84, v40, v92
  v_dot2c_f32_bf16 v86, v40, v40
  v_dot2c_f32_bf16 v85, v41, v92
  v_dot2c_f32_bf16 v87, v41, v41
  v_dot2c_f32_bf16 v84, v42, v92
  v_dot2c_f32_bf16 v86, v42, v42
  v_dot2c_f32_bf16 v85, v43, v92
  v_dot2c_f32_bf16 v87, v43, v43
  s_nop 2
  v_add_f32 v84, v84, v85
  v_add_f32 v86, v86, v87
  v_mov_b32 v85, v84
  v_mov_b32 v87, v86
  s_nop 1
  v_permlane32_swap_b32 v84, v85
  v_permlane32_swap_b32 v86, v87
  s_nop 1
  v_add_f32 v84, v84, v85
  v_add_f32 v86, v86, v87
  v_mul_f32 v84, 0x3a800000, v84
  v_mul_f32 v86, 0x3a800000, v86
  v_fma_f32 v86, -v84, v84, v86
  v_max_f32 v86, 0, v86
  v_mov_b32 v50, v84
  v_cvt_pk_bf16_f32 v50, v50, v50
  v_and_b32 v50, 0xffff0000, v50
  v_mov_b32 v85, v86
  v_cvt_pk_bf16_f32 v85, v85, v85
  v_and_b32 v85, 0xffff0000, v85
  v_add_f32 v85, 0x3727c5ac, v85
  v_cvt_pk_bf16_f32 v85, v85, v85
  v_and_b32 v85, 0xffff0000, v85
  v_sqrt_f32 v85, v85
  s_nop 0
  v_cvt_pk_bf16_f32 v85, v85, v85
  v_and_b32 v85, 0xffff0000, v85
  v_rcp_f32 v48, v85
  s_nop 0
  v_mul_f32 v87, v48, v48
  v_mul_f32 v87, v87, v86
  v_cvt_pk_bf16_f32 v87, v87, v87
  v_and_b32 v87, 0xffff0000, v87
  v_add_f32 v87, 0x3727c5ac, v87
  v_cvt_pk_bf16_f32 v87, v87, v87
  v_and_b32 v87, 0xffff0000, v87
  v_sqrt_f32 v87, v87
  s_nop 0
  v_cvt_pk_bf16_f32 v87, v87, v87
  v_and_b32 v87, 0xffff0000, v87
  v_rcp_f32 v87, v87
  s_nop 0
  v_mul_f32 v52, v48, v87
  v_mul_f32 v50, -v50, v48
  v_mul_f32 v54, -v84, v52
  s_lshl_b32 s57, s48, 8
  s_lshl_b32 s58, s55, 6
  s_add_u32 s57, s57, s58
  s_lshl_b32 s57, s57, 4
  s_add_u32 s57, s57, 23330816
  v_and_b32 v9, 31, v0
  v_lshlrev_b32 v9, 4, v9
  s_mov_b32 s64, s57
  s_lshl_b32 s61, s50, 9
  v_add_u32 v9, s61, v9
  v_mul_f32 v60, 0x3e8293ee, v48
  v_mul_f32 v61, 0x3e8293ee, v50
  v_mov_b32 v62, v52
  v_mov_b32 v63, v54
  buffer_store_dwordx4 v[60:63], v9, s[36:39], s57 offen sc1
  s_and_b32 s57, s55, 1
  s_lshl_b32 s57, s57, 12
  v_and_b32 v64, 15, v0
  v_lshlrev_b32 v64, 4, v64
  v_bfe_u32 v65, v0, 4, 1
  v_lshl_add_u32 v64, v65, 10, v64
  v_lshrrev_b32 v65, 5, v0
  v_lshl_add_u32 v64, v65, 8, v64
  v_add_u32 v64, s57, v64
  v_lshlrev_b32 v65, 4, v0
  s_lshr_b32 s57, s55, 1
  s_lshl_b32 s58, s48, 1
  s_add_u32 s68, s57, s58
  s_mul_i32 s67, s68, 1179648
  s_lshl_b32 s58, s51, 13
  s_add_u32 s67, s67, s58
  s_add_u32 s67, s67, 262144
  v_lshrrev_b32 v66, 5, v0
  v_lshlrev_b32 v66, 4, v66
  v_add_u32 v66, 159744, v66
  s_barrier
  s_setprio 3
  ds_read_b128 v[128:131], v66 offset:0
  ds_read_b128 v[132:135], v66 offset:32
  ds_read_b128 v[136:139], v66 offset:64
  ds_read_b128 v[140:143], v66 offset:96
  ds_read_b128 v[144:147], v66 offset:128
  ds_read_b128 v[148:151], v66 offset:160
  ds_read_b128 v[152:155], v66 offset:192
  ds_read_b128 v[156:159], v66 offset:224
  ds_read_b128 v[160:163], v66 offset:256
  ds_read_b128 v[164:167], v66 offset:288
  ds_read_b128 v[168:171], v66 offset:320
  ds_read_b128 v[172:175], v66 offset:352
  s_waitcnt lgkmcnt(4)
  ds_read_b128 v[176:179], v66 offset:384
  ds_read_b128 v[180:183], v66 offset:416
  ds_read_b128 v[184:187], v66 offset:448
  ds_read_b128 v[188:191], v66 offset:480
  v_pk_mul_f32 v[96:97], v[96:97], v[48:49] op_sel:[0,0] op_sel_hi:[1,0]
  v_pk_mul_f32 v[98:99], v[98:99], v[48:49] op_sel:[0,0] op_sel_hi:[1,0]
  v_pk_mul_f32 v[100:101], v[100:101], v[48:49] op_sel:[0,0] op_sel_hi:[1,0]
  v_pk_mul_f32 v[102:103], v[102:103], v[48:49] op_sel:[0,0] op_sel_hi:[1,0]
  v_pk_mul_f32 v[104:105], v[104:105], v[48:49] op_sel:[0,0] op_sel_hi:[1,0]
  v_pk_mul_f32 v[106:107], v[106:107], v[48:49] op_sel:[0,0] op_sel_hi:[1,0]
  v_pk_mul_f32 v[108:109], v[108:109], v[48:49] op_sel:[0,0] op_sel_hi:[1,0]
  v_pk_mul_f32 v[110:111], v[110:111], v[48:49] op_sel:[0,0] op_sel_hi:[1,0]
  v_pk_add_f32 v[128:129], v[128:129], v[144:145]
  v_pk_add_f32 v[130:131], v[130:131], v[146:147]
  v_pk_add_f32 v[132:133], v[132:133], v[148:149]
  v_pk_add_f32 v[134:135], v[134:135], v[150:151]
  v_pk_add_f32 v[136:137], v[136:137], v[152:153]
  v_pk_add_f32 v[138:139], v[138:139], v[154:155]
  v_pk_add_f32 v[140:141], v[140:141], v[156:157]
  v_pk_add_f32 v[142:143], v[142:143], v[158:159]
  s_waitcnt lgkmcnt(0)
  v_pk_add_f32 v[160:161], v[160:161], v[176:177]
  v_pk_add_f32 v[162:163], v[162:163], v[178:179]
  v_pk_add_f32 v[164:165], v[164:165], v[180:181]
  v_pk_add_f32 v[166:167], v[166:167], v[182:183]
  v_pk_add_f32 v[168:169], v[168:169], v[184:185]
  v_pk_add_f32 v[170:171], v[170:171], v[186:187]
  v_pk_add_f32 v[172:173], v[172:173], v[188:189]
  v_pk_add_f32 v[174:175], v[174:175], v[190:191]
  v_pk_add_f32 v[128:129], v[128:129], v[160:161]
  v_pk_add_f32 v[130:131], v[130:131], v[162:163]
  v_pk_add_f32 v[132:133], v[132:133], v[164:165]
  v_pk_add_f32 v[134:135], v[134:135], v[166:167]
  v_pk_add_f32 v[136:137], v[136:137], v[168:169]
  v_pk_add_f32 v[138:139], v[138:139], v[170:171]
  v_pk_add_f32 v[140:141], v[140:141], v[172:173]
  v_pk_add_f32 v[142:143], v[142:143], v[174:175]
  v_pk_fma_f32 v[96:97], v[128:129], v[50:51], v[96:97] op_sel:[0,0,0] op_sel_hi:[1,0,1]
  v_pk_fma_f32 v[98:99], v[130:131], v[50:51], v[98:99] op_sel:[0,0,0] op_sel_hi:[1,0,1]
  v_pk_fma_f32 v[100:101], v[132:133], v[50:51], v[100:101] op_sel:[0,0,0] op_sel_hi:[1,0,1]
  v_pk_fma_f32 v[102:103], v[134:135], v[50:51], v[102:103] op_sel:[0,0,0] op_sel_hi:[1,0,1]
  v_pk_fma_f32 v[104:105], v[136:137], v[50:51], v[104:105] op_sel:[0,0,0] op_sel_hi:[1,0,1]
  v_pk_fma_f32 v[106:107], v[138:139], v[50:51], v[106:107] op_sel:[0,0,0] op_sel_hi:[1,0,1]
  v_pk_fma_f32 v[108:109], v[140:141], v[50:51], v[108:109] op_sel:[0,0,0] op_sel_hi:[1,0,1]
  v_pk_fma_f32 v[110:111], v[142:143], v[50:51], v[110:111] op_sel:[0,0,0] op_sel_hi:[1,0,1]
  s_lshl_b32 s57, s48, 3
  s_lshl_b32 s58, s55, 1
  s_add_u32 s57, s57, s58
  s_add_u32 s57, s57, s50
  s_lshl_b32 s57, s57, 12
  s_add_u32 s57, s57, 23068672
  v_cvt_pk_bf16_f32 v96, v96, v97
  v_cvt_pk_bf16_f32 v97, v98, v99
  v_cvt_pk_bf16_f32 v98, v100, v101
  v_cvt_pk_bf16_f32 v99, v102, v103
  v_cvt_pk_bf16_f32 v100, v104, v105
  v_cvt_pk_bf16_f32 v101, v106, v107
  v_cvt_pk_bf16_f32 v102, v108, v109
  v_cvt_pk_bf16_f32 v103, v110, v111
  buffer_store_dwordx4 v[96:99], v65, s[36:39], s57 offen offset:0 sc1
  buffer_store_dwordx4 v[100:103], v65, s[36:39], s57 offen offset:1024 sc1
  v_mov_b32 v4, 161812
  v_mov_b32 v2, 1
  v_lshlrev_b32 v3, 8, v0
  s_sub_u32 s58, s2, 224
  s_lshl_b32 s58, s58, 2
  s_mov_b64 exec, 1
  s_waitcnt vmcnt(0)
  ds_add_rtn_u32 v5, v4, v2
  s_waitcnt lgkmcnt(0)
  v_readfirstlane_b32 s57, v5
  s_mov_b64 exec, -1
  s_cmp_eq_u32 s57, 3
  s_cbranch_scc0 parallel_sum__grouped_kv_mqa__mixer_channel_mlp__prompt_kernel_k_nosig
  buffer_store_dword v2, v3, s[44:47], s58 offen sc1
  s_waitcnt vmcnt(0)
  ds_write_b32 v4, v2 offset:12
parallel_sum__grouped_kv_mqa__mixer_channel_mlp__prompt_kernel_k_nosig:
  s_mov_b32 s59, 0
parallel_sum__grouped_kv_mqa__mixer_channel_mlp__prompt_kernel_k_wp:
  ds_read_b32 v5, v4 offset:12
  s_add_u32 s59, s59, 1
  s_cmp_gt_u32 s59, 0x400000
  s_cbranch_scc1 parallel_sum__grouped_kv_mqa__mixer_channel_mlp__prompt_kernel_k_wp_ok
  s_waitcnt lgkmcnt(0)
  v_cmp_eq_u32 vcc, 0, v5
  s_nop 1
  s_cbranch_vccz parallel_sum__grouped_kv_mqa__mixer_channel_mlp__prompt_kernel_k_wp_ok
  s_sleep 2
  s_branch parallel_sum__grouped_kv_mqa__mixer_channel_mlp__prompt_kernel_k_wp
parallel_sum__grouped_kv_mqa__mixer_channel_mlp__prompt_kernel_k_wp_ok:
  s_lshl_b32 s57, s48, 2
  s_add_u32 s57, s57, s49
  s_sub_u32 s57, s57, 28
  s_lshl_b32 s57, s57, 2
  s_add_u32 s57, s57, s55
  s_mul_i32 s58, s57, 57344
  v_lshlrev_b32 v4, 7, v0
  v_add_u32 v5, s58, v4
  s_lshl_b32 s58, s57, 14
  v_add_u32 v5, s58, v4
  global_load_dword v6, v5, s[4:5]
  v_add_u32 v5, 8192, v5
  global_load_dword v6, v5, s[4:5]
  v_mov_b32 v4, 161796
  s_mov_b32 s59, 0
parallel_sum__grouped_kv_mqa__mixer_channel_mlp__prompt_kernel_k_wf:
  s_sleep 4
  ds_read_b32 v5, v4
  s_add_u32 s59, s59, 1
  s_cmp_gt_u32 s59, 0x400000
  s_cbranch_scc1 parallel_sum__grouped_kv_mqa__mixer_channel_mlp__prompt_kernel_k_wf_ok
  s_waitcnt lgkmcnt(0)
  v_cmp_eq_u32 vcc, 0, v5
  s_nop 1
  s_cbranch_vccnz parallel_sum__grouped_kv_mqa__mixer_channel_mlp__prompt_kernel_k_wf
parallel_sum__grouped_kv_mqa__mixer_channel_mlp__prompt_kernel_k_wf_ok:
  v_xor_b32 v9, 0x200, v9
  buffer_load_dword v57, v9, s[36:39], s64 offen sc1
  buffer_load_dword v59, v9, s[36:39], s64 offen offset:4 sc1
  ds_read_b128 v[12:15], v66 offset:512
  ds_read_b128 v[16:19], v66 offset:544
  ds_read_b128 v[20:23], v66 offset:576
  ds_read_b128 v[24:27], v66 offset:608
  ds_read_b128 v[28:31], v66 offset:640
  ds_read_b128 v[32:35], v66 offset:672
  ds_read_b128 v[36:39], v66 offset:704
  ds_read_b128 v[40:43], v66 offset:736
  ds_read_b128 v[68:71], v66 offset:768
  ds_read_b128 v[72:75], v66 offset:800
  ds_read_b128 v[76:79], v66 offset:832
  ds_read_b128 v[80:83], v66 offset:864
  s_lshl_b32 s57, s55, 12
  s_add_u32 s57, s57, 49152
  s_lshl_b32 s58, s50, 11
  s_add_u32 s57, s57, s58
  v_add_u32 v8, s57, v65
  v_xor_b32 v10, 0x800, v8
  s_waitcnt vmcnt(0) lgkmcnt(4)
  v_mul_f32 v49, 0x3e8293ee, v48
  v_mul_f32 v51, 0x3e8293ee, v50
  v_pk_add_f32 v[12:13], v[12:13], v[28:29]
  v_pk_add_f32 v[14:15], v[14:15], v[30:31]
  v_pk_add_f32 v[16:17], v[16:17], v[32:33]
  v_pk_add_f32 v[18:19], v[18:19], v[34:35]
  v_pk_add_f32 v[20:21], v[20:21], v[36:37]
  v_pk_add_f32 v[22:23], v[22:23], v[38:39]
  v_pk_add_f32 v[24:25], v[24:25], v[40:41]
  v_pk_add_f32 v[26:27], v[26:27], v[42:43]
  ds_read_b128 v[28:31], v66 offset:896
  ds_read_b128 v[32:35], v66 offset:928
  ds_read_b128 v[36:39], v66 offset:960
  ds_read_b128 v[40:43], v66 offset:992
  s_waitcnt lgkmcnt(4)
  v_pk_add_f32 v[12:13], v[12:13], v[68:69]
  v_pk_add_f32 v[14:15], v[14:15], v[70:71]
  v_pk_add_f32 v[16:17], v[16:17], v[72:73]
  v_pk_add_f32 v[18:19], v[18:19], v[74:75]
  v_pk_add_f32 v[20:21], v[20:21], v[76:77]
  v_pk_add_f32 v[22:23], v[22:23], v[78:79]
  v_pk_add_f32 v[24:25], v[24:25], v[80:81]
  v_pk_add_f32 v[26:27], v[26:27], v[82:83]
  v_pk_mul_f32 v[224:225], v[224:225], v[48:49] op_sel:[0,1] op_sel_hi:[1,1]
  v_pk_mul_f32 v[226:227], v[226:227], v[48:49] op_sel:[0,1] op_sel_hi:[1,1]
  v_pk_mul_f32 v[228:229], v[228:229], v[48:49] op_sel:[0,1] op_sel_hi:[1,1]
  v_pk_mul_f32 v[230:231], v[230:231], v[48:49] op_sel:[0,1] op_sel_hi:[1,1]
  v_pk_mul_f32 v[232:233], v[232:233], v[48:49] op_sel:[0,1] op_sel_hi:[1,1]
  v_pk_mul_f32 v[234:235], v[234:235], v[48:49] op_sel:[0,1] op_sel_hi:[1,1]
  v_pk_mul_f32 v[236:237], v[236:237], v[48:49] op_sel:[0,1] op_sel_hi:[1,1]
  v_pk_mul_f32 v[238:239], v[238:239], v[48:49] op_sel:[0,1] op_sel_hi:[1,1]
  v_pk_mul_f32 v[240:241], v[240:241], v[56:57] op_sel:[0,1] op_sel_hi:[1,1]
  v_pk_mul_f32 v[242:243], v[242:243], v[56:57] op_sel:[0,1] op_sel_hi:[1,1]
  v_pk_mul_f32 v[244:245], v[244:245], v[56:57] op_sel:[0,1] op_sel_hi:[1,1]
  v_pk_mul_f32 v[246:247], v[246:247], v[56:57] op_sel:[0,1] op_sel_hi:[1,1]
  v_pk_mul_f32 v[248:249], v[248:249], v[56:57] op_sel:[0,1] op_sel_hi:[1,1]
  v_pk_mul_f32 v[250:251], v[250:251], v[56:57] op_sel:[0,1] op_sel_hi:[1,1]
  v_pk_mul_f32 v[252:253], v[252:253], v[56:57] op_sel:[0,1] op_sel_hi:[1,1]
  v_pk_mul_f32 v[254:255], v[254:255], v[56:57] op_sel:[0,1] op_sel_hi:[1,1]
  s_waitcnt lgkmcnt(0)
  v_pk_add_f32 v[12:13], v[12:13], v[28:29]
  v_pk_add_f32 v[14:15], v[14:15], v[30:31]
  v_pk_add_f32 v[16:17], v[16:17], v[32:33]
  v_pk_add_f32 v[18:19], v[18:19], v[34:35]
  v_pk_add_f32 v[20:21], v[20:21], v[36:37]
  v_pk_add_f32 v[22:23], v[22:23], v[38:39]
  v_pk_add_f32 v[24:25], v[24:25], v[40:41]
  v_pk_add_f32 v[26:27], v[26:27], v[42:43]
  ds_read_b128 v[68:71], v66 offset:0
  ds_read_b128 v[72:75], v66 offset:32
  ds_read_b128 v[76:79], v66 offset:64
  ds_read_b128 v[80:83], v66 offset:96
  v_pk_fma_f32 v[224:225], v[12:13], v[50:51], v[224:225] op_sel:[0,1,0] op_sel_hi:[1,1,1]
  v_pk_fma_f32 v[226:227], v[14:15], v[50:51], v[226:227] op_sel:[0,1,0] op_sel_hi:[1,1,1]
  v_pk_fma_f32 v[228:229], v[16:17], v[50:51], v[228:229] op_sel:[0,1,0] op_sel_hi:[1,1,1]
  v_pk_fma_f32 v[230:231], v[18:19], v[50:51], v[230:231] op_sel:[0,1,0] op_sel_hi:[1,1,1]
  v_pk_fma_f32 v[232:233], v[20:21], v[50:51], v[232:233] op_sel:[0,1,0] op_sel_hi:[1,1,1]
  v_pk_fma_f32 v[234:235], v[22:23], v[50:51], v[234:235] op_sel:[0,1,0] op_sel_hi:[1,1,1]
  v_pk_fma_f32 v[236:237], v[24:25], v[50:51], v[236:237] op_sel:[0,1,0] op_sel_hi:[1,1,1]
  v_pk_fma_f32 v[238:239], v[26:27], v[50:51], v[238:239] op_sel:[0,1,0] op_sel_hi:[1,1,1]
  v_cvt_pk_bf16_f32 v84, v224, v225
  v_cvt_pk_bf16_f32 v85, v226, v227
  v_cvt_pk_bf16_f32 v86, v228, v229
  v_cvt_pk_bf16_f32 v87, v230, v231
  v_cvt_pk_bf16_f32 v88, v232, v233
  v_cvt_pk_bf16_f32 v89, v234, v235
  v_cvt_pk_bf16_f32 v90, v236, v237
  v_cvt_pk_bf16_f32 v91, v238, v239
  ds_write_b128 v8, v[84:87] offset:0
  ds_write_b128 v8, v[88:91] offset:1024
  v_pk_fma_f32 v[240:241], v[12:13], v[58:59], v[240:241] op_sel:[0,1,0] op_sel_hi:[1,1,1]
  v_pk_fma_f32 v[242:243], v[14:15], v[58:59], v[242:243] op_sel:[0,1,0] op_sel_hi:[1,1,1]
  v_pk_fma_f32 v[244:245], v[16:17], v[58:59], v[244:245] op_sel:[0,1,0] op_sel_hi:[1,1,1]
  v_pk_fma_f32 v[246:247], v[18:19], v[58:59], v[246:247] op_sel:[0,1,0] op_sel_hi:[1,1,1]
  v_pk_fma_f32 v[248:249], v[20:21], v[58:59], v[248:249] op_sel:[0,1,0] op_sel_hi:[1,1,1]
  v_pk_fma_f32 v[250:251], v[22:23], v[58:59], v[250:251] op_sel:[0,1,0] op_sel_hi:[1,1,1]
  v_pk_fma_f32 v[252:253], v[24:25], v[58:59], v[252:253] op_sel:[0,1,0] op_sel_hi:[1,1,1]
  v_pk_fma_f32 v[254:255], v[26:27], v[58:59], v[254:255] op_sel:[0,1,0] op_sel_hi:[1,1,1]
  v_cvt_pk_bf16_f32 v84, v240, v241
  v_cvt_pk_bf16_f32 v85, v242, v243
  v_cvt_pk_bf16_f32 v86, v244, v245
  v_cvt_pk_bf16_f32 v87, v246, v247
  v_cvt_pk_bf16_f32 v88, v248, v249
  v_cvt_pk_bf16_f32 v89, v250, v251
  v_cvt_pk_bf16_f32 v90, v252, v253
  v_cvt_pk_bf16_f32 v91, v254, v255
  ds_write_b128 v10, v[84:87] offset:0
  ds_write_b128 v10, v[88:91] offset:1024
  s_lshl_b32 s57, s55, 7
  s_add_u32 s57, s57, 161808
  v_mov_b32 v2, s57
  v_mov_b32 v3, 1
  ds_write_b32 v2, v3
  s_branch parallel_sum__grouped_kv_mqa__mixer_channel_mlp__prompt_kernel_g2
parallel_sum__grouped_kv_mqa__mixer_channel_mlp__prompt_kernel_ckv:
  v_mov_b32 v84, 0
  v_mov_b32 v85, 0
  v_mov_b32 v86, 0
  v_mov_b32 v87, 0
  v_mov_b32 v88, 0
  v_mov_b32 v89, 0
  v_mov_b32 v90, 0
  v_mov_b32 v91, 0
  v_mov_b32 v92, 0x3f803f80
  s_barrier
  ds_read_b128 v[32:35], v2 offset:0
  ds_read_b128 v[36:39], v2 offset:4096
  ds_read_b64_tr_b16 v[12:13], v8 offset:0
  ds_read_b64_tr_b16 v[14:15], v8 offset:256
  ds_read_b64_tr_b16 v[28:29], v8 offset:16384
  ds_read_b64_tr_b16 v[30:31], v8 offset:16640
  s_waitcnt lgkmcnt(0)
  s_mov_b32 s63, 5
  .p2align 6
parallel_sum__grouped_kv_mqa__mixer_channel_mlp__prompt_kernel_v_loop:
  s_waitcnt lgkmcnt(0)
  v_mfma_f32_32x32x16_bf16 v[96:111], v[32:35], v[12:15], v[96:111]
  ds_read_b128 v[40:43], v3 offset:0
  ds_read_b128 v[44:47], v3 offset:4096
  ds_read_b64_tr_b16 v[12:13], v8 offset:1024
  v_mfma_f32_32x32x16_bf16 v[224:239], v[28:31], v[32:35], v[224:239]
  ds_read_b64_tr_b16 v[14:15], v8 offset:1280
  v_mfma_f32_32x32x16_bf16 v[240:255], v[28:31], v[36:39], v[240:255]
  ds_read_b64_tr_b16 v[28:29], v8 offset:17408
  ds_read_b64_tr_b16 v[30:31], v8 offset:17664
  v_dot2c_f32_bf16 v84, v32, v92
  v_dot2c_f32_bf16 v86, v32, v32
  v_dot2c_f32_bf16 v85, v33, v92
  v_dot2c_f32_bf16 v87, v33, v33
  v_dot2c_f32_bf16 v84, v34, v92
  v_dot2c_f32_bf16 v86, v34, v34
  v_dot2c_f32_bf16 v85, v35, v92
  v_dot2c_f32_bf16 v87, v35, v35
  s_waitcnt lgkmcnt(0)
  v_mfma_f32_32x32x16_bf16 v[96:111], v[40:43], v[12:15], v[96:111]
  ds_read_b128 v[32:35], v4 offset:0
  ds_read_b128 v[36:39], v4 offset:4096
  ds_read_b64_tr_b16 v[12:13], v8 offset:2048
  v_mfma_f32_32x32x16_bf16 v[224:239], v[28:31], v[40:43], v[224:239]
  ds_read_b64_tr_b16 v[14:15], v8 offset:2304
  v_mfma_f32_32x32x16_bf16 v[240:255], v[28:31], v[44:47], v[240:255]
  ds_read_b64_tr_b16 v[28:29], v8 offset:18432
  ds_read_b64_tr_b16 v[30:31], v8 offset:18688
  v_dot2c_f32_bf16 v84, v40, v92
  v_dot2c_f32_bf16 v86, v40, v40
  v_dot2c_f32_bf16 v85, v41, v92
  v_dot2c_f32_bf16 v87, v41, v41
  v_dot2c_f32_bf16 v84, v42, v92
  v_dot2c_f32_bf16 v86, v42, v42
  v_dot2c_f32_bf16 v85, v43, v92
  v_dot2c_f32_bf16 v87, v43, v43
  s_waitcnt lgkmcnt(0)
  v_mfma_f32_32x32x16_bf16 v[96:111], v[32:35], v[12:15], v[96:111]
  ds_read_b128 v[40:43], v5 offset:0
  ds_read_b128 v[44:47], v5 offset:4096
  ds_read_b64_tr_b16 v[12:13], v8 offset:3072
  v_mfma_f32_32x32x16_bf16 v[224:239], v[28:31], v[32:35], v[224:239]
  ds_read_b64_tr_b16 v[14:15], v8 offset:3328
  v_mfma_f32_32x32x16_bf16 v[240:255], v[28:31], v[36:39], v[240:255]
  ds_read_b64_tr_b16 v[28:29], v8 offset:19456
  ds_read_b64_tr_b16 v[30:31], v8 offset:19712
  v_dot2c_f32_bf16 v84, v32, v92
  v_dot2c_f32_bf16 v86, v32, v32
  v_dot2c_f32_bf16 v85, v33, v92
  v_dot2c_f32_bf16 v87, v33, v33
  v_dot2c_f32_bf16 v84, v34, v92
  v_dot2c_f32_bf16 v86, v34, v34
  v_dot2c_f32_bf16 v85, v35, v92
  v_dot2c_f32_bf16 v87, v35, v35
  s_waitcnt lgkmcnt(0)
  v_mfma_f32_32x32x16_bf16 v[96:111], v[40:43], v[12:15], v[96:111]
  v_mfma_f32_32x32x16_bf16 v[224:239], v[28:31], v[40:43], v[224:239]
  s_waitcnt lgkmcnt(0)
  s_barrier
  ds_read_b128 v[32:35], v2 offset:8192
  ds_read_b128 v[36:39], v2 offset:12288
  ds_read_b64_tr_b16 v[12:13], v8 offset:20480
  v_mfma_f32_32x32x16_bf16 v[240:255], v[28:31], v[44:47], v[240:255]
  ds_read_b64_tr_b16 v[14:15], v8 offset:20736
  ds_read_b64_tr_b16 v[28:29], v8 offset:36864
  ds_read_b64_tr_b16 v[30:31], v8 offset:37120
  v_dot2c_f32_bf16 v84, v40, v92
  v_dot2c_f32_bf16 v86, v40, v40
  v_dot2c_f32_bf16 v85, v41, v92
  v_dot2c_f32_bf16 v87, v41, v41
  v_dot2c_f32_bf16 v84, v42, v92
  v_dot2c_f32_bf16 v86, v42, v42
  v_dot2c_f32_bf16 v85, v43, v92
  v_dot2c_f32_bf16 v87, v43, v43
  s_waitcnt lgkmcnt(0)
  v_mfma_f32_32x32x16_bf16 v[96:111], v[32:35], v[12:15], v[96:111]
  ds_read_b128 v[40:43], v3 offset:8192
  ds_read_b128 v[44:47], v3 offset:12288
  ds_read_b64_tr_b16 v[12:13], v8 offset:21504
  v_mfma_f32_32x32x16_bf16 v[224:239], v[28:31], v[32:35], v[224:239]
  ds_read_b64_tr_b16 v[14:15], v8 offset:21760
  v_mfma_f32_32x32x16_bf16 v[240:255], v[28:31], v[36:39], v[240:255]
  ds_read_b64_tr_b16 v[28:29], v8 offset:37888
  ds_read_b64_tr_b16 v[30:31], v8 offset:38144
  v_dot2c_f32_bf16 v84, v32, v92
  v_dot2c_f32_bf16 v86, v32, v32
  v_dot2c_f32_bf16 v85, v33, v92
  v_dot2c_f32_bf16 v87, v33, v33
  v_dot2c_f32_bf16 v84, v34, v92
  v_dot2c_f32_bf16 v86, v34, v34
  v_dot2c_f32_bf16 v85, v35, v92
  v_dot2c_f32_bf16 v87, v35, v35
  s_waitcnt lgkmcnt(0)
  v_mfma_f32_32x32x16_bf16 v[96:111], v[40:43], v[12:15], v[96:111]
  ds_read_b128 v[32:35], v4 offset:8192
  ds_read_b128 v[36:39], v4 offset:12288
  ds_read_b64_tr_b16 v[12:13], v8 offset:22528
  v_mfma_f32_32x32x16_bf16 v[224:239], v[28:31], v[40:43], v[224:239]
  ds_read_b64_tr_b16 v[14:15], v8 offset:22784
  v_mfma_f32_32x32x16_bf16 v[240:255], v[28:31], v[44:47], v[240:255]
  ds_read_b64_tr_b16 v[28:29], v8 offset:38912
  ds_read_b64_tr_b16 v[30:31], v8 offset:39168
  v_dot2c_f32_bf16 v84, v40, v92
  v_dot2c_f32_bf16 v86, v40, v40
  v_dot2c_f32_bf16 v85, v41, v92
  v_dot2c_f32_bf16 v87, v41, v41
  v_dot2c_f32_bf16 v84, v42, v92
  v_dot2c_f32_bf16 v86, v42, v42
  v_dot2c_f32_bf16 v85, v43, v92
  v_dot2c_f32_bf16 v87, v43, v43
  s_waitcnt lgkmcnt(0)
  v_mfma_f32_32x32x16_bf16 v[96:111], v[32:35], v[12:15], v[96:111]
  ds_read_b128 v[40:43], v5 offset:8192
  ds_read_b128 v[44:47], v5 offset:12288
  ds_read_b64_tr_b16 v[12:13], v8 offset:23552
  v_mfma_f32_32x32x16_bf16 v[224:239], v[28:31], v[32:35], v[224:239]
  ds_read_b64_tr_b16 v[14:15], v8 offset:23808
  v_mfma_f32_32x32x16_bf16 v[240:255], v[28:31], v[36:39], v[240:255]
  ds_read_b64_tr_b16 v[28:29], v8 offset:39936
  ds_read_b64_tr_b16 v[30:31], v8 offset:40192
  v_dot2c_f32_bf16 v84, v32, v92
  v_dot2c_f32_bf16 v86, v32, v32
  v_dot2c_f32_bf16 v85, v33, v92
  v_dot2c_f32_bf16 v87, v33, v33
  v_dot2c_f32_bf16 v84, v34, v92
  v_dot2c_f32_bf16 v86, v34, v34
  v_dot2c_f32_bf16 v85, v35, v92
  v_dot2c_f32_bf16 v87, v35, v35
  s_waitcnt lgkmcnt(0)
  v_mfma_f32_32x32x16_bf16 v[96:111], v[40:43], v[12:15], v[96:111]
  v_mfma_f32_32x32x16_bf16 v[224:239], v[28:31], v[40:43], v[224:239]
  s_waitcnt lgkmcnt(0)
  s_barrier
  ds_read_b128 v[32:35], v2 offset:16384
  ds_read_b128 v[36:39], v2 offset:20480
  ds_read_b64_tr_b16 v[12:13], v8 offset:40960
  v_mfma_f32_32x32x16_bf16 v[240:255], v[28:31], v[44:47], v[240:255]
  ds_read_b64_tr_b16 v[14:15], v8 offset:41216
  ds_read_b64_tr_b16 v[28:29], v8 offset:57344
  ds_read_b64_tr_b16 v[30:31], v8 offset:57600
  v_dot2c_f32_bf16 v84, v40, v92
  v_dot2c_f32_bf16 v86, v40, v40
  v_dot2c_f32_bf16 v85, v41, v92
  v_dot2c_f32_bf16 v87, v41, v41
  v_dot2c_f32_bf16 v84, v42, v92
  v_dot2c_f32_bf16 v86, v42, v42
  v_dot2c_f32_bf16 v85, v43, v92
  v_dot2c_f32_bf16 v87, v43, v43
  s_waitcnt lgkmcnt(0)
  v_mfma_f32_32x32x16_bf16 v[96:111], v[32:35], v[12:15], v[96:111]
  ds_read_b128 v[40:43], v3 offset:16384
  ds_read_b128 v[44:47], v3 offset:20480
  ds_read_b64_tr_b16 v[12:13], v8 offset:41984
  v_mfma_f32_32x32x16_bf16 v[224:239], v[28:31], v[32:35], v[224:239]
  ds_read_b64_tr_b16 v[14:15], v8 offset:42240
  v_mfma_f32_32x32x16_bf16 v[240:255], v[28:31], v[36:39], v[240:255]
  ds_read_b64_tr_b16 v[28:29], v8 offset:58368
  ds_read_b64_tr_b16 v[30:31], v8 offset:58624
  v_dot2c_f32_bf16 v84, v32, v92
  v_dot2c_f32_bf16 v86, v32, v32
  v_dot2c_f32_bf16 v85, v33, v92
  v_dot2c_f32_bf16 v87, v33, v33
  v_dot2c_f32_bf16 v84, v34, v92
  v_dot2c_f32_bf16 v86, v34, v34
  v_dot2c_f32_bf16 v85, v35, v92
  v_dot2c_f32_bf16 v87, v35, v35
  s_waitcnt lgkmcnt(0)
  v_mfma_f32_32x32x16_bf16 v[96:111], v[40:43], v[12:15], v[96:111]
  ds_read_b128 v[32:35], v4 offset:16384
  ds_read_b128 v[36:39], v4 offset:20480
  ds_read_b64_tr_b16 v[12:13], v8 offset:43008
  v_mfma_f32_32x32x16_bf16 v[224:239], v[28:31], v[40:43], v[224:239]
  ds_read_b64_tr_b16 v[14:15], v8 offset:43264
  v_mfma_f32_32x32x16_bf16 v[240:255], v[28:31], v[44:47], v[240:255]
  ds_read_b64_tr_b16 v[28:29], v8 offset:59392
  ds_read_b64_tr_b16 v[30:31], v8 offset:59648
  v_dot2c_f32_bf16 v84, v40, v92
  v_dot2c_f32_bf16 v86, v40, v40
  v_dot2c_f32_bf16 v85, v41, v92
  v_dot2c_f32_bf16 v87, v41, v41
  v_dot2c_f32_bf16 v84, v42, v92
  v_dot2c_f32_bf16 v86, v42, v42
  v_dot2c_f32_bf16 v85, v43, v92
  v_dot2c_f32_bf16 v87, v43, v43
  s_waitcnt lgkmcnt(0)
  v_mfma_f32_32x32x16_bf16 v[96:111], v[32:35], v[12:15], v[96:111]
  ds_read_b128 v[40:43], v5 offset:16384
  ds_read_b128 v[44:47], v5 offset:20480
  ds_read_b64_tr_b16 v[12:13], v8 offset:44032
  v_mfma_f32_32x32x16_bf16 v[224:239], v[28:31], v[32:35], v[224:239]
  ds_read_b64_tr_b16 v[14:15], v8 offset:44288
  v_mfma_f32_32x32x16_bf16 v[240:255], v[28:31], v[36:39], v[240:255]
  ds_read_b64_tr_b16 v[28:29], v8 offset:60416
  ds_read_b64_tr_b16 v[30:31], v8 offset:60672
  v_dot2c_f32_bf16 v84, v32, v92
  v_dot2c_f32_bf16 v86, v32, v32
  v_dot2c_f32_bf16 v85, v33, v92
  v_dot2c_f32_bf16 v87, v33, v33
  v_dot2c_f32_bf16 v84, v34, v92
  v_dot2c_f32_bf16 v86, v34, v34
  v_dot2c_f32_bf16 v85, v35, v92
  v_dot2c_f32_bf16 v87, v35, v35
  s_waitcnt lgkmcnt(0)
  v_mfma_f32_32x32x16_bf16 v[96:111], v[40:43], v[12:15], v[96:111]
  v_mfma_f32_32x32x16_bf16 v[224:239], v[28:31], v[40:43], v[224:239]
  s_waitcnt lgkmcnt(0)
  s_barrier
  ds_read_b128 v[32:35], v2 offset:0
  ds_read_b128 v[36:39], v2 offset:4096
  ds_read_b64_tr_b16 v[12:13], v8 offset:0
  v_mfma_f32_32x32x16_bf16 v[240:255], v[28:31], v[44:47], v[240:255]
  ds_read_b64_tr_b16 v[14:15], v8 offset:256
  ds_read_b64_tr_b16 v[28:29], v8 offset:16384
  ds_read_b64_tr_b16 v[30:31], v8 offset:16640
  v_dot2c_f32_bf16 v84, v40, v92
  v_dot2c_f32_bf16 v86, v40, v40
  v_dot2c_f32_bf16 v85, v41, v92
  v_dot2c_f32_bf16 v87, v41, v41
  v_dot2c_f32_bf16 v84, v42, v92
  v_dot2c_f32_bf16 v86, v42, v42
  v_dot2c_f32_bf16 v85, v43, v92
  v_dot2c_f32_bf16 v87, v43, v43
  s_sub_u32 s63, s63, 1
  s_cmp_lg_u32 s63, 0
  s_cbranch_scc1 parallel_sum__grouped_kv_mqa__mixer_channel_mlp__prompt_kernel_v_loop
  s_waitcnt lgkmcnt(0)
  v_mfma_f32_32x32x16_bf16 v[96:111], v[32:35], v[12:15], v[96:111]
  ds_read_b128 v[40:43], v3 offset:0
  ds_read_b128 v[44:47], v3 offset:4096
  ds_read_b64_tr_b16 v[12:13], v8 offset:1024
  v_mfma_f32_32x32x16_bf16 v[224:239], v[28:31], v[32:35], v[224:239]
  ds_read_b64_tr_b16 v[14:15], v8 offset:1280
  v_mfma_f32_32x32x16_bf16 v[240:255], v[28:31], v[36:39], v[240:255]
  ds_read_b64_tr_b16 v[28:29], v8 offset:17408
  ds_read_b64_tr_b16 v[30:31], v8 offset:17664
  v_dot2c_f32_bf16 v84, v32, v92
  v_dot2c_f32_bf16 v86, v32, v32
  v_dot2c_f32_bf16 v85, v33, v92
  v_dot2c_f32_bf16 v87, v33, v33
  v_dot2c_f32_bf16 v84, v34, v92
  v_dot2c_f32_bf16 v86, v34, v34
  v_dot2c_f32_bf16 v85, v35, v92
  v_dot2c_f32_bf16 v87, v35, v35
  s_waitcnt lgkmcnt(0)
  v_mfma_f32_32x32x16_bf16 v[96:111], v[40:43], v[12:15], v[96:111]
  ds_read_b128 v[32:35], v4 offset:0
  ds_read_b128 v[36:39], v4 offset:4096
  ds_read_b64_tr_b16 v[12:13], v8 offset:2048
  v_mfma_f32_32x32x16_bf16 v[224:239], v[28:31], v[40:43], v[224:239]
  ds_read_b64_tr_b16 v[14:15], v8 offset:2304
  v_mfma_f32_32x32x16_bf16 v[240:255], v[28:31], v[44:47], v[240:255]
  ds_read_b64_tr_b16 v[28:29], v8 offset:18432
  ds_read_b64_tr_b16 v[30:31], v8 offset:18688
  v_dot2c_f32_bf16 v84, v40, v92
  v_dot2c_f32_bf16 v86, v40, v40
  v_dot2c_f32_bf16 v85, v41, v92
  v_dot2c_f32_bf16 v87, v41, v41
  v_dot2c_f32_bf16 v84, v42, v92
  v_dot2c_f32_bf16 v86, v42, v42
  v_dot2c_f32_bf16 v85, v43, v92
  v_dot2c_f32_bf16 v87, v43, v43
  s_waitcnt lgkmcnt(0)
  v_mfma_f32_32x32x16_bf16 v[96:111], v[32:35], v[12:15], v[96:111]
  ds_read_b128 v[40:43], v5 offset:0
  ds_read_b128 v[44:47], v5 offset:4096
  ds_read_b64_tr_b16 v[12:13], v8 offset:3072
  v_mfma_f32_32x32x16_bf16 v[224:239], v[28:31], v[32:35], v[224:239]
  ds_read_b64_tr_b16 v[14:15], v8 offset:3328
  v_mfma_f32_32x32x16_bf16 v[240:255], v[28:31], v[36:39], v[240:255]
  ds_read_b64_tr_b16 v[28:29], v8 offset:19456
  ds_read_b64_tr_b16 v[30:31], v8 offset:19712
  v_dot2c_f32_bf16 v84, v32, v92
  v_dot2c_f32_bf16 v86, v32, v32
  v_dot2c_f32_bf16 v85, v33, v92
  v_dot2c_f32_bf16 v87, v33, v33
  v_dot2c_f32_bf16 v84, v34, v92
  v_dot2c_f32_bf16 v86, v34, v34
  v_dot2c_f32_bf16 v85, v35, v92
  v_dot2c_f32_bf16 v87, v35, v35
  s_waitcnt lgkmcnt(0)
  v_mfma_f32_32x32x16_bf16 v[96:111], v[40:43], v[12:15], v[96:111]
  v_mfma_f32_32x32x16_bf16 v[224:239], v[28:31], v[40:43], v[224:239]
  v_mfma_f32_32x32x16_bf16 v[240:255], v[28:31], v[44:47], v[240:255]
  v_dot2c_f32_bf16 v84, v40, v92
  v_dot2c_f32_bf16 v86, v40, v40
  v_dot2c_f32_bf16 v85, v41, v92
  v_dot2c_f32_bf16 v87, v41, v41
  v_dot2c_f32_bf16 v84, v42, v92
  v_dot2c_f32_bf16 v86, v42, v42
  v_dot2c_f32_bf16 v85, v43, v92
  v_dot2c_f32_bf16 v87, v43, v43
  s_nop 2
  v_add_f32 v84, v84, v85
  v_add_f32 v86, v86, v87
  v_mov_b32 v85, v84
  v_mov_b32 v87, v86
  s_nop 1
  v_permlane32_swap_b32 v84, v85
  v_permlane32_swap_b32 v86, v87
  s_nop 1
  v_add_f32 v84, v84, v85
  v_add_f32 v86, v86, v87
  v_mul_f32 v84, 0x3a800000, v84
  v_mul_f32 v86, 0x3a800000, v86
  v_fma_f32 v86, -v84, v84, v86
  v_max_f32 v86, 0, v86
  v_mov_b32 v50, v84
  v_cvt_pk_bf16_f32 v50, v50, v50
  v_and_b32 v50, 0xffff0000, v50
  v_mov_b32 v85, v86
  v_cvt_pk_bf16_f32 v85, v85, v85
  v_and_b32 v85, 0xffff0000, v85
  v_add_f32 v85, 0x3727c5ac, v85
  v_cvt_pk_bf16_f32 v85, v85, v85
  v_and_b32 v85, 0xffff0000, v85
  v_sqrt_f32 v85, v85
  s_nop 0
  v_cvt_pk_bf16_f32 v85, v85, v85
  v_and_b32 v85, 0xffff0000, v85
  v_rcp_f32 v48, v85
  s_nop 0
  v_mul_f32 v87, v48, v48
  v_mul_f32 v87, v87, v86
  v_cvt_pk_bf16_f32 v87, v87, v87
  v_and_b32 v87, 0xffff0000, v87
  v_add_f32 v87, 0x3727c5ac, v87
  v_cvt_pk_bf16_f32 v87, v87, v87
  v_and_b32 v87, 0xffff0000, v87
  v_sqrt_f32 v87, v87
  s_nop 0
  v_cvt_pk_bf16_f32 v87, v87, v87
  v_and_b32 v87, 0xffff0000, v87
  v_rcp_f32 v87, v87
  s_nop 0
  v_mul_f32 v52, v48, v87
  v_mul_f32 v50, -v50, v48
  v_mul_f32 v54, -v84, v52
  s_lshl_b32 s57, s48, 8
  s_lshl_b32 s58, s55, 6
  s_add_u32 s57, s57, s58
  s_lshl_b32 s57, s57, 4
  s_add_u32 s57, s57, 23330816
  v_and_b32 v9, 31, v0
  v_lshlrev_b32 v9, 4, v9
  s_mov_b32 s64, s57
  s_lshl_b32 s61, s50, 9
  v_add_u32 v9, s61, v9
  s_and_b32 s57, s55, 1
  s_lshl_b32 s57, s57, 12
  v_and_b32 v64, 15, v0
  v_lshlrev_b32 v64, 4, v64
  v_bfe_u32 v65, v0, 4, 1
  v_lshl_add_u32 v64, v65, 10, v64
  v_lshrrev_b32 v65, 5, v0
  v_lshl_add_u32 v64, v65, 8, v64
  v_add_u32 v64, s57, v64
  v_lshlrev_b32 v65, 4, v0
  s_lshr_b32 s57, s55, 1
  s_lshl_b32 s58, s48, 1
  s_add_u32 s68, s57, s58
  s_mul_i32 s67, s68, 1179648
  s_lshl_b32 s58, s51, 13
  s_add_u32 s67, s67, s58
  s_add_u32 s67, s67, 262144
  v_lshrrev_b32 v66, 5, v0
  v_lshlrev_b32 v66, 4, v66
  v_add_u32 v66, 159744, v66
  s_barrier
  s_setprio 3
  s_lshl_b32 s57, s55, 9
  s_add_u32 s57, s57, 65536
  v_and_b32 v2, 31, v0
  v_lshlrev_b32 v2, 2, v2
  v_add_u32 v3, s57, v2
  ds_write_b32 v3, v48
  ds_write_b32 v3, v50 offset:128
  v_add_u32 v2, 159744, v2
  ds_read_b32 v4, v2 offset:0
  ds_read_b32 v5, v2 offset:128
  ds_read_b32 v6, v2 offset:256
  ds_read_b32 v7, v2 offset:384
  v_lshrrev_b32 v3, 5, v0
  v_lshlrev_b32 v3, 4, v3
  v_add_u32 v3, s57, v3
  ds_read_b128 v[128:131], v3 offset:0
  ds_read_b128 v[132:135], v3 offset:32
  ds_read_b128 v[136:139], v3 offset:64
  ds_read_b128 v[140:143], v3 offset:96
  ds_read_b128 v[144:147], v3 offset:128
  ds_read_b128 v[148:151], v3 offset:160
  ds_read_b128 v[152:155], v3 offset:192
  ds_read_b128 v[156:159], v3 offset:224
  s_waitcnt lgkmcnt(0)
  v_add_f32 v4, v4, v5
  v_add_f32 v6, v6, v7
  v_pk_mul_f32 v[96:97], v[96:97], v[128:129]
  v_pk_mul_f32 v[98:99], v[98:99], v[130:131]
  v_pk_mul_f32 v[100:101], v[100:101], v[132:133]
  v_pk_mul_f32 v[102:103], v[102:103], v[134:135]
  v_pk_mul_f32 v[104:105], v[104:105], v[136:137]
  v_pk_mul_f32 v[106:107], v[106:107], v[138:139]
  v_pk_mul_f32 v[108:109], v[108:109], v[140:141]
  v_pk_mul_f32 v[110:111], v[110:111], v[142:143]
  v_add_f32 v4, v4, v6
  v_pk_fma_f32 v[96:97], v[144:145], v[4:5], v[96:97] op_sel:[0,0,0] op_sel_hi:[1,0,1]
  v_pk_fma_f32 v[98:99], v[146:147], v[4:5], v[98:99] op_sel:[0,0,0] op_sel_hi:[1,0,1]
  v_pk_fma_f32 v[100:101], v[148:149], v[4:5], v[100:101] op_sel:[0,0,0] op_sel_hi:[1,0,1]
  v_pk_fma_f32 v[102:103], v[150:151], v[4:5], v[102:103] op_sel:[0,0,0] op_sel_hi:[1,0,1]
  v_pk_fma_f32 v[104:105], v[152:153], v[4:5], v[104:105] op_sel:[0,0,0] op_sel_hi:[1,0,1]
  v_pk_fma_f32 v[106:107], v[154:155], v[4:5], v[106:107] op_sel:[0,0,0] op_sel_hi:[1,0,1]
  v_pk_fma_f32 v[108:109], v[156:157], v[4:5], v[108:109] op_sel:[0,0,0] op_sel_hi:[1,0,1]
  v_pk_fma_f32 v[110:111], v[158:159], v[4:5], v[110:111] op_sel:[0,0,0] op_sel_hi:[1,0,1]
  s_lshl_b32 s57, s48, 3
  s_lshl_b32 s58, s55, 1
  s_add_u32 s57, s57, s58
  s_add_u32 s57, s57, s50
  s_lshl_b32 s57, s57, 12
  s_add_u32 s57, s57, 23070720
  v_cvt_pk_bf16_f32 v96, v96, v97
  v_cvt_pk_bf16_f32 v97, v98, v99
  v_cvt_pk_bf16_f32 v98, v100, v101
  v_cvt_pk_bf16_f32 v99, v102, v103
  v_cvt_pk_bf16_f32 v100, v104, v105
  v_cvt_pk_bf16_f32 v101, v106, v107
  v_cvt_pk_bf16_f32 v102, v108, v109
  v_cvt_pk_bf16_f32 v103, v110, v111
  buffer_store_dwordx4 v[96:99], v65, s[36:39], s57 offen offset:0 sc1
  buffer_store_dwordx4 v[100:103], v65, s[36:39], s57 offen offset:1024 sc1
  v_mov_b32 v4, 161812
  v_mov_b32 v2, 1
  v_lshlrev_b32 v3, 8, v0
  s_sub_u32 s58, s2, 224
  s_lshl_b32 s58, s58, 2
  s_mov_b64 exec, 1
  s_waitcnt vmcnt(0)
  ds_add_rtn_u32 v5, v4, v2
  s_waitcnt lgkmcnt(0)
  v_readfirstlane_b32 s57, v5
  s_mov_b64 exec, -1
  s_cmp_eq_u32 s57, 3
  s_cbranch_scc0 parallel_sum__grouped_kv_mqa__mixer_channel_mlp__prompt_kernel_v_nosig
  buffer_store_dword v2, v3, s[44:47], s58 offen sc1
  s_waitcnt vmcnt(0)
  ds_write_b32 v4, v2 offset:12
parallel_sum__grouped_kv_mqa__mixer_channel_mlp__prompt_kernel_v_nosig:
  s_mov_b32 s59, 0
parallel_sum__grouped_kv_mqa__mixer_channel_mlp__prompt_kernel_v_wp:
  ds_read_b32 v5, v4 offset:12
  s_add_u32 s59, s59, 1
  s_cmp_gt_u32 s59, 0x400000
  s_cbranch_scc1 parallel_sum__grouped_kv_mqa__mixer_channel_mlp__prompt_kernel_v_wp_ok
  s_waitcnt lgkmcnt(0)
  v_cmp_eq_u32 vcc, 0, v5
  s_nop 1
  s_cbranch_vccz parallel_sum__grouped_kv_mqa__mixer_channel_mlp__prompt_kernel_v_wp_ok
  s_sleep 2
  s_branch parallel_sum__grouped_kv_mqa__mixer_channel_mlp__prompt_kernel_v_wp
parallel_sum__grouped_kv_mqa__mixer_channel_mlp__prompt_kernel_v_wp_ok:
  s_lshl_b32 s57, s48, 2
  s_add_u32 s57, s57, s49
  s_sub_u32 s57, s57, 28
  s_lshl_b32 s57, s57, 2
  s_add_u32 s57, s57, s55
  s_mul_i32 s58, s57, 57344
  v_lshlrev_b32 v4, 7, v0
  v_add_u32 v5, s58, v4
  s_lshl_b32 s58, s57, 14
  v_add_u32 v5, s58, v4
  global_load_dword v6, v5, s[4:5]
  v_add_u32 v5, 8192, v5
  global_load_dword v6, v5, s[4:5]
  v_mov_b32 v4, 161796
  s_mov_b32 s59, 0
parallel_sum__grouped_kv_mqa__mixer_channel_mlp__prompt_kernel_v_wf:
  s_sleep 4
  ds_read_b32 v5, v4
  s_add_u32 s59, s59, 1
  s_cmp_gt_u32 s59, 0x400000
  s_cbranch_scc1 parallel_sum__grouped_kv_mqa__mixer_channel_mlp__prompt_kernel_v_wf_ok
  s_waitcnt lgkmcnt(0)
  v_cmp_eq_u32 vcc, 0, v5
  s_nop 1
  s_cbranch_vccnz parallel_sum__grouped_kv_mqa__mixer_channel_mlp__prompt_kernel_v_wf
parallel_sum__grouped_kv_mqa__mixer_channel_mlp__prompt_kernel_v_wf_ok:
  v_xor_b32 v9, 0x200, v9
  buffer_load_dword v57, v9, s[36:39], s64 offen sc1
  buffer_load_dword v59, v9, s[36:39], s64 offen offset:4 sc1
  ds_read_b128 v[12:15], v66 offset:512
  ds_read_b128 v[16:19], v66 offset:544
  ds_read_b128 v[20:23], v66 offset:576
  ds_read_b128 v[24:27], v66 offset:608
  ds_read_b128 v[28:31], v66 offset:640
  ds_read_b128 v[32:35], v66 offset:672
  ds_read_b128 v[36:39], v66 offset:704
  ds_read_b128 v[40:43], v66 offset:736
  ds_read_b128 v[68:71], v66 offset:768
  ds_read_b128 v[72:75], v66 offset:800
  ds_read_b128 v[76:79], v66 offset:832
  ds_read_b128 v[80:83], v66 offset:864
  s_lshl_b32 s57, s55, 12
  s_add_u32 s57, s57, 49152
  s_lshl_b32 s58, s50, 11
  s_add_u32 s57, s57, s58
  v_add_u32 v8, s57, v65
  v_xor_b32 v10, 0x800, v8
  s_waitcnt vmcnt(0) lgkmcnt(4)
  v_mul_f32 v49, 0x3e8293ee, v48
  v_mul_f32 v51, 0x3e8293ee, v50
  v_pk_add_f32 v[12:13], v[12:13], v[28:29]
  v_pk_add_f32 v[14:15], v[14:15], v[30:31]
  v_pk_add_f32 v[16:17], v[16:17], v[32:33]
  v_pk_add_f32 v[18:19], v[18:19], v[34:35]
  v_pk_add_f32 v[20:21], v[20:21], v[36:37]
  v_pk_add_f32 v[22:23], v[22:23], v[38:39]
  v_pk_add_f32 v[24:25], v[24:25], v[40:41]
  v_pk_add_f32 v[26:27], v[26:27], v[42:43]
  ds_read_b128 v[28:31], v66 offset:896
  ds_read_b128 v[32:35], v66 offset:928
  ds_read_b128 v[36:39], v66 offset:960
  ds_read_b128 v[40:43], v66 offset:992
  s_waitcnt lgkmcnt(4)
  v_pk_add_f32 v[12:13], v[12:13], v[68:69]
  v_pk_add_f32 v[14:15], v[14:15], v[70:71]
  v_pk_add_f32 v[16:17], v[16:17], v[72:73]
  v_pk_add_f32 v[18:19], v[18:19], v[74:75]
  v_pk_add_f32 v[20:21], v[20:21], v[76:77]
  v_pk_add_f32 v[22:23], v[22:23], v[78:79]
  v_pk_add_f32 v[24:25], v[24:25], v[80:81]
  v_pk_add_f32 v[26:27], v[26:27], v[82:83]
  v_pk_mul_f32 v[224:225], v[224:225], v[48:49] op_sel:[0,1] op_sel_hi:[1,1]
  v_pk_mul_f32 v[226:227], v[226:227], v[48:49] op_sel:[0,1] op_sel_hi:[1,1]
  v_pk_mul_f32 v[228:229], v[228:229], v[48:49] op_sel:[0,1] op_sel_hi:[1,1]
  v_pk_mul_f32 v[230:231], v[230:231], v[48:49] op_sel:[0,1] op_sel_hi:[1,1]
  v_pk_mul_f32 v[232:233], v[232:233], v[48:49] op_sel:[0,1] op_sel_hi:[1,1]
  v_pk_mul_f32 v[234:235], v[234:235], v[48:49] op_sel:[0,1] op_sel_hi:[1,1]
  v_pk_mul_f32 v[236:237], v[236:237], v[48:49] op_sel:[0,1] op_sel_hi:[1,1]
  v_pk_mul_f32 v[238:239], v[238:239], v[48:49] op_sel:[0,1] op_sel_hi:[1,1]
  v_pk_mul_f32 v[240:241], v[240:241], v[56:57] op_sel:[0,1] op_sel_hi:[1,1]
  v_pk_mul_f32 v[242:243], v[242:243], v[56:57] op_sel:[0,1] op_sel_hi:[1,1]
  v_pk_mul_f32 v[244:245], v[244:245], v[56:57] op_sel:[0,1] op_sel_hi:[1,1]
  v_pk_mul_f32 v[246:247], v[246:247], v[56:57] op_sel:[0,1] op_sel_hi:[1,1]
  v_pk_mul_f32 v[248:249], v[248:249], v[56:57] op_sel:[0,1] op_sel_hi:[1,1]
  v_pk_mul_f32 v[250:251], v[250:251], v[56:57] op_sel:[0,1] op_sel_hi:[1,1]
  v_pk_mul_f32 v[252:253], v[252:253], v[56:57] op_sel:[0,1] op_sel_hi:[1,1]
  v_pk_mul_f32 v[254:255], v[254:255], v[56:57] op_sel:[0,1] op_sel_hi:[1,1]
  s_waitcnt lgkmcnt(0)
  v_pk_add_f32 v[12:13], v[12:13], v[28:29]
  v_pk_add_f32 v[14:15], v[14:15], v[30:31]
  v_pk_add_f32 v[16:17], v[16:17], v[32:33]
  v_pk_add_f32 v[18:19], v[18:19], v[34:35]
  v_pk_add_f32 v[20:21], v[20:21], v[36:37]
  v_pk_add_f32 v[22:23], v[22:23], v[38:39]
  v_pk_add_f32 v[24:25], v[24:25], v[40:41]
  v_pk_add_f32 v[26:27], v[26:27], v[42:43]
  ds_read_b128 v[68:71], v66 offset:0
  ds_read_b128 v[72:75], v66 offset:32
  ds_read_b128 v[76:79], v66 offset:64
  ds_read_b128 v[80:83], v66 offset:96
  v_pk_fma_f32 v[224:225], v[12:13], v[50:51], v[224:225] op_sel:[0,1,0] op_sel_hi:[1,1,1]
  v_pk_fma_f32 v[226:227], v[14:15], v[50:51], v[226:227] op_sel:[0,1,0] op_sel_hi:[1,1,1]
  v_pk_fma_f32 v[228:229], v[16:17], v[50:51], v[228:229] op_sel:[0,1,0] op_sel_hi:[1,1,1]
  v_pk_fma_f32 v[230:231], v[18:19], v[50:51], v[230:231] op_sel:[0,1,0] op_sel_hi:[1,1,1]
  v_pk_fma_f32 v[232:233], v[20:21], v[50:51], v[232:233] op_sel:[0,1,0] op_sel_hi:[1,1,1]
  v_pk_fma_f32 v[234:235], v[22:23], v[50:51], v[234:235] op_sel:[0,1,0] op_sel_hi:[1,1,1]
  v_pk_fma_f32 v[236:237], v[24:25], v[50:51], v[236:237] op_sel:[0,1,0] op_sel_hi:[1,1,1]
  v_pk_fma_f32 v[238:239], v[26:27], v[50:51], v[238:239] op_sel:[0,1,0] op_sel_hi:[1,1,1]
  v_cvt_pk_bf16_f32 v84, v224, v225
  v_cvt_pk_bf16_f32 v85, v226, v227
  v_cvt_pk_bf16_f32 v86, v228, v229
  v_cvt_pk_bf16_f32 v87, v230, v231
  v_cvt_pk_bf16_f32 v88, v232, v233
  v_cvt_pk_bf16_f32 v89, v234, v235
  v_cvt_pk_bf16_f32 v90, v236, v237
  v_cvt_pk_bf16_f32 v91, v238, v239
  ds_write_b128 v8, v[84:87] offset:0
  ds_write_b128 v8, v[88:91] offset:1024
  v_pk_fma_f32 v[240:241], v[12:13], v[58:59], v[240:241] op_sel:[0,1,0] op_sel_hi:[1,1,1]
  v_pk_fma_f32 v[242:243], v[14:15], v[58:59], v[242:243] op_sel:[0,1,0] op_sel_hi:[1,1,1]
  v_pk_fma_f32 v[244:245], v[16:17], v[58:59], v[244:245] op_sel:[0,1,0] op_sel_hi:[1,1,1]
  v_pk_fma_f32 v[246:247], v[18:19], v[58:59], v[246:247] op_sel:[0,1,0] op_sel_hi:[1,1,1]
  v_pk_fma_f32 v[248:249], v[20:21], v[58:59], v[248:249] op_sel:[0,1,0] op_sel_hi:[1,1,1]
  v_pk_fma_f32 v[250:251], v[22:23], v[58:59], v[250:251] op_sel:[0,1,0] op_sel_hi:[1,1,1]
  v_pk_fma_f32 v[252:253], v[24:25], v[58:59], v[252:253] op_sel:[0,1,0] op_sel_hi:[1,1,1]
  v_pk_fma_f32 v[254:255], v[26:27], v[58:59], v[254:255] op_sel:[0,1,0] op_sel_hi:[1,1,1]
  v_cvt_pk_bf16_f32 v84, v240, v241
  v_cvt_pk_bf16_f32 v85, v242, v243
  v_cvt_pk_bf16_f32 v86, v244, v245
  v_cvt_pk_bf16_f32 v87, v246, v247
  v_cvt_pk_bf16_f32 v88, v248, v249
  v_cvt_pk_bf16_f32 v89, v250, v251
  v_cvt_pk_bf16_f32 v90, v252, v253
  v_cvt_pk_bf16_f32 v91, v254, v255
  ds_write_b128 v10, v[84:87] offset:0
  ds_write_b128 v10, v[88:91] offset:1024
  s_lshl_b32 s57, s55, 7
  s_add_u32 s57, s57, 161808
  v_mov_b32 v2, s57
  v_mov_b32 v3, 1
  ds_write_b32 v2, v3
  s_branch parallel_sum__grouped_kv_mqa__mixer_channel_mlp__prompt_kernel_g2
parallel_sum__grouped_kv_mqa__mixer_channel_mlp__prompt_kernel_att_early:
  s_sub_u32 s70, s55, 4
  s_add_u32 s32, s22, 23068672
  s_addc_u32 s33, s23, 0
  s_mov_b32 s34, 262144
  s_mov_b32 s35, 0x20000
  v_lshlrev_b32 v1, 4, v0
  s_lshl_b32 s65, s70, 12
  s_lshr_b32 s64, s2, 3
  s_and_b32 s64, s64, 15
  s_lshl_b32 s64, s64, 14
  s_add_u32 s64, s64, s65
  s_add_u32 m0, s65, 126976
  s_nop 0
  buffer_load_dwordx4 v1, s[32:35], s64 offen offset:0 sc1 lds
  buffer_load_dwordx4 v1, s[32:35], s64 offen offset:1024 sc1 lds
  buffer_load_dwordx4 v1, s[32:35], s64 offen offset:2048 sc1 lds
  buffer_load_dwordx4 v1, s[32:35], s64 offen offset:3072 sc1 lds
  s_add_u32 s64, s64, 16384
  s_and_b32 s64, s64, 262143
  s_add_u32 m0, s65, 143360
  s_nop 0
  buffer_load_dwordx4 v1, s[32:35], s64 offen offset:0 sc1 lds
  buffer_load_dwordx4 v1, s[32:35], s64 offen offset:1024 sc1 lds
  buffer_load_dwordx4 v1, s[32:35], s64 offen offset:2048 sc1 lds
  buffer_load_dwordx4 v1, s[32:35], s64 offen offset:3072 sc1 lds
  s_add_u32 s64, s64, 16384
  s_and_b32 s64, s64, 262143
  s_branch parallel_sum__grouped_kv_mqa__mixer_channel_mlp__prompt_kernel_att_early_ret
parallel_sum__grouped_kv_mqa__mixer_channel_mlp__prompt_kernel_att:
  s_setprio 2
  s_cmp_eq_u32 s56, 0
  s_cbranch_scc1 parallel_sum__grouped_kv_mqa__mixer_channel_mlp__prompt_kernel_att_kv
  s_sub_u32 s70, s55, 4
  s_add_u32 s32, s22, 23068672
  s_addc_u32 s33, s23, 0
  s_mov_b32 s34, 262144
  s_mov_b32 s35, 0x20000
  v_lshlrev_b32 v1, 4, v0
  s_lshl_b32 s65, s70, 12
  s_lshr_b32 s64, s2, 3
  s_and_b32 s64, s64, 15
  s_lshl_b32 s64, s64, 14
  s_add_u32 s64, s64, s65
  s_mov_b32 s68, 0
  v_mov_b32 v80, 161796
parallel_sum__grouped_kv_mqa__mixer_channel_mlp__prompt_kernel_pkv:
  s_add_u32 s68, s68, 1
  s_cmp_gt_u32 s68, 0x100000
  s_cbranch_scc1 parallel_sum__grouped_kv_mqa__mixer_channel_mlp__prompt_kernel_pkv_ok
  s_cmp_eq_u32 s70, 0
  s_cbranch_scc0 parallel_sum__grouped_kv_mqa__mixer_channel_mlp__prompt_kernel_pkv_f
  s_sleep 64
  buffer_load_dword v82, v81, s[44:47], 0 offen sc1
  s_waitcnt vmcnt(0)
  v_and_b32 v82, v84, v82
  v_cmp_ne_u32 vcc, v84, v82
  v_mov_b32 v82, 1
  s_cbranch_vccnz parallel_sum__grouped_kv_mqa__mixer_channel_mlp__prompt_kernel_pkv
  ds_write_b32 v80, v82
  s_branch parallel_sum__grouped_kv_mqa__mixer_channel_mlp__prompt_kernel_pkv_ok
parallel_sum__grouped_kv_mqa__mixer_channel_mlp__prompt_kernel_pkv_f:
  s_sleep 4
  ds_read_b32 v82, v80
  s_waitcnt lgkmcnt(0)
  v_cmp_eq_u32 vcc, 0, v82
  s_nop 1
  s_cbranch_vccnz parallel_sum__grouped_kv_mqa__mixer_channel_mlp__prompt_kernel_pkv
parallel_sum__grouped_kv_mqa__mixer_channel_mlp__prompt_kernel_pkv_ok:
  s_add_u32 m0, s65, 126976
  s_nop 0
  buffer_load_dwordx4 v1, s[32:35], s64 offen offset:0 sc1 lds
  buffer_load_dwordx4 v1, s[32:35], s64 offen offset:1024 sc1 lds
  buffer_load_dwordx4 v1, s[32:35], s64 offen offset:2048 sc1 lds
  buffer_load_dwordx4 v1, s[32:35], s64 offen offset:3072 sc1 lds
  s_add_u32 s64, s64, 16384
  s_and_b32 s64, s64, 262143
  s_add_u32 m0, s65, 143360
  s_nop 0
  buffer_load_dwordx4 v1, s[32:35], s64 offen offset:0 sc1 lds
  buffer_load_dwordx4 v1, s[32:35], s64 offen offset:1024 sc1 lds
  buffer_load_dwordx4 v1, s[32:35], s64 offen offset:2048 sc1 lds
  buffer_load_dwordx4 v1, s[32:35], s64 offen offset:3072 sc1 lds
  s_add_u32 s64, s64, 16384
  s_and_b32 s64, s64, 262143
parallel_sum__grouped_kv_mqa__mixer_channel_mlp__prompt_kernel_att_kv:
  s_add_u32 m0, s65, 94208
  s_nop 0
  buffer_load_dwordx4 v1, s[32:35], s64 offen offset:0 sc1 lds
  buffer_load_dwordx4 v1, s[32:35], s64 offen offset:1024 sc1 lds
  buffer_load_dwordx4 v1, s[32:35], s64 offen offset:2048 sc1 lds
  buffer_load_dwordx4 v1, s[32:35], s64 offen offset:3072 sc1 lds
  s_add_u32 s64, s64, 16384
  s_and_b32 s64, s64, 262143
  s_lshr_b32 s57, s70, 1
  s_lshl_b32 s50, s48, 1
  s_add_u32 s50, s50, s57
  s_mov_b32 s51, s49
  s_mul_i32 s67, s50, 1179648
  s_lshl_b32 s57, s51, 13
  s_add_u32 s67, s67, s57
  s_and_b32 s57, s70, 1
  s_lshl_b32 s57, s57, 12
  s_add_u32 s67, s67, s57
  s_and_b32 s57, s2, 7
  s_lshr_b32 s58, s2, 3
  s_and_b32 s48, s57, 1
  s_xor_b32 s48, s48, 1
  s_lshl_b32 s48, s48, 1
  s_bfe_u32 s59, s57, 0x10001
  s_add_u32 s48, s48, s59
  s_lshl_b32 s48, s48, 2
  s_and_b32 s59, s58, 3
  s_add_u32 s48, s48, s59
  s_lshr_b32 s49, s57, 2
  s_lshl_b32 s49, s49, 3
  s_lshr_b32 s59, s58, 2
  s_add_u32 s49, s49, s59
  s_mov_b32 s40, s96
  s_mov_b32 s41, s97
  s_mov_b32 s42, 2048
  s_mov_b32 s43, 0x20000
  s_mov_b32 s44, s98
  s_mov_b32 s45, s99
  s_mov_b32 s46, 4194304
  s_mov_b32 s47, 0x20000
  v_add_u32 v7, 94208, v1
  s_lshl_b32 s57, s70, 7
  s_add_u32 s57, s57, 161792
  v_mov_b32 v2, s57
  v_and_b32 v3, 3, v0
  v_lshlrev_b32 v3, 7, v3
  v_add_u32 v3, 161792, v3
  v_mov_b32 v8, 0x3f803f80
  v_and_b32 v9, 4, v0
  v_cmp_eq_u32 vcc, 0, v9
  s_nop 1
  v_cndmask_b32 v12, 0, v8, vcc
  v_cndmask_b32 v13, 0, v8, vcc
  v_cndmask_b32 v14, v8, 0, vcc
  v_cndmask_b32 v15, v8, 0, vcc
  v_mov_b32 v8, 0x4444
  v_mov_b32 v6, 0xeeee
  v_and_b32 v9, 1, v0
  v_cmp_eq_u32 vcc, 0, v9
  s_nop 1
  v_cndmask_b32 v6, v6, v8, vcc
  v_mov_b32 v44, 0
  v_mov_b32 v45, 0
  v_mov_b32 v46, 0
  v_mov_b32 v47, 0
  v_mov_b32 v48, 0
  v_mov_b32 v49, 0
  v_mov_b32 v50, 0
  v_mov_b32 v51, 0
  v_mov_b32 v52, 0
  v_mov_b32 v53, 0
  v_mov_b32 v54, 0
  v_mov_b32 v55, 0
  v_mov_b32 v160, 0
  v_mov_b32 v161, 0
  v_mov_b32 v162, 0
  v_mov_b32 v163, 0
  v_mov_b32 v164, 0
  v_mov_b32 v165, 0
  v_mov_b32 v166, 0
  v_mov_b32 v167, 0
  v_mov_b32 v168, 0
  v_mov_b32 v169, 0
  v_mov_b32 v170, 0
  v_mov_b32 v171, 0
  v_mov_b32 v172, 0
  v_mov_b32 v173, 0
  v_mov_b32 v174, 0
  v_mov_b32 v175, 0
  v_mov_b32 v112, 0
  v_mov_b32 v113, 0
  v_mov_b32 v114, 0
  v_mov_b32 v115, 0
  v_mov_b32 v176, 0
  v_mov_b32 v177, 0
  v_mov_b32 v178, 0
  v_mov_b32 v179, 0
  v_mov_b32 v180, 0
  v_mov_b32 v181, 0
  v_mov_b32 v182, 0
  v_mov_b32 v183, 0
  v_mov_b32 v184, 0
  v_mov_b32 v185, 0
  v_mov_b32 v186, 0
  v_mov_b32 v187, 0
  v_mov_b32 v188, 0
  v_mov_b32 v189, 0
  v_mov_b32 v190, 0
  v_mov_b32 v191, 0
  v_mov_b32 v116, 0
  v_mov_b32 v117, 0
  v_mov_b32 v118, 0
  v_mov_b32 v119, 0
  v_mov_b32 v10, 161796
  s_waitcnt vmcnt(4)
  v_mov_b32 v4, 1
  ds_write_b32 v2, v4
  s_mov_b32 s68, 0
parallel_sum__grouped_kv_mqa__mixer_channel_mlp__prompt_kernel_a0_l:
  ds_read_b32 v5, v3
  s_add_u32 s68, s68, 1
  s_cmp_gt_u32 s68, 0x400000
  s_cbranch_scc1 parallel_sum__grouped_kv_mqa__mixer_channel_mlp__prompt_kernel_a0_ret
  s_waitcnt lgkmcnt(0)
  v_cmp_gt_u32 vcc, v4, v5
  s_nop 1
  s_cbranch_vccnz parallel_sum__grouped_kv_mqa__mixer_channel_mlp__prompt_kernel_a0_l
parallel_sum__grouped_kv_mqa__mixer_channel_mlp__prompt_kernel_a0_ret:
  ds_read_b128 v[16:19], v7 offset:32768
  ds_read_b128 v[20:23], v7 offset:33792
  ds_read_b128 v[24:27], v7 offset:34816
  ds_read_b128 v[28:31], v7 offset:35840
  ds_read_b128 v[32:35], v7 offset:36864
  ds_read_b128 v[36:39], v7 offset:37888
  ds_read_b128 v[40:43], v7 offset:38912
  s_mov_b32 s68, 0
parallel_sum__grouped_kv_mqa__mixer_channel_mlp__prompt_kernel_pq:
  s_sleep 1
  ds_read_b32 v8, v2 offset:16
  s_add_u32 s68, s68, 1
  s_cmp_gt_u32 s68, 0x400000
  s_cbranch_scc1 parallel_sum__grouped_kv_mqa__mixer_channel_mlp__prompt_kernel_pq_ok
  s_waitcnt lgkmcnt(0)
  v_cmp_eq_u32 vcc, 0, v8
  s_nop 1
  s_cbranch_vccnz parallel_sum__grouped_kv_mqa__mixer_channel_mlp__prompt_kernel_pq
parallel_sum__grouped_kv_mqa__mixer_channel_mlp__prompt_kernel_pq_ok:
  s_add_u32 s57, s65, 49152
  v_add_u32 v8, s57, v1
  ds_read_b128 v[96:99], v8 offset:0
  ds_read_b128 v[100:103], v8 offset:1024
  ds_read_b128 v[104:107], v8 offset:2048
  ds_read_b128 v[108:111], v8 offset:3072
  s_waitcnt lgkmcnt(0)
  v_mfma_f32_32x32x16_bf16 v[64:79], v[16:19], v[96:99], 0
  v_mfma_f32_32x32x16_bf16 v[64:79], v[20:23], v[100:103], v[64:79]
  v_mfma_f32_32x32x16_bf16 v[80:95], v[16:19], v[104:107], 0
  v_mfma_f32_32x32x16_bf16 v[80:95], v[20:23], v[108:111], v[80:95]
  s_nop 15
  v_max3_f32 v8, v64, v65, v66
  v_max3_f32 v8, v8, v67, v68
  v_max3_f32 v8, v8, v69, v70
  v_max3_f32 v8, v8, v71, v72
  v_max3_f32 v8, v8, v73, v74
  v_max3_f32 v8, v8, v75, v76
  v_max3_f32 v8, v8, v77, v78
  v_max_f32 v8, v8, v79
  v_mov_b32 v9, v8
  s_nop 1
  v_permlane32_swap_b32 v8, v9
  s_nop 1
  v_max_f32 v8, v8, v9
  v_sub_f32 v128, 0, v8
  v_sub_f32 v129, 0, v8
  v_sub_f32 v130, 0, v8
  v_sub_f32 v131, 0, v8
  v_sub_f32 v132, 0, v8
  v_sub_f32 v133, 0, v8
  v_sub_f32 v134, 0, v8
  v_sub_f32 v135, 0, v8
  v_sub_f32 v136, 0, v8
  v_sub_f32 v137, 0, v8
  v_sub_f32 v138, 0, v8
  v_sub_f32 v139, 0, v8
  v_sub_f32 v140, 0, v8
  v_sub_f32 v141, 0, v8
  v_sub_f32 v142, 0, v8
  v_sub_f32 v143, 0, v8
  v_max3_f32 v8, v80, v81, v82
  v_max3_f32 v8, v8, v83, v84
  v_max3_f32 v8, v8, v85, v86
  v_max3_f32 v8, v8, v87, v88
  v_max3_f32 v8, v8, v89, v90
  v_max3_f32 v8, v8, v91, v92
  v_max3_f32 v8, v8, v93, v94
  v_max_f32 v8, v8, v95
  v_mov_b32 v9, v8
  s_nop 1
  v_permlane32_swap_b32 v8, v9
  s_nop 1
  v_max_f32 v8, v8, v9
  v_sub_f32 v144, 0, v8
  v_sub_f32 v145, 0, v8
  v_sub_f32 v146, 0, v8
  v_sub_f32 v147, 0, v8
  v_sub_f32 v148, 0, v8
  v_sub_f32 v149, 0, v8
  v_sub_f32 v150, 0, v8
  v_sub_f32 v151, 0, v8
  v_sub_f32 v152, 0, v8
  v_sub_f32 v153, 0, v8
  v_sub_f32 v154, 0, v8
  v_sub_f32 v155, 0, v8
  v_sub_f32 v156, 0, v8
  v_sub_f32 v157, 0, v8
  v_sub_f32 v158, 0, v8
  v_sub_f32 v159, 0, v8
  v_add_f32 v64, v64, v128
  v_add_f32 v65, v65, v128
  v_add_f32 v66, v66, v128
  v_add_f32 v67, v67, v128
  v_add_f32 v68, v68, v128
  v_add_f32 v69, v69, v128
  v_add_f32 v70, v70, v128
  v_add_f32 v71, v71, v128
  v_add_f32 v72, v72, v128
  v_add_f32 v73, v73, v128
  v_add_f32 v74, v74, v128
  v_add_f32 v75, v75, v128
  v_add_f32 v76, v76, v128
  v_add_f32 v77, v77, v128
  v_add_f32 v78, v78, v128
  v_add_f32 v79, v79, v128
  s_mov_b32 s63, 4
  .p2align 6
parallel_sum__grouped_kv_mqa__mixer_channel_mlp__prompt_kernel_aloop:
  v_exp_f32 v64, v64
  v_exp_f32 v65, v65
  v_mfma_f32_32x32x16_bf16 v[176:191], v[44:47], v[52:55], v[176:191]
  ds_read_b128 v[44:47], v7 offset:39936
  v_exp_f32 v66, v66
  v_exp_f32 v67, v67
  v_exp_f32 v68, v68
  v_smfmac_f32_16x16x64_bf16 v[116:119], v[12:15], v[48:55], v6
  v_exp_f32 v69, v69
  v_cvt_pk_bf16_f32 v48, v64, v65
  v_cvt_pk_bf16_f32 v49, v66, v67
  v_mfma_f32_32x32x16_bf16 v[80:95], v[16:19], v[104:107], v[144:159]
  ds_read_b128 v[16:19], v7 offset:40960
  v_exp_f32 v70, v70
  v_exp_f32 v71, v71
  v_exp_f32 v72, v72
  v_cvt_pk_bf16_f32 v50, v68, v69
  v_mfma_f32_32x32x16_bf16 v[80:95], v[20:23], v[108:111], v[80:95]
  ds_read_b128 v[20:23], v7 offset:41984
  v_exp_f32 v73, v73
  v_cvt_pk_bf16_f32 v51, v70, v71
  v_exp_f32 v74, v74
  v_exp_f32 v75, v75
  v_cvt_pk_bf16_f32 v52, v72, v73
  v_mfma_f32_32x32x16_bf16 v[160:175], v[24:27], v[48:51], v[160:175]
  v_exp_f32 v76, v76
  v_exp_f32 v77, v77
  v_exp_f32 v78, v78
  v_exp_f32 v79, v79
  v_cvt_pk_bf16_f32 v53, v74, v75
  v_cvt_pk_bf16_f32 v54, v76, v77
  v_cvt_pk_bf16_f32 v55, v78, v79
  v_exp_f32 v80, v80
  v_exp_f32 v81, v81
  s_waitcnt lgkmcnt(3)
  v_mfma_f32_32x32x16_bf16 v[160:175], v[28:31], v[52:55], v[160:175]
  v_exp_f32 v82, v82
  v_exp_f32 v83, v83
  v_exp_f32 v84, v84
  v_smfmac_f32_16x16x64_bf16 v[112:115], v[12:15], v[48:55], v6
  v_exp_f32 v85, v85
  v_cvt_pk_bf16_f32 v48, v80, v81
  v_cvt_pk_bf16_f32 v49, v82, v83
  v_mfma_f32_32x32x16_bf16 v[64:79], v[32:35], v[96:99], v[128:143]
  v_exp_f32 v86, v86
  v_exp_f32 v87, v87
  v_exp_f32 v88, v88
  v_cvt_pk_bf16_f32 v50, v84, v85
  v_mfma_f32_32x32x16_bf16 v[64:79], v[36:39], v[100:103], v[64:79]
  v_exp_f32 v89, v89
  v_cvt_pk_bf16_f32 v51, v86, v87
  v_exp_f32 v90, v90
  v_exp_f32 v91, v91
  v_cvt_pk_bf16_f32 v52, v88, v89
  v_mfma_f32_32x32x16_bf16 v[176:191], v[24:27], v[48:51], v[176:191]
  ds_read_b128 v[24:27], v7 offset:43008
  v_exp_f32 v92, v92
  v_exp_f32 v93, v93
  v_exp_f32 v94, v94
  v_exp_f32 v95, v95
  v_cvt_pk_bf16_f32 v53, v90, v91
  v_cvt_pk_bf16_f32 v54, v92, v93
  v_cvt_pk_bf16_f32 v55, v94, v95
  v_exp_f32 v64, v64
  v_exp_f32 v65, v65
  v_mfma_f32_32x32x16_bf16 v[176:191], v[28:31], v[52:55], v[176:191]
  ds_read_b128 v[28:31], v7 offset:44032
  v_exp_f32 v66, v66
  v_exp_f32 v67, v67
  v_exp_f32 v68, v68
  v_smfmac_f32_16x16x64_bf16 v[116:119], v[12:15], v[48:55], v6
  ds_read_b32 v5, v3
  v_exp_f32 v69, v69
  v_cvt_pk_bf16_f32 v48, v64, v65
  v_cvt_pk_bf16_f32 v49, v66, v67
  v_mfma_f32_32x32x16_bf16 v[80:95], v[32:35], v[104:107], v[144:159]
  ds_read_b128 v[32:35], v7 offset:45056
  v_exp_f32 v70, v70
  v_exp_f32 v71, v71
  v_exp_f32 v72, v72
  v_cvt_pk_bf16_f32 v50, v68, v69
  v_mfma_f32_32x32x16_bf16 v[80:95], v[36:39], v[108:111], v[80:95]
  ds_read_b128 v[36:39], v7 offset:46080
  v_exp_f32 v73, v73
  v_cvt_pk_bf16_f32 v51, v70, v71
  v_exp_f32 v74, v74
  v_exp_f32 v75, v75
  v_cvt_pk_bf16_f32 v52, v72, v73
  v_mfma_f32_32x32x16_bf16 v[160:175], v[40:43], v[48:51], v[160:175]
  v_exp_f32 v76, v76
  v_exp_f32 v77, v77
  v_exp_f32 v78, v78
  v_exp_f32 v79, v79
  v_cvt_pk_bf16_f32 v53, v74, v75
  v_cvt_pk_bf16_f32 v54, v76, v77
  v_cvt_pk_bf16_f32 v55, v78, v79
  v_exp_f32 v80, v80
  v_exp_f32 v81, v81
  s_waitcnt lgkmcnt(2)
  v_mfma_f32_32x32x16_bf16 v[160:175], v[44:47], v[52:55], v[160:175]
  s_add_u32 m0, s65, 110592
  v_cmp_gt_u32 vcc, v4, v5
  v_exp_f32 v82, v82
  v_exp_f32 v83, v83
  v_exp_f32 v84, v84
  s_cbranch_vccnz parallel_sum__grouped_kv_mqa__mixer_channel_mlp__prompt_kernel_slow0
parallel_sum__grouped_kv_mqa__mixer_channel_mlp__prompt_kernel_slow0_ret:
  v_smfmac_f32_16x16x64_bf16 v[112:115], v[12:15], v[48:55], v6
  buffer_load_dwordx4 v1, s[32:35], s64 offen offset:0 sc1 lds
  v_exp_f32 v85, v85
  v_cvt_pk_bf16_f32 v48, v80, v81
  v_cvt_pk_bf16_f32 v49, v82, v83
  v_mfma_f32_32x32x16_bf16 v[64:79], v[16:19], v[96:99], v[128:143]
  buffer_load_dwordx4 v1, s[32:35], s64 offen offset:1024 sc1 lds
  v_exp_f32 v86, v86
  v_exp_f32 v87, v87
  v_exp_f32 v88, v88
  v_cvt_pk_bf16_f32 v50, v84, v85
  v_mfma_f32_32x32x16_bf16 v[64:79], v[20:23], v[100:103], v[64:79]
  buffer_load_dwordx4 v1, s[32:35], s64 offen offset:2048 sc1 lds
  v_exp_f32 v89, v89
  v_cvt_pk_bf16_f32 v51, v86, v87
  v_exp_f32 v90, v90
  v_exp_f32 v91, v91
  v_cvt_pk_bf16_f32 v52, v88, v89
  v_mfma_f32_32x32x16_bf16 v[176:191], v[40:43], v[48:51], v[176:191]
  ds_read_b128 v[40:43], v7 offset:47104
  v_exp_f32 v92, v92
  v_exp_f32 v93, v93
  v_exp_f32 v94, v94
  v_exp_f32 v95, v95
  v_cvt_pk_bf16_f32 v53, v90, v91
  v_cvt_pk_bf16_f32 v54, v92, v93
  v_cvt_pk_bf16_f32 v55, v94, v95
  v_exp_f32 v64, v64
  v_exp_f32 v65, v65
  v_mfma_f32_32x32x16_bf16 v[176:191], v[44:47], v[52:55], v[176:191]
  ds_read_b128 v[44:47], v7 offset:48128
  v_exp_f32 v66, v66
  v_exp_f32 v67, v67
  v_exp_f32 v68, v68
  v_smfmac_f32_16x16x64_bf16 v[116:119], v[12:15], v[48:55], v6
  buffer_load_dwordx4 v1, s[32:35], s64 offen offset:3072 sc1 lds
  v_exp_f32 v69, v69
  v_cvt_pk_bf16_f32 v48, v64, v65
  v_cvt_pk_bf16_f32 v49, v66, v67
  v_mfma_f32_32x32x16_bf16 v[80:95], v[16:19], v[104:107], v[144:159]
  ds_read_b128 v[16:19], v7 offset:49152
  v_exp_f32 v70, v70
  v_exp_f32 v71, v71
  v_exp_f32 v72, v72
  v_cvt_pk_bf16_f32 v50, v68, v69
  v_mfma_f32_32x32x16_bf16 v[80:95], v[20:23], v[108:111], v[80:95]
  ds_read_b128 v[20:23], v7 offset:50176
  v_exp_f32 v73, v73
  v_cvt_pk_bf16_f32 v51, v70, v71
  v_exp_f32 v74, v74
  v_exp_f32 v75, v75
  v_cvt_pk_bf16_f32 v52, v72, v73
  v_mfma_f32_32x32x16_bf16 v[160:175], v[24:27], v[48:51], v[160:175]
  s_add_u32 s64, s64, 16384
  s_and_b32 s64, s64, 262143
  v_exp_f32 v76, v76
  v_exp_f32 v77, v77
  v_exp_f32 v78, v78
  v_exp_f32 v79, v79
  v_cvt_pk_bf16_f32 v53, v74, v75
  v_cvt_pk_bf16_f32 v54, v76, v77
  v_cvt_pk_bf16_f32 v55, v78, v79
  v_exp_f32 v80, v80
  v_exp_f32 v81, v81
  s_waitcnt lgkmcnt(3)
  v_mfma_f32_32x32x16_bf16 v[160:175], v[28:31], v[52:55], v[160:175]
  v_exp_f32 v82, v82
  v_exp_f32 v83, v83
  v_exp_f32 v84, v84
  v_smfmac_f32_16x16x64_bf16 v[112:115], v[12:15], v[48:55], v6
  v_exp_f32 v85, v85
  v_cvt_pk_bf16_f32 v48, v80, v81
  v_cvt_pk_bf16_f32 v49, v82, v83
  v_mfma_f32_32x32x16_bf16 v[64:79], v[32:35], v[96:99], v[128:143]
  v_exp_f32 v86, v86
  v_exp_f32 v87, v87
  v_exp_f32 v88, v88
  v_cvt_pk_bf16_f32 v50, v84, v85
  v_mfma_f32_32x32x16_bf16 v[64:79], v[36:39], v[100:103], v[64:79]
  v_exp_f32 v89, v89
  v_cvt_pk_bf16_f32 v51, v86, v87
  v_exp_f32 v90, v90
  v_exp_f32 v91, v91
  v_cvt_pk_bf16_f32 v52, v88, v89
  v_mfma_f32_32x32x16_bf16 v[176:191], v[24:27], v[48:51], v[176:191]
  ds_read_b128 v[24:27], v7 offset:51200
  v_exp_f32 v92, v92
  v_exp_f32 v93, v93
  v_exp_f32 v94, v94
  v_exp_f32 v95, v95
  v_cvt_pk_bf16_f32 v53, v90, v91
  v_cvt_pk_bf16_f32 v54, v92, v93
  v_cvt_pk_bf16_f32 v55, v94, v95
  v_exp_f32 v64, v64
  v_exp_f32 v65, v65
  v_mfma_f32_32x32x16_bf16 v[176:191], v[28:31], v[52:55], v[176:191]
  ds_read_b128 v[28:31], v7 offset:52224
  v_exp_f32 v66, v66
  v_exp_f32 v67, v67
  v_exp_f32 v68, v68
  v_smfmac_f32_16x16x64_bf16 v[116:119], v[12:15], v[48:55], v6
  v_exp_f32 v69, v69
  v_cvt_pk_bf16_f32 v48, v64, v65
  v_cvt_pk_bf16_f32 v49, v66, v67
  v_mfma_f32_32x32x16_bf16 v[80:95], v[32:35], v[104:107], v[144:159]
  ds_read_b128 v[32:35], v7 offset:53248
  v_exp_f32 v70, v70
  v_exp_f32 v71, v71
  v_exp_f32 v72, v72
  v_cvt_pk_bf16_f32 v50, v68, v69
  v_mfma_f32_32x32x16_bf16 v[80:95], v[36:39], v[108:111], v[80:95]
  ds_read_b128 v[36:39], v7 offset:54272
  v_exp_f32 v73, v73
  v_cvt_pk_bf16_f32 v51, v70, v71
  v_exp_f32 v74, v74
  v_exp_f32 v75, v75
  v_cvt_pk_bf16_f32 v52, v72, v73
  v_add_u32 v4, 1, v4
  v_mfma_f32_32x32x16_bf16 v[160:175], v[40:43], v[48:51], v[160:175]
  v_exp_f32 v76, v76
  v_exp_f32 v77, v77
  v_exp_f32 v78, v78
  v_exp_f32 v79, v79
  v_cvt_pk_bf16_f32 v53, v74, v75
  v_cvt_pk_bf16_f32 v54, v76, v77
  v_cvt_pk_bf16_f32 v55, v78, v79
  v_exp_f32 v80, v80
  v_exp_f32 v81, v81
  s_waitcnt vmcnt(4) lgkmcnt(3)
  v_mfma_f32_32x32x16_bf16 v[160:175], v[44:47], v[52:55], v[160:175]
  ds_write_b32 v2, v4
  v_exp_f32 v82, v82
  v_exp_f32 v83, v83
  v_exp_f32 v84, v84
  v_smfmac_f32_16x16x64_bf16 v[112:115], v[12:15], v[48:55], v6
  v_exp_f32 v85, v85
  v_cvt_pk_bf16_f32 v48, v80, v81
  v_cvt_pk_bf16_f32 v49, v82, v83
  v_mfma_f32_32x32x16_bf16 v[64:79], v[16:19], v[96:99], v[128:143]
  v_exp_f32 v86, v86
  v_exp_f32 v87, v87
  v_exp_f32 v88, v88
  v_cvt_pk_bf16_f32 v50, v84, v85
  v_mfma_f32_32x32x16_bf16 v[64:79], v[20:23], v[100:103], v[64:79]
  v_exp_f32 v89, v89
  v_cvt_pk_bf16_f32 v51, v86, v87
  v_exp_f32 v90, v90
  v_exp_f32 v91, v91
  v_cvt_pk_bf16_f32 v52, v88, v89
  v_mfma_f32_32x32x16_bf16 v[176:191], v[40:43], v[48:51], v[176:191]
  ds_read_b128 v[40:43], v7 offset:55296
  v_exp_f32 v92, v92
  v_exp_f32 v93, v93
  v_exp_f32 v94, v94
  v_exp_f32 v95, v95
  v_cvt_pk_bf16_f32 v53, v90, v91
  v_cvt_pk_bf16_f32 v54, v92, v93
  v_cvt_pk_bf16_f32 v55, v94, v95
  v_exp_f32 v64, v64
  v_exp_f32 v65, v65
  v_mfma_f32_32x32x16_bf16 v[176:191], v[44:47], v[52:55], v[176:191]
  ds_read_b128 v[44:47], v7 offset:56320
  v_exp_f32 v66, v66
  v_exp_f32 v67, v67
  v_exp_f32 v68, v68
  v_smfmac_f32_16x16x64_bf16 v[116:119], v[12:15], v[48:55], v6
  v_exp_f32 v69, v69
  v_cvt_pk_bf16_f32 v48, v64, v65
  v_cvt_pk_bf16_f32 v49, v66, v67
  v_mfma_f32_32x32x16_bf16 v[80:95], v[16:19], v[104:107], v[144:159]
  ds_read_b128 v[16:19], v7 offset:57344
  v_exp_f32 v70, v70
  v_exp_f32 v71, v71
  v_exp_f32 v72, v72
  v_cvt_pk_bf16_f32 v50, v68, v69
  v_mfma_f32_32x32x16_bf16 v[80:95], v[20:23], v[108:111], v[80:95]
  ds_read_b128 v[20:23], v7 offset:58368
  v_exp_f32 v73, v73
  v_cvt_pk_bf16_f32 v51, v70, v71
  v_exp_f32 v74, v74
  v_exp_f32 v75, v75
  v_cvt_pk_bf16_f32 v52, v72, v73
  v_mfma_f32_32x32x16_bf16 v[160:175], v[24:27], v[48:51], v[160:175]
  v_exp_f32 v76, v76
  v_exp_f32 v77, v77
  v_exp_f32 v78, v78
  v_exp_f32 v79, v79
  v_cvt_pk_bf16_f32 v53, v74, v75
  v_cvt_pk_bf16_f32 v54, v76, v77
  v_cvt_pk_bf16_f32 v55, v78, v79
  v_exp_f32 v80, v80
  v_exp_f32 v81, v81
  s_waitcnt lgkmcnt(3)
  v_mfma_f32_32x32x16_bf16 v[160:175], v[28:31], v[52:55], v[160:175]
  v_exp_f32 v82, v82
  v_exp_f32 v83, v83
  v_exp_f32 v84, v84
  v_smfmac_f32_16x16x64_bf16 v[112:115], v[12:15], v[48:55], v6
  v_exp_f32 v85, v85
  v_cvt_pk_bf16_f32 v48, v80, v81
  v_cvt_pk_bf16_f32 v49, v82, v83
  v_mfma_f32_32x32x16_bf16 v[64:79], v[32:35], v[96:99], v[128:143]
  v_exp_f32 v86, v86
  v_exp_f32 v87, v87
  v_exp_f32 v88, v88
  v_cvt_pk_bf16_f32 v50, v84, v85
  v_mfma_f32_32x32x16_bf16 v[64:79], v[36:39], v[100:103], v[64:79]
  v_exp_f32 v89, v89
  v_cvt_pk_bf16_f32 v51, v86, v87
  v_exp_f32 v90, v90
  v_exp_f32 v91, v91
  v_cvt_pk_bf16_f32 v52, v88, v89
  v_mfma_f32_32x32x16_bf16 v[176:191], v[24:27], v[48:51], v[176:191]
  ds_read_b128 v[24:27], v7 offset:59392
  v_exp_f32 v92, v92
  v_exp_f32 v93, v93
  v_exp_f32 v94, v94
  v_exp_f32 v95, v95
  v_cvt_pk_bf16_f32 v53, v90, v91
  v_cvt_pk_bf16_f32 v54, v92, v93
  v_cvt_pk_bf16_f32 v55, v94, v95
  v_exp_f32 v64, v64
  v_exp_f32 v65, v65
  v_mfma_f32_32x32x16_bf16 v[176:191], v[28:31], v[52:55], v[176:191]
  ds_read_b128 v[28:31], v7 offset:60416
  v_exp_f32 v66, v66
  v_exp_f32 v67, v67
  v_exp_f32 v68, v68
  v_smfmac_f32_16x16x64_bf16 v[116:119], v[12:15], v[48:55], v6
  ds_read_b32 v5, v3
  v_exp_f32 v69, v69
  v_cvt_pk_bf16_f32 v48, v64, v65
  v_cvt_pk_bf16_f32 v49, v66, v67
  v_mfma_f32_32x32x16_bf16 v[80:95], v[32:35], v[104:107], v[144:159]
  ds_read_b128 v[32:35], v7 offset:61440
  v_exp_f32 v70, v70
  v_exp_f32 v71, v71
  v_exp_f32 v72, v72
  v_cvt_pk_bf16_f32 v50, v68, v69
  v_mfma_f32_32x32x16_bf16 v[80:95], v[36:39], v[108:111], v[80:95]
  ds_read_b128 v[36:39], v7 offset:62464
  v_exp_f32 v73, v73
  v_cvt_pk_bf16_f32 v51, v70, v71
  v_exp_f32 v74, v74
  v_exp_f32 v75, v75
  v_cvt_pk_bf16_f32 v52, v72, v73
  v_mfma_f32_32x32x16_bf16 v[160:175], v[40:43], v[48:51], v[160:175]
  v_exp_f32 v76, v76
  v_exp_f32 v77, v77
  v_exp_f32 v78, v78
  v_exp_f32 v79, v79
  v_cvt_pk_bf16_f32 v53, v74, v75
  v_cvt_pk_bf16_f32 v54, v76, v77
  v_cvt_pk_bf16_f32 v55, v78, v79
  v_exp_f32 v80, v80
  v_exp_f32 v81, v81
  s_waitcnt lgkmcnt(2)
  v_mfma_f32_32x32x16_bf16 v[160:175], v[44:47], v[52:55], v[160:175]
  s_add_u32 m0, s65, 126976
  v_cmp_gt_u32 vcc, v4, v5
  v_exp_f32 v82, v82
  v_exp_f32 v83, v83
  v_exp_f32 v84, v84
  s_cbranch_vccnz parallel_sum__grouped_kv_mqa__mixer_channel_mlp__prompt_kernel_slow1
parallel_sum__grouped_kv_mqa__mixer_channel_mlp__prompt_kernel_slow1_ret:
  v_smfmac_f32_16x16x64_bf16 v[112:115], v[12:15], v[48:55], v6
  buffer_load_dwordx4 v1, s[32:35], s64 offen offset:0 sc1 lds
  v_exp_f32 v85, v85
  v_cvt_pk_bf16_f32 v48, v80, v81
  v_cvt_pk_bf16_f32 v49, v82, v83
  v_mfma_f32_32x32x16_bf16 v[64:79], v[16:19], v[96:99], v[128:143]
  buffer_load_dwordx4 v1, s[32:35], s64 offen offset:1024 sc1 lds
  v_exp_f32 v86, v86
  v_exp_f32 v87, v87
  v_exp_f32 v88, v88
  v_cvt_pk_bf16_f32 v50, v84, v85
  v_mfma_f32_32x32x16_bf16 v[64:79], v[20:23], v[100:103], v[64:79]
  buffer_load_dwordx4 v1, s[32:35], s64 offen offset:2048 sc1 lds
  v_exp_f32 v89, v89
  v_cvt_pk_bf16_f32 v51, v86, v87
  v_exp_f32 v90, v90
  v_exp_f32 v91, v91
  v_cvt_pk_bf16_f32 v52, v88, v89
  v_mfma_f32_32x32x16_bf16 v[176:191], v[40:43], v[48:51], v[176:191]
  ds_read_b128 v[40:43], v7 offset:63488
  v_exp_f32 v92, v92
  v_exp_f32 v93, v93
  v_exp_f32 v94, v94
  v_exp_f32 v95, v95
  v_cvt_pk_bf16_f32 v53, v90, v91
  v_cvt_pk_bf16_f32 v54, v92, v93
  v_cvt_pk_bf16_f32 v55, v94, v95
  v_exp_f32 v64, v64
  v_exp_f32 v65, v65
  v_mfma_f32_32x32x16_bf16 v[176:191], v[44:47], v[52:55], v[176:191]
  ds_read_b128 v[44:47], v7 offset:64512
  v_exp_f32 v66, v66
  v_exp_f32 v67, v67
  v_exp_f32 v68, v68
  v_smfmac_f32_16x16x64_bf16 v[116:119], v[12:15], v[48:55], v6
  buffer_load_dwordx4 v1, s[32:35], s64 offen offset:3072 sc1 lds
  v_exp_f32 v69, v69
  v_cvt_pk_bf16_f32 v48, v64, v65
  v_cvt_pk_bf16_f32 v49, v66, v67
  v_mfma_f32_32x32x16_bf16 v[80:95], v[16:19], v[104:107], v[144:159]
  ds_read_b128 v[16:19], v7 offset:0
  v_exp_f32 v70, v70
  v_exp_f32 v71, v71
  v_exp_f32 v72, v72
  v_cvt_pk_bf16_f32 v50, v68, v69
  v_mfma_f32_32x32x16_bf16 v[80:95], v[20:23], v[108:111], v[80:95]
  ds_read_b128 v[20:23], v7 offset:1024
  v_exp_f32 v73, v73
  v_cvt_pk_bf16_f32 v51, v70, v71
  v_exp_f32 v74, v74
  v_exp_f32 v75, v75
  v_cvt_pk_bf16_f32 v52, v72, v73
  v_mfma_f32_32x32x16_bf16 v[160:175], v[24:27], v[48:51], v[160:175]
  s_add_u32 s64, s64, 16384
  s_and_b32 s64, s64, 262143
  v_exp_f32 v76, v76
  v_exp_f32 v77, v77
  v_exp_f32 v78, v78
  v_exp_f32 v79, v79
  v_cvt_pk_bf16_f32 v53, v74, v75
  v_cvt_pk_bf16_f32 v54, v76, v77
  v_cvt_pk_bf16_f32 v55, v78, v79
  v_exp_f32 v80, v80
  v_exp_f32 v81, v81
  s_waitcnt lgkmcnt(3)
  v_mfma_f32_32x32x16_bf16 v[160:175], v[28:31], v[52:55], v[160:175]
  v_exp_f32 v82, v82
  v_exp_f32 v83, v83
  v_exp_f32 v84, v84
  v_smfmac_f32_16x16x64_bf16 v[112:115], v[12:15], v[48:55], v6
  v_exp_f32 v85, v85
  v_cvt_pk_bf16_f32 v48, v80, v81
  v_cvt_pk_bf16_f32 v49, v82, v83
  v_mfma_f32_32x32x16_bf16 v[64:79], v[32:35], v[96:99], v[128:143]
  v_exp_f32 v86, v86
  v_exp_f32 v87, v87
  v_exp_f32 v88, v88
  v_cvt_pk_bf16_f32 v50, v84, v85
  v_mfma_f32_32x32x16_bf16 v[64:79], v[36:39], v[100:103], v[64:79]
  v_exp_f32 v89, v89
  v_cvt_pk_bf16_f32 v51, v86, v87
  v_exp_f32 v90, v90
  v_exp_f32 v91, v91
  v_cvt_pk_bf16_f32 v52, v88, v89
  v_mfma_f32_32x32x16_bf16 v[176:191], v[24:27], v[48:51], v[176:191]
  ds_read_b128 v[24:27], v7 offset:2048
  v_exp_f32 v92, v92
  v_exp_f32 v93, v93
  v_exp_f32 v94, v94
  v_exp_f32 v95, v95
  v_cvt_pk_bf16_f32 v53, v90, v91
  v_cvt_pk_bf16_f32 v54, v92, v93
  v_cvt_pk_bf16_f32 v55, v94, v95
  v_exp_f32 v64, v64
  v_exp_f32 v65, v65
  v_mfma_f32_32x32x16_bf16 v[176:191], v[28:31], v[52:55], v[176:191]
  ds_read_b128 v[28:31], v7 offset:3072
  v_exp_f32 v66, v66
  v_exp_f32 v67, v67
  v_exp_f32 v68, v68
  v_smfmac_f32_16x16x64_bf16 v[116:119], v[12:15], v[48:55], v6
  v_exp_f32 v69, v69
  v_cvt_pk_bf16_f32 v48, v64, v65
  v_cvt_pk_bf16_f32 v49, v66, v67
  v_mfma_f32_32x32x16_bf16 v[80:95], v[32:35], v[104:107], v[144:159]
  ds_read_b128 v[32:35], v7 offset:4096
  v_exp_f32 v70, v70
  v_exp_f32 v71, v71
  v_exp_f32 v72, v72
  v_cvt_pk_bf16_f32 v50, v68, v69
  v_mfma_f32_32x32x16_bf16 v[80:95], v[36:39], v[108:111], v[80:95]
  ds_read_b128 v[36:39], v7 offset:5120
  v_exp_f32 v73, v73
  v_cvt_pk_bf16_f32 v51, v70, v71
  v_exp_f32 v74, v74
  v_exp_f32 v75, v75
  v_cvt_pk_bf16_f32 v52, v72, v73
  v_add_u32 v4, 1, v4
  v_mfma_f32_32x32x16_bf16 v[160:175], v[40:43], v[48:51], v[160:175]
  v_exp_f32 v76, v76
  v_exp_f32 v77, v77
  v_exp_f32 v78, v78
  v_exp_f32 v79, v79
  v_cvt_pk_bf16_f32 v53, v74, v75
  v_cvt_pk_bf16_f32 v54, v76, v77
  v_cvt_pk_bf16_f32 v55, v78, v79
  v_exp_f32 v80, v80
  v_exp_f32 v81, v81
  s_waitcnt vmcnt(4) lgkmcnt(3)
  v_mfma_f32_32x32x16_bf16 v[160:175], v[44:47], v[52:55], v[160:175]
  ds_write_b32 v2, v4
  v_exp_f32 v82, v82
  v_exp_f32 v83, v83
  v_exp_f32 v84, v84
  v_smfmac_f32_16x16x64_bf16 v[112:115], v[12:15], v[48:55], v6
  v_exp_f32 v85, v85
  v_cvt_pk_bf16_f32 v48, v80, v81
  v_cvt_pk_bf16_f32 v49, v82, v83
  v_mfma_f32_32x32x16_bf16 v[64:79], v[16:19], v[96:99], v[128:143]
  v_exp_f32 v86, v86
  v_exp_f32 v87, v87
  v_exp_f32 v88, v88
  v_cvt_pk_bf16_f32 v50, v84, v85
  v_mfma_f32_32x32x16_bf16 v[64:79], v[20:23], v[100:103], v[64:79]
  v_exp_f32 v89, v89
  v_cvt_pk_bf16_f32 v51, v86, v87
  v_exp_f32 v90, v90
  v_exp_f32 v91, v91
  v_cvt_pk_bf16_f32 v52, v88, v89
  v_mfma_f32_32x32x16_bf16 v[176:191], v[40:43], v[48:51], v[176:191]
  ds_read_b128 v[40:43], v7 offset:6144
  v_exp_f32 v92, v92
  v_exp_f32 v93, v93
  v_exp_f32 v94, v94
  v_exp_f32 v95, v95
  v_cvt_pk_bf16_f32 v53, v90, v91
  v_cvt_pk_bf16_f32 v54, v92, v93
  v_cvt_pk_bf16_f32 v55, v94, v95
  v_exp_f32 v64, v64
  v_exp_f32 v65, v65
  v_mfma_f32_32x32x16_bf16 v[176:191], v[44:47], v[52:55], v[176:191]
  ds_read_b128 v[44:47], v7 offset:7168
  v_exp_f32 v66, v66
  v_exp_f32 v67, v67
  v_exp_f32 v68, v68
  v_smfmac_f32_16x16x64_bf16 v[116:119], v[12:15], v[48:55], v6
  v_exp_f32 v69, v69
  v_cvt_pk_bf16_f32 v48, v64, v65
  v_cvt_pk_bf16_f32 v49, v66, v67
  v_mfma_f32_32x32x16_bf16 v[80:95], v[16:19], v[104:107], v[144:159]
  ds_read_b128 v[16:19], v7 offset:8192
  v_exp_f32 v70, v70
  v_exp_f32 v71, v71
  v_exp_f32 v72, v72
  v_cvt_pk_bf16_f32 v50, v68, v69
  v_mfma_f32_32x32x16_bf16 v[80:95], v[20:23], v[108:111], v[80:95]
  ds_read_b128 v[20:23], v7 offset:9216
  v_exp_f32 v73, v73
  v_cvt_pk_bf16_f32 v51, v70, v71
  v_exp_f32 v74, v74
  v_exp_f32 v75, v75
  v_cvt_pk_bf16_f32 v52, v72, v73
  v_mfma_f32_32x32x16_bf16 v[160:175], v[24:27], v[48:51], v[160:175]
  v_exp_f32 v76, v76
  v_exp_f32 v77, v77
  v_exp_f32 v78, v78
  v_exp_f32 v79, v79
  v_cvt_pk_bf16_f32 v53, v74, v75
  v_cvt_pk_bf16_f32 v54, v76, v77
  v_cvt_pk_bf16_f32 v55, v78, v79
  v_exp_f32 v80, v80
  v_exp_f32 v81, v81
  s_waitcnt lgkmcnt(3)
  v_mfma_f32_32x32x16_bf16 v[160:175], v[28:31], v[52:55], v[160:175]
  v_exp_f32 v82, v82
  v_exp_f32 v83, v83
  v_exp_f32 v84, v84
  v_smfmac_f32_16x16x64_bf16 v[112:115], v[12:15], v[48:55], v6
  v_exp_f32 v85, v85
  v_cvt_pk_bf16_f32 v48, v80, v81
  v_cvt_pk_bf16_f32 v49, v82, v83
  v_mfma_f32_32x32x16_bf16 v[64:79], v[32:35], v[96:99], v[128:143]
  v_exp_f32 v86, v86
  v_exp_f32 v87, v87
  v_exp_f32 v88, v88
  v_cvt_pk_bf16_f32 v50, v84, v85
  v_mfma_f32_32x32x16_bf16 v[64:79], v[36:39], v[100:103], v[64:79]
  v_exp_f32 v89, v89
  v_cvt_pk_bf16_f32 v51, v86, v87
  v_exp_f32 v90, v90
  v_exp_f32 v91, v91
  v_cvt_pk_bf16_f32 v52, v88, v89
  v_mfma_f32_32x32x16_bf16 v[176:191], v[24:27], v[48:51], v[176:191]
  ds_read_b128 v[24:27], v7 offset:10240
  v_exp_f32 v92, v92
  v_exp_f32 v93, v93
  v_exp_f32 v94, v94
  v_exp_f32 v95, v95
  v_cvt_pk_bf16_f32 v53, v90, v91
  v_cvt_pk_bf16_f32 v54, v92, v93
  v_cvt_pk_bf16_f32 v55, v94, v95
  v_exp_f32 v64, v64
  v_exp_f32 v65, v65
  v_mfma_f32_32x32x16_bf16 v[176:191], v[28:31], v[52:55], v[176:191]
  ds_read_b128 v[28:31], v7 offset:11264
  v_exp_f32 v66, v66
  v_exp_f32 v67, v67
  v_exp_f32 v68, v68
  v_smfmac_f32_16x16x64_bf16 v[116:119], v[12:15], v[48:55], v6
  ds_read_b32 v5, v3
  v_exp_f32 v69, v69
  v_cvt_pk_bf16_f32 v48, v64, v65
  v_cvt_pk_bf16_f32 v49, v66, v67
  v_mfma_f32_32x32x16_bf16 v[80:95], v[32:35], v[104:107], v[144:159]
  ds_read_b128 v[32:35], v7 offset:12288
  v_exp_f32 v70, v70
  v_exp_f32 v71, v71
  v_exp_f32 v72, v72
  v_cvt_pk_bf16_f32 v50, v68, v69
  v_mfma_f32_32x32x16_bf16 v[80:95], v[36:39], v[108:111], v[80:95]
  ds_read_b128 v[36:39], v7 offset:13312
  v_exp_f32 v73, v73
  v_cvt_pk_bf16_f32 v51, v70, v71
  v_exp_f32 v74, v74
  v_exp_f32 v75, v75
  v_cvt_pk_bf16_f32 v52, v72, v73
  v_mfma_f32_32x32x16_bf16 v[160:175], v[40:43], v[48:51], v[160:175]
  v_exp_f32 v76, v76
  v_exp_f32 v77, v77
  v_exp_f32 v78, v78
  v_exp_f32 v79, v79
  v_cvt_pk_bf16_f32 v53, v74, v75
  v_cvt_pk_bf16_f32 v54, v76, v77
  v_cvt_pk_bf16_f32 v55, v78, v79
  v_exp_f32 v80, v80
  v_exp_f32 v81, v81
  s_waitcnt lgkmcnt(2)
  v_mfma_f32_32x32x16_bf16 v[160:175], v[44:47], v[52:55], v[160:175]
  s_add_u32 m0, s65, 143360
  v_cmp_gt_u32 vcc, v4, v5
  v_exp_f32 v82, v82
  v_exp_f32 v83, v83
  v_exp_f32 v84, v84
  s_cbranch_vccnz parallel_sum__grouped_kv_mqa__mixer_channel_mlp__prompt_kernel_slow2
parallel_sum__grouped_kv_mqa__mixer_channel_mlp__prompt_kernel_slow2_ret:
  v_smfmac_f32_16x16x64_bf16 v[112:115], v[12:15], v[48:55], v6
  buffer_load_dwordx4 v1, s[32:35], s64 offen offset:0 sc1 lds
  v_exp_f32 v85, v85
  v_cvt_pk_bf16_f32 v48, v80, v81
  v_cvt_pk_bf16_f32 v49, v82, v83
  v_mfma_f32_32x32x16_bf16 v[64:79], v[16:19], v[96:99], v[128:143]
  buffer_load_dwordx4 v1, s[32:35], s64 offen offset:1024 sc1 lds
  v_exp_f32 v86, v86
  v_exp_f32 v87, v87
  v_exp_f32 v88, v88
  v_cvt_pk_bf16_f32 v50, v84, v85
  v_mfma_f32_32x32x16_bf16 v[64:79], v[20:23], v[100:103], v[64:79]
  buffer_load_dwordx4 v1, s[32:35], s64 offen offset:2048 sc1 lds
  v_exp_f32 v89, v89
  v_cvt_pk_bf16_f32 v51, v86, v87
  v_exp_f32 v90, v90
  v_exp_f32 v91, v91
  v_cvt_pk_bf16_f32 v52, v88, v89
  v_mfma_f32_32x32x16_bf16 v[176:191], v[40:43], v[48:51], v[176:191]
  ds_read_b128 v[40:43], v7 offset:14336
  v_exp_f32 v92, v92
  v_exp_f32 v93, v93
  v_exp_f32 v94, v94
  v_exp_f32 v95, v95
  v_cvt_pk_bf16_f32 v53, v90, v91
  v_cvt_pk_bf16_f32 v54, v92, v93
  v_cvt_pk_bf16_f32 v55, v94, v95
  v_exp_f32 v64, v64
  v_exp_f32 v65, v65
  v_mfma_f32_32x32x16_bf16 v[176:191], v[44:47], v[52:55], v[176:191]
  ds_read_b128 v[44:47], v7 offset:15360
  v_exp_f32 v66, v66
  v_exp_f32 v67, v67
  v_exp_f32 v68, v68
  v_smfmac_f32_16x16x64_bf16 v[116:119], v[12:15], v[48:55], v6
  buffer_load_dwordx4 v1, s[32:35], s64 offen offset:3072 sc1 lds
  v_exp_f32 v69, v69
  v_cvt_pk_bf16_f32 v48, v64, v65
  v_cvt_pk_bf16_f32 v49, v66, v67
  v_mfma_f32_32x32x16_bf16 v[80:95], v[16:19], v[104:107], v[144:159]
  ds_read_b128 v[16:19], v7 offset:16384
  v_exp_f32 v70, v70
  v_exp_f32 v71, v71
  v_exp_f32 v72, v72
  v_cvt_pk_bf16_f32 v50, v68, v69
  v_mfma_f32_32x32x16_bf16 v[80:95], v[20:23], v[108:111], v[80:95]
  ds_read_b128 v[20:23], v7 offset:17408
  v_exp_f32 v73, v73
  v_cvt_pk_bf16_f32 v51, v70, v71
  v_exp_f32 v74, v74
  v_exp_f32 v75, v75
  v_cvt_pk_bf16_f32 v52, v72, v73
  v_mfma_f32_32x32x16_bf16 v[160:175], v[24:27], v[48:51], v[160:175]
  s_add_u32 s64, s64, 16384
  s_and_b32 s64, s64, 262143
  v_exp_f32 v76, v76
  v_exp_f32 v77, v77
  v_exp_f32 v78, v78
  v_exp_f32 v79, v79
  v_cvt_pk_bf16_f32 v53, v74, v75
  v_cvt_pk_bf16_f32 v54, v76, v77
  v_cvt_pk_bf16_f32 v55, v78, v79
  v_exp_f32 v80, v80
  v_exp_f32 v81, v81
  s_waitcnt lgkmcnt(3)
  v_mfma_f32_32x32x16_bf16 v[160:175], v[28:31], v[52:55], v[160:175]
  v_exp_f32 v82, v82
  v_exp_f32 v83, v83
  v_exp_f32 v84, v84
  v_smfmac_f32_16x16x64_bf16 v[112:115], v[12:15], v[48:55], v6
  v_exp_f32 v85, v85
  v_cvt_pk_bf16_f32 v48, v80, v81
  v_cvt_pk_bf16_f32 v49, v82, v83
  v_mfma_f32_32x32x16_bf16 v[64:79], v[32:35], v[96:99], v[128:143]
  v_exp_f32 v86, v86
  v_exp_f32 v87, v87
  v_exp_f32 v88, v88
  v_cvt_pk_bf16_f32 v50, v84, v85
  v_mfma_f32_32x32x16_bf16 v[64:79], v[36:39], v[100:103], v[64:79]
  v_exp_f32 v89, v89
  v_cvt_pk_bf16_f32 v51, v86, v87
  v_exp_f32 v90, v90
  v_exp_f32 v91, v91
  v_cvt_pk_bf16_f32 v52, v88, v89
  v_mfma_f32_32x32x16_bf16 v[176:191], v[24:27], v[48:51], v[176:191]
  ds_read_b128 v[24:27], v7 offset:18432
  v_exp_f32 v92, v92
  v_exp_f32 v93, v93
  v_exp_f32 v94, v94
  v_exp_f32 v95, v95
  v_cvt_pk_bf16_f32 v53, v90, v91
  v_cvt_pk_bf16_f32 v54, v92, v93
  v_cvt_pk_bf16_f32 v55, v94, v95
  v_exp_f32 v64, v64
  v_exp_f32 v65, v65
  v_mfma_f32_32x32x16_bf16 v[176:191], v[28:31], v[52:55], v[176:191]
  ds_read_b128 v[28:31], v7 offset:19456
  v_exp_f32 v66, v66
  v_exp_f32 v67, v67
  v_exp_f32 v68, v68
  v_smfmac_f32_16x16x64_bf16 v[116:119], v[12:15], v[48:55], v6
  v_exp_f32 v69, v69
  v_cvt_pk_bf16_f32 v48, v64, v65
  v_cvt_pk_bf16_f32 v49, v66, v67
  v_mfma_f32_32x32x16_bf16 v[80:95], v[32:35], v[104:107], v[144:159]
  ds_read_b128 v[32:35], v7 offset:20480
  v_exp_f32 v70, v70
  v_exp_f32 v71, v71
  v_exp_f32 v72, v72
  v_cvt_pk_bf16_f32 v50, v68, v69
  v_mfma_f32_32x32x16_bf16 v[80:95], v[36:39], v[108:111], v[80:95]
  ds_read_b128 v[36:39], v7 offset:21504
  v_exp_f32 v73, v73
  v_cvt_pk_bf16_f32 v51, v70, v71
  v_exp_f32 v74, v74
  v_exp_f32 v75, v75
  v_cvt_pk_bf16_f32 v52, v72, v73
  v_add_u32 v4, 1, v4
  v_mfma_f32_32x32x16_bf16 v[160:175], v[40:43], v[48:51], v[160:175]
  v_exp_f32 v76, v76
  v_exp_f32 v77, v77
  v_exp_f32 v78, v78
  v_exp_f32 v79, v79
  v_cvt_pk_bf16_f32 v53, v74, v75
  v_cvt_pk_bf16_f32 v54, v76, v77
  v_cvt_pk_bf16_f32 v55, v78, v79
  v_exp_f32 v80, v80
  v_exp_f32 v81, v81
  s_waitcnt vmcnt(4) lgkmcnt(3)
  v_mfma_f32_32x32x16_bf16 v[160:175], v[44:47], v[52:55], v[160:175]
  ds_write_b32 v2, v4
  v_exp_f32 v82, v82
  v_exp_f32 v83, v83
  v_exp_f32 v84, v84
  v_smfmac_f32_16x16x64_bf16 v[112:115], v[12:15], v[48:55], v6
  v_exp_f32 v85, v85
  v_cvt_pk_bf16_f32 v48, v80, v81
  v_cvt_pk_bf16_f32 v49, v82, v83
  v_mfma_f32_32x32x16_bf16 v[64:79], v[16:19], v[96:99], v[128:143]
  v_exp_f32 v86, v86
  v_exp_f32 v87, v87
  v_exp_f32 v88, v88
  v_cvt_pk_bf16_f32 v50, v84, v85
  v_mfma_f32_32x32x16_bf16 v[64:79], v[20:23], v[100:103], v[64:79]
  v_exp_f32 v89, v89
  v_cvt_pk_bf16_f32 v51, v86, v87
  v_exp_f32 v90, v90
  v_exp_f32 v91, v91
  v_cvt_pk_bf16_f32 v52, v88, v89
  v_mfma_f32_32x32x16_bf16 v[176:191], v[40:43], v[48:51], v[176:191]
  ds_read_b128 v[40:43], v7 offset:22528
  v_exp_f32 v92, v92
  v_exp_f32 v93, v93
  v_exp_f32 v94, v94
  v_exp_f32 v95, v95
  v_cvt_pk_bf16_f32 v53, v90, v91
  v_cvt_pk_bf16_f32 v54, v92, v93
  v_cvt_pk_bf16_f32 v55, v94, v95
  v_exp_f32 v64, v64
  v_exp_f32 v65, v65
  v_mfma_f32_32x32x16_bf16 v[176:191], v[44:47], v[52:55], v[176:191]
  ds_read_b128 v[44:47], v7 offset:23552
  v_exp_f32 v66, v66
  v_exp_f32 v67, v67
  v_exp_f32 v68, v68
  v_smfmac_f32_16x16x64_bf16 v[116:119], v[12:15], v[48:55], v6
  v_exp_f32 v69, v69
  v_cvt_pk_bf16_f32 v48, v64, v65
  v_cvt_pk_bf16_f32 v49, v66, v67
  v_mfma_f32_32x32x16_bf16 v[80:95], v[16:19], v[104:107], v[144:159]
  ds_read_b128 v[16:19], v7 offset:24576
  v_exp_f32 v70, v70
  v_exp_f32 v71, v71
  v_exp_f32 v72, v72
  v_cvt_pk_bf16_f32 v50, v68, v69
  v_mfma_f32_32x32x16_bf16 v[80:95], v[20:23], v[108:111], v[80:95]
  ds_read_b128 v[20:23], v7 offset:25600
  v_exp_f32 v73, v73
  v_cvt_pk_bf16_f32 v51, v70, v71
  v_exp_f32 v74, v74
  v_exp_f32 v75, v75
  v_cvt_pk_bf16_f32 v52, v72, v73
  v_mfma_f32_32x32x16_bf16 v[160:175], v[24:27], v[48:51], v[160:175]
  v_exp_f32 v76, v76
  v_exp_f32 v77, v77
  v_exp_f32 v78, v78
  v_exp_f32 v79, v79
  v_cvt_pk_bf16_f32 v53, v74, v75
  v_cvt_pk_bf16_f32 v54, v76, v77
  v_cvt_pk_bf16_f32 v55, v78, v79
  v_exp_f32 v80, v80
  v_exp_f32 v81, v81
  s_waitcnt lgkmcnt(3)
  v_mfma_f32_32x32x16_bf16 v[160:175], v[28:31], v[52:55], v[160:175]
  v_exp_f32 v82, v82
  v_exp_f32 v83, v83
  v_exp_f32 v84, v84
  v_smfmac_f32_16x16x64_bf16 v[112:115], v[12:15], v[48:55], v6
  v_exp_f32 v85, v85
  v_cvt_pk_bf16_f32 v48, v80, v81
  v_cvt_pk_bf16_f32 v49, v82, v83
  v_mfma_f32_32x32x16_bf16 v[64:79], v[32:35], v[96:99], v[128:143]
  v_exp_f32 v86, v86
  v_exp_f32 v87, v87
  v_exp_f32 v88, v88
  v_cvt_pk_bf16_f32 v50, v84, v85
  v_mfma_f32_32x32x16_bf16 v[64:79], v[36:39], v[100:103], v[64:79]
  v_exp_f32 v89, v89
  v_cvt_pk_bf16_f32 v51, v86, v87
  v_exp_f32 v90, v90
  v_exp_f32 v91, v91
  v_cvt_pk_bf16_f32 v52, v88, v89
  v_mfma_f32_32x32x16_bf16 v[176:191], v[24:27], v[48:51], v[176:191]
  ds_read_b128 v[24:27], v7 offset:26624
  v_exp_f32 v92, v92
  v_exp_f32 v93, v93
  v_exp_f32 v94, v94
  v_exp_f32 v95, v95
  v_cvt_pk_bf16_f32 v53, v90, v91
  v_cvt_pk_bf16_f32 v54, v92, v93
  v_cvt_pk_bf16_f32 v55, v94, v95
  v_exp_f32 v64, v64
  v_exp_f32 v65, v65
  v_mfma_f32_32x32x16_bf16 v[176:191], v[28:31], v[52:55], v[176:191]
  ds_read_b128 v[28:31], v7 offset:27648
  v_exp_f32 v66, v66
  v_exp_f32 v67, v67
  v_exp_f32 v68, v68
  v_smfmac_f32_16x16x64_bf16 v[116:119], v[12:15], v[48:55], v6
  ds_read_b32 v5, v3
  v_exp_f32 v69, v69
  v_cvt_pk_bf16_f32 v48, v64, v65
  v_cvt_pk_bf16_f32 v49, v66, v67
  v_mfma_f32_32x32x16_bf16 v[80:95], v[32:35], v[104:107], v[144:159]
  ds_read_b128 v[32:35], v7 offset:28672
  v_exp_f32 v70, v70
  v_exp_f32 v71, v71
  v_exp_f32 v72, v72
  v_cvt_pk_bf16_f32 v50, v68, v69
  v_mfma_f32_32x32x16_bf16 v[80:95], v[36:39], v[108:111], v[80:95]
  ds_read_b128 v[36:39], v7 offset:29696
  v_exp_f32 v73, v73
  v_cvt_pk_bf16_f32 v51, v70, v71
  v_exp_f32 v74, v74
  v_exp_f32 v75, v75
  v_cvt_pk_bf16_f32 v52, v72, v73
  v_mfma_f32_32x32x16_bf16 v[160:175], v[40:43], v[48:51], v[160:175]
  v_exp_f32 v76, v76
  v_exp_f32 v77, v77
  v_exp_f32 v78, v78
  v_exp_f32 v79, v79
  v_cvt_pk_bf16_f32 v53, v74, v75
  v_cvt_pk_bf16_f32 v54, v76, v77
  v_cvt_pk_bf16_f32 v55, v78, v79
  v_exp_f32 v80, v80
  v_exp_f32 v81, v81
  s_waitcnt lgkmcnt(2)
  v_mfma_f32_32x32x16_bf16 v[160:175], v[44:47], v[52:55], v[160:175]
  s_add_u32 m0, s65, 94208
  v_cmp_gt_u32 vcc, v4, v5
  v_exp_f32 v82, v82
  v_exp_f32 v83, v83
  v_exp_f32 v84, v84
  s_cbranch_vccnz parallel_sum__grouped_kv_mqa__mixer_channel_mlp__prompt_kernel_slow3
parallel_sum__grouped_kv_mqa__mixer_channel_mlp__prompt_kernel_slow3_ret:
  v_smfmac_f32_16x16x64_bf16 v[112:115], v[12:15], v[48:55], v6
  buffer_load_dwordx4 v1, s[32:35], s64 offen offset:0 sc1 lds
  v_exp_f32 v85, v85
  v_cvt_pk_bf16_f32 v48, v80, v81
  v_cvt_pk_bf16_f32 v49, v82, v83
  v_mfma_f32_32x32x16_bf16 v[64:79], v[16:19], v[96:99], v[128:143]
  buffer_load_dwordx4 v1, s[32:35], s64 offen offset:1024 sc1 lds
  v_exp_f32 v86, v86
  v_exp_f32 v87, v87
  v_exp_f32 v88, v88
  v_cvt_pk_bf16_f32 v50, v84, v85
  v_mfma_f32_32x32x16_bf16 v[64:79], v[20:23], v[100:103], v[64:79]
  buffer_load_dwordx4 v1, s[32:35], s64 offen offset:2048 sc1 lds
  v_exp_f32 v89, v89
  v_cvt_pk_bf16_f32 v51, v86, v87
  v_exp_f32 v90, v90
  v_exp_f32 v91, v91
  v_cvt_pk_bf16_f32 v52, v88, v89
  v_mfma_f32_32x32x16_bf16 v[176:191], v[40:43], v[48:51], v[176:191]
  ds_read_b128 v[40:43], v7 offset:30720
  v_exp_f32 v92, v92
  v_exp_f32 v93, v93
  v_exp_f32 v94, v94
  v_exp_f32 v95, v95
  v_cvt_pk_bf16_f32 v53, v90, v91
  v_cvt_pk_bf16_f32 v54, v92, v93
  v_cvt_pk_bf16_f32 v55, v94, v95
  v_exp_f32 v64, v64
  v_exp_f32 v65, v65
  v_mfma_f32_32x32x16_bf16 v[176:191], v[44:47], v[52:55], v[176:191]
  ds_read_b128 v[44:47], v7 offset:31744
  v_exp_f32 v66, v66
  v_exp_f32 v67, v67
  v_exp_f32 v68, v68
  v_smfmac_f32_16x16x64_bf16 v[116:119], v[12:15], v[48:55], v6
  buffer_load_dwordx4 v1, s[32:35], s64 offen offset:3072 sc1 lds
  v_exp_f32 v69, v69
  v_cvt_pk_bf16_f32 v48, v64, v65
  v_cvt_pk_bf16_f32 v49, v66, v67
  v_mfma_f32_32x32x16_bf16 v[80:95], v[16:19], v[104:107], v[144:159]
  ds_read_b128 v[16:19], v7 offset:32768
  v_exp_f32 v70, v70
  v_exp_f32 v71, v71
  v_exp_f32 v72, v72
  v_cvt_pk_bf16_f32 v50, v68, v69
  v_mfma_f32_32x32x16_bf16 v[80:95], v[20:23], v[108:111], v[80:95]
  ds_read_b128 v[20:23], v7 offset:33792
  v_exp_f32 v73, v73
  v_cvt_pk_bf16_f32 v51, v70, v71
  v_exp_f32 v74, v74
  v_exp_f32 v75, v75
  v_cvt_pk_bf16_f32 v52, v72, v73
  v_mfma_f32_32x32x16_bf16 v[160:175], v[24:27], v[48:51], v[160:175]
  s_add_u32 s64, s64, 16384
  s_and_b32 s64, s64, 262143
  v_exp_f32 v76, v76
  v_exp_f32 v77, v77
  v_exp_f32 v78, v78
  v_exp_f32 v79, v79
  v_cvt_pk_bf16_f32 v53, v74, v75
  v_cvt_pk_bf16_f32 v54, v76, v77
  v_cvt_pk_bf16_f32 v55, v78, v79
  v_exp_f32 v80, v80
  v_exp_f32 v81, v81
  s_waitcnt lgkmcnt(3)
  v_mfma_f32_32x32x16_bf16 v[160:175], v[28:31], v[52:55], v[160:175]
  v_exp_f32 v82, v82
  v_exp_f32 v83, v83
  v_exp_f32 v84, v84
  v_smfmac_f32_16x16x64_bf16 v[112:115], v[12:15], v[48:55], v6
  v_exp_f32 v85, v85
  v_cvt_pk_bf16_f32 v48, v80, v81
  v_cvt_pk_bf16_f32 v49, v82, v83
  v_mfma_f32_32x32x16_bf16 v[64:79], v[32:35], v[96:99], v[128:143]
  v_exp_f32 v86, v86
  v_exp_f32 v87, v87
  v_exp_f32 v88, v88
  v_cvt_pk_bf16_f32 v50, v84, v85
  v_mfma_f32_32x32x16_bf16 v[64:79], v[36:39], v[100:103], v[64:79]
  v_exp_f32 v89, v89
  v_cvt_pk_bf16_f32 v51, v86, v87
  v_exp_f32 v90, v90
  v_exp_f32 v91, v91
  v_cvt_pk_bf16_f32 v52, v88, v89
  v_mfma_f32_32x32x16_bf16 v[176:191], v[24:27], v[48:51], v[176:191]
  ds_read_b128 v[24:27], v7 offset:34816
  v_exp_f32 v92, v92
  v_exp_f32 v93, v93
  v_exp_f32 v94, v94
  v_exp_f32 v95, v95
  v_cvt_pk_bf16_f32 v53, v90, v91
  v_cvt_pk_bf16_f32 v54, v92, v93
  v_cvt_pk_bf16_f32 v55, v94, v95
  v_exp_f32 v64, v64
  v_exp_f32 v65, v65
  v_mfma_f32_32x32x16_bf16 v[176:191], v[28:31], v[52:55], v[176:191]
  ds_read_b128 v[28:31], v7 offset:35840
  v_exp_f32 v66, v66
  v_exp_f32 v67, v67
  v_exp_f32 v68, v68
  v_smfmac_f32_16x16x64_bf16 v[116:119], v[12:15], v[48:55], v6
  v_exp_f32 v69, v69
  v_cvt_pk_bf16_f32 v48, v64, v65
  v_cvt_pk_bf16_f32 v49, v66, v67
  v_mfma_f32_32x32x16_bf16 v[80:95], v[32:35], v[104:107], v[144:159]
  ds_read_b128 v[32:35], v7 offset:36864
  v_exp_f32 v70, v70
  v_exp_f32 v71, v71
  v_exp_f32 v72, v72
  v_cvt_pk_bf16_f32 v50, v68, v69
  v_mfma_f32_32x32x16_bf16 v[80:95], v[36:39], v[108:111], v[80:95]
  ds_read_b128 v[36:39], v7 offset:37888
  v_exp_f32 v73, v73
  v_cvt_pk_bf16_f32 v51, v70, v71
  v_exp_f32 v74, v74
  v_exp_f32 v75, v75
  v_cvt_pk_bf16_f32 v52, v72, v73
  v_add_u32 v4, 1, v4
  v_mfma_f32_32x32x16_bf16 v[160:175], v[40:43], v[48:51], v[160:175]
  v_exp_f32 v76, v76
  v_exp_f32 v77, v77
  v_exp_f32 v78, v78
  v_exp_f32 v79, v79
  v_cvt_pk_bf16_f32 v53, v74, v75
  v_cvt_pk_bf16_f32 v54, v76, v77
  v_cvt_pk_bf16_f32 v55, v78, v79
  v_exp_f32 v80, v80
  v_exp_f32 v81, v81
  s_waitcnt vmcnt(4) lgkmcnt(3)
  v_mfma_f32_32x32x16_bf16 v[160:175], v[44:47], v[52:55], v[160:175]
  ds_write_b32 v2, v4
  v_exp_f32 v82, v82
  v_exp_f32 v83, v83
  v_exp_f32 v84, v84
  v_smfmac_f32_16x16x64_bf16 v[112:115], v[12:15], v[48:55], v6
  v_exp_f32 v85, v85
  v_cvt_pk_bf16_f32 v48, v80, v81
  v_cvt_pk_bf16_f32 v49, v82, v83
  v_mfma_f32_32x32x16_bf16 v[64:79], v[16:19], v[96:99], v[128:143]
  v_exp_f32 v86, v86
  v_exp_f32 v87, v87
  v_exp_f32 v88, v88
  v_cvt_pk_bf16_f32 v50, v84, v85
  v_mfma_f32_32x32x16_bf16 v[64:79], v[20:23], v[100:103], v[64:79]
  v_exp_f32 v89, v89
  v_cvt_pk_bf16_f32 v51, v86, v87
  v_exp_f32 v90, v90
  v_exp_f32 v91, v91
  v_cvt_pk_bf16_f32 v52, v88, v89
  v_mfma_f32_32x32x16_bf16 v[176:191], v[40:43], v[48:51], v[176:191]
  ds_read_b128 v[40:43], v7 offset:38912
  v_exp_f32 v92, v92
  v_exp_f32 v93, v93
  v_exp_f32 v94, v94
  v_exp_f32 v95, v95
  v_cvt_pk_bf16_f32 v53, v90, v91
  v_cvt_pk_bf16_f32 v54, v92, v93
  v_cvt_pk_bf16_f32 v55, v94, v95
  s_sub_u32 s63, s63, 1
  s_cmp_lg_u32 s63, 0
  s_cbranch_scc1 parallel_sum__grouped_kv_mqa__mixer_channel_mlp__prompt_kernel_aloop
  v_mfma_f32_32x32x16_bf16 v[176:191], v[44:47], v[52:55], v[176:191]
  v_smfmac_f32_16x16x64_bf16 v[116:119], v[12:15], v[48:55], v6
  v_mov_b32 v5, 0x53800000
  v_and_b32 v3, 15, v0
  v_lshlrev_b32 v3, 4, v3
  v_bfe_u32 v9, v0, 4, 1
  v_lshl_add_u32 v3, v9, 10, v3
  v_lshrrev_b32 v9, 5, v0
  v_lshl_add_u32 v3, v9, 8, v3
  v_add_f32 v112, v112, v113
  v_cmp_nle_f32 vcc, v112, v5
  s_nop 1
  s_cbranch_vccnz parallel_sum__grouped_kv_mqa__mixer_channel_mlp__prompt_kernel_fb0
parallel_sum__grouped_kv_mqa__mixer_channel_mlp__prompt_kernel_ok0:
  v_rcp_f32 v8, v112
  s_nop 0
  v_mul_f32 v160, v160, v8
  v_mul_f32 v161, v161, v8
  v_mul_f32 v162, v162, v8
  v_mul_f32 v163, v163, v8
  v_mul_f32 v164, v164, v8
  v_mul_f32 v165, v165, v8
  v_mul_f32 v166, v166, v8
  v_mul_f32 v167, v167, v8
  v_mul_f32 v168, v168, v8
  v_mul_f32 v169, v169, v8
  v_mul_f32 v170, v170, v8
  v_mul_f32 v171, v171, v8
  v_mul_f32 v172, v172, v8
  v_mul_f32 v173, v173, v8
  v_mul_f32 v174, v174, v8
  v_mul_f32 v175, v175, v8
  v_cvt_pk_bf16_f32 v80, v160, v161
  v_cvt_pk_bf16_f32 v81, v162, v163
  v_cvt_pk_bf16_f32 v82, v164, v165
  v_cvt_pk_bf16_f32 v83, v166, v167
  v_cvt_pk_bf16_f32 v84, v168, v169
  v_cvt_pk_bf16_f32 v85, v170, v171
  v_cvt_pk_bf16_f32 v86, v172, v173
  v_cvt_pk_bf16_f32 v87, v174, v175
  buffer_store_dwordx4 v[80:83], v3, s[36:39], s67 offen offset:0 sc1
  buffer_store_dwordx4 v[84:87], v3, s[36:39], s67 offen offset:512 sc1
  s_nop 3
  v_add_f32 v116, v116, v117
  v_cmp_nle_f32 vcc, v116, v5
  s_nop 1
  s_cbranch_vccnz parallel_sum__grouped_kv_mqa__mixer_channel_mlp__prompt_kernel_fb1
parallel_sum__grouped_kv_mqa__mixer_channel_mlp__prompt_kernel_ok1:
  v_rcp_f32 v8, v116
  s_nop 0
  v_mul_f32 v176, v176, v8
  v_mul_f32 v177, v177, v8
  v_mul_f32 v178, v178, v8
  v_mul_f32 v179, v179, v8
  v_mul_f32 v180, v180, v8
  v_mul_f32 v181, v181, v8
  v_mul_f32 v182, v182, v8
  v_mul_f32 v183, v183, v8
  v_mul_f32 v184, v184, v8
  v_mul_f32 v185, v185, v8
  v_mul_f32 v186, v186, v8
  v_mul_f32 v187, v187, v8
  v_mul_f32 v188, v188, v8
  v_mul_f32 v189, v189, v8
  v_mul_f32 v190, v190, v8
  v_mul_f32 v191, v191, v8
  v_cvt_pk_bf16_f32 v88, v176, v177
  v_cvt_pk_bf16_f32 v89, v178, v179
  v_cvt_pk_bf16_f32 v90, v180, v181
  v_cvt_pk_bf16_f32 v91, v182, v183
  v_cvt_pk_bf16_f32 v92, v184, v185
  v_cvt_pk_bf16_f32 v93, v186, v187
  v_cvt_pk_bf16_f32 v94, v188, v189
  v_cvt_pk_bf16_f32 v95, v190, v191
  buffer_store_dwordx4 v[88:91], v3, s[36:39], s67 offen offset:2048 sc1
  buffer_store_dwordx4 v[92:95], v3, s[36:39], s67 offen offset:2560 sc1
  s_mul_i32 s57, s50, 1024
  s_lshl_b32 s58, s51, 1
  s_add_u32 s57, s57, s58
  s_and_b32 s58, s70, 1
  s_add_u32 s57, s57, s58
  s_add_u32 s57, s57, 23642112
  v_mov_b32 v8, 1
  v_lshlrev_b32 v9, 24, v0
  s_waitcnt vmcnt(0) lgkmcnt(0)
  buffer_store_byte v8, v9, s[36:39], s57 offen sc1
  ds_write_b32 v2, v4 offset:24
  s_cmp_eq_u32 s70, 0
  s_cbranch_scc0 parallel_sum__grouped_kv_mqa__mixer_channel_mlp__prompt_kernel_attdone
  s_mul_i32 s60, s48, 1024
  s_add_u32 s60, s60, 23642112
  v_lshrrev_b32 v8, 5, v0
  v_lshlrev_b32 v9, 1, v0
  v_lshl_add_u32 v9, v8, 24, v9
  s_mov_b32 s68, 0
  s_setprio 0
parallel_sum__grouped_kv_mqa__mixer_channel_mlp__prompt_kernel_ogate:
  ds_read_b32 v8, v10 offset:4
  s_add_u32 s68, s68, 1
  s_cmp_gt_u32 s68, 0x400000
  s_cbranch_scc1 parallel_sum__grouped_kv_mqa__mixer_channel_mlp__prompt_kernel_ogo
  s_waitcnt lgkmcnt(0)
  v_cmp_gt_u32 vcc, 2, v8
  s_nop 1
  s_cbranch_vccz parallel_sum__grouped_kv_mqa__mixer_channel_mlp__prompt_kernel_ogo
  s_sleep 4
  s_branch parallel_sum__grouped_kv_mqa__mixer_channel_mlp__prompt_kernel_ogate
parallel_sum__grouped_kv_mqa__mixer_channel_mlp__prompt_kernel_ogo:
  ds_write_b32 v10, v4 offset:24
  s_setprio 2
  s_mov_b32 s68, 0
parallel_sum__grouped_kv_mqa__mixer_channel_mlp__prompt_kernel_opoll:
  buffer_load_ushort v8, v9, s[36:39], s60 offen sc1
  s_add_u32 s68, s68, 1
  s_waitcnt vmcnt(0)
  v_cmp_eq_u32 vcc, 0x0101, v8
  s_nop 1
  v_mov_b32 v8, vcc_lo
  s_mov_b64 exec, 1
  ds_or_b32 v10, v8 offset:8
  s_mov_b64 exec, -1
  s_cmp_eq_u32 vcc_lo, -1
  s_cbranch_scc1 parallel_sum__grouped_kv_mqa__mixer_channel_mlp__prompt_kernel_attdone
  s_cmp_gt_u32 s68, 0x100000
  s_cbranch_scc1 parallel_sum__grouped_kv_mqa__mixer_channel_mlp__prompt_kernel_attdone
  s_sleep 6
  s_branch parallel_sum__grouped_kv_mqa__mixer_channel_mlp__prompt_kernel_opoll
parallel_sum__grouped_kv_mqa__mixer_channel_mlp__prompt_kernel_slow0:
  s_mov_b32 s68, 0
parallel_sum__grouped_kv_mqa__mixer_channel_mlp__prompt_kernel_slow0_l:
  ds_read_b32 v5, v3
  s_add_u32 s68, s68, 1
  s_cmp_gt_u32 s68, 0x400000
  s_cbranch_scc1 parallel_sum__grouped_kv_mqa__mixer_channel_mlp__prompt_kernel_slow0_ret
  s_waitcnt lgkmcnt(0)
  v_cmp_gt_u32 vcc, v4, v5
  s_nop 1
  s_cbranch_vccnz parallel_sum__grouped_kv_mqa__mixer_channel_mlp__prompt_kernel_slow0_l
  s_branch parallel_sum__grouped_kv_mqa__mixer_channel_mlp__prompt_kernel_slow0_ret
parallel_sum__grouped_kv_mqa__mixer_channel_mlp__prompt_kernel_slow1:
  s_mov_b32 s68, 0
parallel_sum__grouped_kv_mqa__mixer_channel_mlp__prompt_kernel_slow1_l:
  ds_read_b32 v5, v3
  s_add_u32 s68, s68, 1
  s_cmp_gt_u32 s68, 0x400000
  s_cbranch_scc1 parallel_sum__grouped_kv_mqa__mixer_channel_mlp__prompt_kernel_slow1_ret
  s_waitcnt lgkmcnt(0)
  v_cmp_gt_u32 vcc, v4, v5
  s_nop 1
  s_cbranch_vccnz parallel_sum__grouped_kv_mqa__mixer_channel_mlp__prompt_kernel_slow1_l
  s_branch parallel_sum__grouped_kv_mqa__mixer_channel_mlp__prompt_kernel_slow1_ret
parallel_sum__grouped_kv_mqa__mixer_channel_mlp__prompt_kernel_slow2:
  s_mov_b32 s68, 0
parallel_sum__grouped_kv_mqa__mixer_channel_mlp__prompt_kernel_slow2_l:
  ds_read_b32 v5, v3
  s_add_u32 s68, s68, 1
  s_cmp_gt_u32 s68, 0x400000
  s_cbranch_scc1 parallel_sum__grouped_kv_mqa__mixer_channel_mlp__prompt_kernel_slow2_ret
  s_waitcnt lgkmcnt(0)
  v_cmp_gt_u32 vcc, v4, v5
  s_nop 1
  s_cbranch_vccnz parallel_sum__grouped_kv_mqa__mixer_channel_mlp__prompt_kernel_slow2_l
  s_branch parallel_sum__grouped_kv_mqa__mixer_channel_mlp__prompt_kernel_slow2_ret
parallel_sum__grouped_kv_mqa__mixer_channel_mlp__prompt_kernel_slow3:
  s_mov_b32 s68, 0
parallel_sum__grouped_kv_mqa__mixer_channel_mlp__prompt_kernel_slow3_l:
  ds_read_b32 v5, v3
  s_add_u32 s68, s68, 1
  s_cmp_gt_u32 s68, 0x400000
  s_cbranch_scc1 parallel_sum__grouped_kv_mqa__mixer_channel_mlp__prompt_kernel_slow3_ret
  s_waitcnt lgkmcnt(0)
  v_cmp_gt_u32 vcc, v4, v5
  s_nop 1
  s_cbranch_vccnz parallel_sum__grouped_kv_mqa__mixer_channel_mlp__prompt_kernel_slow3_l
  s_branch parallel_sum__grouped_kv_mqa__mixer_channel_mlp__prompt_kernel_slow3_ret
parallel_sum__grouped_kv_mqa__mixer_channel_mlp__prompt_kernel_fb0:
  s_nop 15
  v_mov_b32 v11, 0xff800000
  s_mov_b32 s59, 0
parallel_sum__grouped_kv_mqa__mixer_channel_mlp__prompt_kernel_fb1_0:
  buffer_load_dwordx4 v[192:195], v1, s[32:35], s59 offen offset:0 sc1
  buffer_load_dwordx4 v[196:199], v1, s[32:35], s59 offen offset:1024 sc1
  s_waitcnt vmcnt(0)
  v_mfma_f32_32x32x16_bf16 v[208:223], v[192:195], v[96:99], 0
  v_mfma_f32_32x32x16_bf16 v[208:223], v[196:199], v[100:103], v[208:223]
  s_nop 15
  v_max3_f32 v8, v208, v209, v210
  v_max3_f32 v8, v8, v211, v212
  v_max3_f32 v8, v8, v213, v214
  v_max3_f32 v8, v8, v215, v216
  v_max3_f32 v8, v8, v217, v218
  v_max3_f32 v8, v8, v219, v220
  v_max3_f32 v8, v8, v221, v222
  v_max_f32 v8, v8, v223
  v_max_f32 v11, v11, v8
  s_add_u32 s59, s59, 4096
  s_cmp_lt_u32 s59, 262144
  s_cbranch_scc1 parallel_sum__grouped_kv_mqa__mixer_channel_mlp__prompt_kernel_fb1_0
  v_mov_b32 v9, v11
  s_nop 1
  v_permlane32_swap_b32 v11, v9
  s_nop 1
  v_max_f32 v11, v11, v9
  v_sub_f32 v128, 0, v11
  v_sub_f32 v129, 0, v11
  v_sub_f32 v130, 0, v11
  v_sub_f32 v131, 0, v11
  v_sub_f32 v132, 0, v11
  v_sub_f32 v133, 0, v11
  v_sub_f32 v134, 0, v11
  v_sub_f32 v135, 0, v11
  v_sub_f32 v136, 0, v11
  v_sub_f32 v137, 0, v11
  v_sub_f32 v138, 0, v11
  v_sub_f32 v139, 0, v11
  v_sub_f32 v140, 0, v11
  v_sub_f32 v141, 0, v11
  v_sub_f32 v142, 0, v11
  v_sub_f32 v143, 0, v11
  v_mov_b32 v160, 0
  v_mov_b32 v161, 0
  v_mov_b32 v162, 0
  v_mov_b32 v163, 0
  v_mov_b32 v164, 0
  v_mov_b32 v165, 0
  v_mov_b32 v166, 0
  v_mov_b32 v167, 0
  v_mov_b32 v168, 0
  v_mov_b32 v169, 0
  v_mov_b32 v170, 0
  v_mov_b32 v171, 0
  v_mov_b32 v172, 0
  v_mov_b32 v173, 0
  v_mov_b32 v174, 0
  v_mov_b32 v175, 0
  v_mov_b32 v112, 0
  v_mov_b32 v113, 0
  v_mov_b32 v114, 0
  v_mov_b32 v115, 0
  s_mov_b32 s59, 0
parallel_sum__grouped_kv_mqa__mixer_channel_mlp__prompt_kernel_fb2_0:
  buffer_load_dwordx4 v[192:195], v1, s[32:35], s59 offen offset:0 sc1
  buffer_load_dwordx4 v[196:199], v1, s[32:35], s59 offen offset:1024 sc1
  buffer_load_dwordx4 v[200:203], v1, s[32:35], s59 offen offset:2048 sc1
  buffer_load_dwordx4 v[204:207], v1, s[32:35], s59 offen offset:3072 sc1
  s_waitcnt vmcnt(0)
  v_mfma_f32_32x32x16_bf16 v[208:223], v[192:195], v[96:99], v[128:143]
  v_mfma_f32_32x32x16_bf16 v[208:223], v[196:199], v[100:103], v[208:223]
  s_nop 15
  v_exp_f32 v208, v208
  v_exp_f32 v209, v209
  v_exp_f32 v210, v210
  v_exp_f32 v211, v211
  v_exp_f32 v212, v212
  v_exp_f32 v213, v213
  v_exp_f32 v214, v214
  v_exp_f32 v215, v215
  v_exp_f32 v216, v216
  v_exp_f32 v217, v217
  v_exp_f32 v218, v218
  v_exp_f32 v219, v219
  v_exp_f32 v220, v220
  v_exp_f32 v221, v221
  v_exp_f32 v222, v222
  v_exp_f32 v223, v223
  s_nop 0
  v_cvt_pk_bf16_f32 v224, v208, v209
  v_cvt_pk_bf16_f32 v225, v210, v211
  v_cvt_pk_bf16_f32 v226, v212, v213
  v_cvt_pk_bf16_f32 v227, v214, v215
  v_cvt_pk_bf16_f32 v228, v216, v217
  v_cvt_pk_bf16_f32 v229, v218, v219
  v_cvt_pk_bf16_f32 v230, v220, v221
  v_cvt_pk_bf16_f32 v231, v222, v223
  s_nop 1
  v_mfma_f32_32x32x16_bf16 v[160:175], v[200:203], v[224:227], v[160:175]
  v_mfma_f32_32x32x16_bf16 v[160:175], v[204:207], v[228:231], v[160:175]
  v_smfmac_f32_16x16x64_bf16 v[112:115], v[12:15], v[224:231], v6
  s_nop 7
  s_add_u32 s59, s59, 4096
  s_cmp_lt_u32 s59, 262144
  s_cbranch_scc1 parallel_sum__grouped_kv_mqa__mixer_channel_mlp__prompt_kernel_fb2_0
  s_nop 15
  v_add_f32 v112, v112, v113
  s_branch parallel_sum__grouped_kv_mqa__mixer_channel_mlp__prompt_kernel_ok0
parallel_sum__grouped_kv_mqa__mixer_channel_mlp__prompt_kernel_fb1:
  s_nop 15
  v_mov_b32 v11, 0xff800000
  s_mov_b32 s59, 0
parallel_sum__grouped_kv_mqa__mixer_channel_mlp__prompt_kernel_fb1_1:
  buffer_load_dwordx4 v[192:195], v1, s[32:35], s59 offen offset:0 sc1
  buffer_load_dwordx4 v[196:199], v1, s[32:35], s59 offen offset:1024 sc1
  s_waitcnt vmcnt(0)
  v_mfma_f32_32x32x16_bf16 v[208:223], v[192:195], v[104:107], 0
  v_mfma_f32_32x32x16_bf16 v[208:223], v[196:199], v[108:111], v[208:223]
  s_nop 15
  v_max3_f32 v8, v208, v209, v210
  v_max3_f32 v8, v8, v211, v212
  v_max3_f32 v8, v8, v213, v214
  v_max3_f32 v8, v8, v215, v216
  v_max3_f32 v8, v8, v217, v218
  v_max3_f32 v8, v8, v219, v220
  v_max3_f32 v8, v8, v221, v222
  v_max_f32 v8, v8, v223
  v_max_f32 v11, v11, v8
  s_add_u32 s59, s59, 4096
  s_cmp_lt_u32 s59, 262144
  s_cbranch_scc1 parallel_sum__grouped_kv_mqa__mixer_channel_mlp__prompt_kernel_fb1_1
  v_mov_b32 v9, v11
  s_nop 1
  v_permlane32_swap_b32 v11, v9
  s_nop 1
  v_max_f32 v11, v11, v9
  v_sub_f32 v144, 0, v11
  v_sub_f32 v145, 0, v11
  v_sub_f32 v146, 0, v11
  v_sub_f32 v147, 0, v11
  v_sub_f32 v148, 0, v11
  v_sub_f32 v149, 0, v11
  v_sub_f32 v150, 0, v11
  v_sub_f32 v151, 0, v11
  v_sub_f32 v152, 0, v11
  v_sub_f32 v153, 0, v11
  v_sub_f32 v154, 0, v11
  v_sub_f32 v155, 0, v11
  v_sub_f32 v156, 0, v11
  v_sub_f32 v157, 0, v11
  v_sub_f32 v158, 0, v11
  v_sub_f32 v159, 0, v11
  v_mov_b32 v176, 0
  v_mov_b32 v177, 0
  v_mov_b32 v178, 0
  v_mov_b32 v179, 0
  v_mov_b32 v180, 0
  v_mov_b32 v181, 0
  v_mov_b32 v182, 0
  v_mov_b32 v183, 0
  v_mov_b32 v184, 0
  v_mov_b32 v185, 0
  v_mov_b32 v186, 0
  v_mov_b32 v187, 0
  v_mov_b32 v188, 0
  v_mov_b32 v189, 0
  v_mov_b32 v190, 0
  v_mov_b32 v191, 0
  v_mov_b32 v116, 0
  v_mov_b32 v117, 0
  v_mov_b32 v118, 0
  v_mov_b32 v119, 0
  s_mov_b32 s59, 0
parallel_sum__grouped_kv_mqa__mixer_channel_mlp__prompt_kernel_fb2_1:
  buffer_load_dwordx4 v[192:195], v1, s[32:35], s59 offen offset:0 sc1
  buffer_load_dwordx4 v[196:199], v1, s[32:35], s59 offen offset:1024 sc1
  buffer_load_dwordx4 v[200:203], v1, s[32:35], s59 offen offset:2048 sc1
  buffer_load_dwordx4 v[204:207], v1, s[32:35], s59 offen offset:3072 sc1
  s_waitcnt vmcnt(0)
  v_mfma_f32_32x32x16_bf16 v[208:223], v[192:195], v[104:107], v[144:159]
  v_mfma_f32_32x32x16_bf16 v[208:223], v[196:199], v[108:111], v[208:223]
  s_nop 15
  v_exp_f32 v208, v208
  v_exp_f32 v209, v209
  v_exp_f32 v210, v210
  v_exp_f32 v211, v211
  v_exp_f32 v212, v212
  v_exp_f32 v213, v213
  v_exp_f32 v214, v214
  v_exp_f32 v215, v215
  v_exp_f32 v216, v216
  v_exp_f32 v217, v217
  v_exp_f32 v218, v218
  v_exp_f32 v219, v219
  v_exp_f32 v220, v220
  v_exp_f32 v221, v221
  v_exp_f32 v222, v222
  v_exp_f32 v223, v223
  s_nop 0
  v_cvt_pk_bf16_f32 v224, v208, v209
  v_cvt_pk_bf16_f32 v225, v210, v211
  v_cvt_pk_bf16_f32 v226, v212, v213
  v_cvt_pk_bf16_f32 v227, v214, v215
  v_cvt_pk_bf16_f32 v228, v216, v217
  v_cvt_pk_bf16_f32 v229, v218, v219
  v_cvt_pk_bf16_f32 v230, v220, v221
  v_cvt_pk_bf16_f32 v231, v222, v223
  s_nop 1
  v_mfma_f32_32x32x16_bf16 v[176:191], v[200:203], v[224:227], v[176:191]
  v_mfma_f32_32x32x16_bf16 v[176:191], v[204:207], v[228:231], v[176:191]
  v_smfmac_f32_16x16x64_bf16 v[116:119], v[12:15], v[224:231], v6
  s_nop 7
  s_add_u32 s59, s59, 4096
  s_cmp_lt_u32 s59, 262144
  s_cbranch_scc1 parallel_sum__grouped_kv_mqa__mixer_channel_mlp__prompt_kernel_fb2_1
  s_nop 15
  v_add_f32 v116, v116, v117
  s_branch parallel_sum__grouped_kv_mqa__mixer_channel_mlp__prompt_kernel_ok1
parallel_sum__grouped_kv_mqa__mixer_channel_mlp__prompt_kernel_attdone:
  s_branch parallel_sum__grouped_kv_mqa__mixer_channel_mlp__prompt_kernel_final
parallel_sum__grouped_kv_mqa__mixer_channel_mlp__prompt_kernel_g2:
  s_and_b32 s57, s2, 7
  s_lshr_b32 s58, s2, 3
  s_and_b32 s48, s57, 1
  s_xor_b32 s48, s48, 1
  s_lshl_b32 s48, s48, 1
  s_bfe_u32 s59, s57, 0x10001
  s_add_u32 s48, s48, s59
  s_lshl_b32 s48, s48, 2
  s_and_b32 s59, s58, 3
  s_add_u32 s48, s48, s59
  s_lshr_b32 s49, s57, 2
  s_lshl_b32 s49, s49, 3
  s_lshr_b32 s59, s58, 2
  s_add_u32 s49, s49, s59
  s_mov_b32 s40, s96
  s_mov_b32 s41, s97
  s_mov_b32 s42, 2048
  s_mov_b32 s43, 0x20000
  s_mov_b32 s44, s98
  s_mov_b32 s45, s99
  s_mov_b32 s46, 4194304
  s_mov_b32 s47, 0x20000
  s_mov_b32 s28, s6
  s_mov_b32 s29, s7
  s_mov_b32 s30, 7340032
  s_mov_b32 s31, 0x20000
  v_lshlrev_b32 v1, 4, v0
  v_lshrrev_b32 v10, 3, v0
  v_lshlrev_b32 v10, 11, v10
  v_and_b32 v11, 7, v0
  v_bfe_u32 v12, v0, 4, 2
  v_lshlrev_b32 v12, 1, v12
  v_xor_b32 v11, v11, v12
  v_lshl_add_u32 v10, v11, 4, v10
  s_lshl_b32 s57, s49, 7
  s_lshl_b32 s58, s55, 16
  s_add_u32 s57, s57, s58
  s_nop 0
  v_add_u32 v2, s57, v10
  v_add_u32 v3, 31744, v2
  s_mov_b32 s54, 14336
  s_mul_i32 s65, s55, 12288
  s_add_u32 s65, s65, 0
  s_mul_i32 s67, s48, 1179648
  s_lshl_b32 s57, s55, 13
  s_add_u32 s67, s67, s57
  s_add_u32 s66, s67, 262144
  s_mul_i32 s69, s48, 7
  s_lshr_b32 s69, s69, 2
  v_bfe_u32 v10, v0, 2, 3
  v_lshrrev_b32 v11, 5, v0
  v_lshl_add_u32 v11, v11, 4, v10
  v_lshrrev_b32 v10, 1, v10
  v_lshlrev_b32 v10, 5, v10
  v_and_b32 v12, 3, v0
  v_lshl_add_u32 v10, v12, 3, v10
  v_lshl_add_u32 v10, v11, 7, v10
  v_add_u32 v4, s65, v10
  v_xor_b32 v5, 32, v4
  v_xor_b32 v6, 64, v4
  v_xor_b32 v7, 96, v4
  v_lshrrev_b32 v10, 4, v0
  v_and_b32 v11, 3, v0
  v_bfe_u32 v12, v0, 2, 2
  v_lshlrev_b32 v8, 2, v11
  v_lshl_add_u32 v8, v12, 8, v8
  v_lshl_add_u32 v8, v10, 24, v8
  v_mov_b32 v9, 0x01010101
  v_mov_b32 v12, 0x0101
  v_cmp_eq_u32 vcc, 3, v11
  s_nop 1
  v_cndmask_b32 v9, v9, v12, vcc
  v_cmp_gt_u32 vcc, 16, v0
  s_nop 1
  v_cndmask_b32 v9, 0, v9, vcc
  v_mov_b32 v128, 0
  v_mov_b32 v129, 0
  v_mov_b32 v130, 0
  v_mov_b32 v131, 0
  v_mov_b32 v132, 0
  v_mov_b32 v133, 0
  v_mov_b32 v134, 0
  v_mov_b32 v135, 0
  v_mov_b32 v136, 0
  v_mov_b32 v137, 0
  v_mov_b32 v138, 0
  v_mov_b32 v139, 0
  v_mov_b32 v140, 0
  v_mov_b32 v141, 0
  v_mov_b32 v142, 0
  v_mov_b32 v143, 0
  v_mov_b32 v144, 0
  v_mov_b32 v145, 0
  v_mov_b32 v146, 0
  v_mov_b32 v147, 0
  v_mov_b32 v148, 0
  v_mov_b32 v149, 0
  v_mov_b32 v150, 0
  v_mov_b32 v151, 0
  v_mov_b32 v152, 0
  v_mov_b32 v153, 0
  v_mov_b32 v154, 0
  v_mov_b32 v155, 0
  v_mov_b32 v156, 0
  v_mov_b32 v157, 0
  v_mov_b32 v158, 0
  v_mov_b32 v159, 0
  v_mov_b32 v160, 0
  v_mov_b32 v161, 0
  v_mov_b32 v162, 0
  v_mov_b32 v163, 0
  v_mov_b32 v164, 0
  v_mov_b32 v165, 0
  v_mov_b32 v166, 0
  v_mov_b32 v167, 0
  v_mov_b32 v168, 0
  v_mov_b32 v169, 0
  v_mov_b32 v170, 0
  v_mov_b32 v171, 0
  v_mov_b32 v172, 0
  v_mov_b32 v173, 0
  v_mov_b32 v174, 0
  v_mov_b32 v175, 0
  v_mov_b32 v176, 0
  v_mov_b32 v177, 0
  v_mov_b32 v178, 0
  v_mov_b32 v179, 0
  v_mov_b32 v180, 0
  v_mov_b32 v181, 0
  v_mov_b32 v182, 0
  v_mov_b32 v183, 0
  v_mov_b32 v184, 0
  v_mov_b32 v185, 0
  v_mov_b32 v186, 0
  v_mov_b32 v187, 0
  v_mov_b32 v188, 0
  v_mov_b32 v189, 0
  v_mov_b32 v190, 0
  v_mov_b32 v191, 0
  v_mov_b32 v192, 0
  v_mov_b32 v193, 0
  v_mov_b32 v194, 0
  v_mov_b32 v195, 0
  v_mov_b32 v196, 0
  v_mov_b32 v197, 0
  v_mov_b32 v198, 0
  v_mov_b32 v199, 0
  v_mov_b32 v200, 0
  v_mov_b32 v201, 0
  v_mov_b32 v202, 0
  v_mov_b32 v203, 0
  v_mov_b32 v204, 0
  v_mov_b32 v205, 0
  v_mov_b32 v206, 0
  v_mov_b32 v207, 0
  v_mov_b32 v208, 0
  v_mov_b32 v209, 0
  v_mov_b32 v210, 0
  v_mov_b32 v211, 0
  v_mov_b32 v212, 0
  v_mov_b32 v213, 0
  v_mov_b32 v214, 0
  v_mov_b32 v215, 0
  v_mov_b32 v216, 0
  v_mov_b32 v217, 0
  v_mov_b32 v218, 0
  v_mov_b32 v219, 0
  v_mov_b32 v220, 0
  v_mov_b32 v221, 0
  v_mov_b32 v222, 0
  v_mov_b32 v223, 0
  v_mov_b32 v224, 0
  v_mov_b32 v225, 0
  v_mov_b32 v226, 0
  v_mov_b32 v227, 0
  v_mov_b32 v228, 0
  v_mov_b32 v229, 0
  v_mov_b32 v230, 0
  v_mov_b32 v231, 0
  v_mov_b32 v232, 0
  v_mov_b32 v233, 0
  v_mov_b32 v234, 0
  v_mov_b32 v235, 0
  v_mov_b32 v236, 0
  v_mov_b32 v237, 0
  v_mov_b32 v238, 0
  v_mov_b32 v239, 0
  v_mov_b32 v240, 0
  v_mov_b32 v241, 0
  v_mov_b32 v242, 0
  v_mov_b32 v243, 0
  v_mov_b32 v244, 0
  v_mov_b32 v245, 0
  v_mov_b32 v246, 0
  v_mov_b32 v247, 0
  v_mov_b32 v248, 0
  v_mov_b32 v249, 0
  v_mov_b32 v250, 0
  v_mov_b32 v251, 0
  v_mov_b32 v252, 0
  v_mov_b32 v253, 0
  v_mov_b32 v254, 0
  v_mov_b32 v255, 0
  v_mov_b32 v14, 161800
  s_mov_b32 s68, 0
parallel_sum__grouped_kv_mqa__mixer_channel_mlp__prompt_kernel_gz:
  v_mov_b32 v11, 161792
  ds_read_b32 v10, v11
  s_add_u32 s68, s68, 1
  s_cmp_gt_u32 s68, 0x400000
  s_cbranch_scc1 parallel_sum__grouped_kv_mqa__mixer_channel_mlp__prompt_kernel_gz_ok
  s_waitcnt lgkmcnt(0)
  v_cmp_eq_u32 vcc, 0, v10
  s_nop 1
  s_cbranch_vccz parallel_sum__grouped_kv_mqa__mixer_channel_mlp__prompt_kernel_gz_ok
  s_sleep 4
  s_branch parallel_sum__grouped_kv_mqa__mixer_channel_mlp__prompt_kernel_gz
parallel_sum__grouped_kv_mqa__mixer_channel_mlp__prompt_kernel_gz_ok:
  s_mul_i32 s60, s48, 1024
  s_add_u32 s60, s60, 23625728
  s_mov_b32 s68, 0
parallel_sum__grouped_kv_mqa__mixer_channel_mlp__prompt_kernel_ph:
  s_add_u32 s68, s68, 1
  s_cmp_gt_u32 s68, 0x100000
  s_cbranch_scc1 parallel_sum__grouped_kv_mqa__mixer_channel_mlp__prompt_kernel_ph_ok
  s_cmp_eq_u32 s55, 0
  s_cbranch_scc0 parallel_sum__grouped_kv_mqa__mixer_channel_mlp__prompt_kernel_ph_f
  buffer_load_dword v10, v8, s[36:39], s60 offen sc1
  s_waitcnt vmcnt(0)
  v_cmp_ne_u32 vcc, v9, v10
  v_mov_b32 v10, 1
  s_cbranch_vccz parallel_sum__grouped_kv_mqa__mixer_channel_mlp__prompt_kernel_ph_set
  s_sleep 8
  s_branch parallel_sum__grouped_kv_mqa__mixer_channel_mlp__prompt_kernel_ph
parallel_sum__grouped_kv_mqa__mixer_channel_mlp__prompt_kernel_ph_f:
  ds_read_b32 v10, v14
  s_waitcnt lgkmcnt(0)
  v_readfirstlane_b32 s57, v10
  s_cmp_ge_u32 s57, 1
  s_cbranch_scc1 parallel_sum__grouped_kv_mqa__mixer_channel_mlp__prompt_kernel_ph_ok
  s_sleep 2
  s_branch parallel_sum__grouped_kv_mqa__mixer_channel_mlp__prompt_kernel_ph
parallel_sum__grouped_kv_mqa__mixer_channel_mlp__prompt_kernel_ph_set:
  ds_write_b32 v14, v10
parallel_sum__grouped_kv_mqa__mixer_channel_mlp__prompt_kernel_ph_ok:
  s_setprio 0
  s_add_u32 m0, s65, 0
  s_lshl_b32 s58, s69, 18
  buffer_load_dwordx4 v2, s[28:31], s58 offen lds
  buffer_load_dwordx4 v3, s[28:31], s58 offen offset:1024 lds
  s_add_u32 s58, s58, s54
  buffer_load_dwordx4 v2, s[28:31], s58 offen offset:2048 lds
  buffer_load_dwordx4 v3, s[28:31], s58 offen offset:3072 lds
  s_lshl_b32 s59, s69, 15
  s_add_u32 s59, s59, s66
  s_add_u32 s69, s69, 1
  s_cmp_eq_u32 s69, 28
  s_cselect_b32 s69, 0, s69
  buffer_load_dwordx4 v[32:35], v1, s[36:39], s59 offen offset:0 sc1
  buffer_load_dwordx4 v[36:39], v1, s[36:39], s59 offen offset:1024 sc1
  buffer_load_dwordx4 v[40:43], v1, s[36:39], s59 offen offset:2048 sc1
  buffer_load_dwordx4 v[44:47], v1, s[36:39], s59 offen offset:3072 sc1
  s_add_u32 s59, s59, 4096
  buffer_load_dwordx4 v[48:51], v1, s[36:39], s59 offen offset:0 sc1
  buffer_load_dwordx4 v[52:55], v1, s[36:39], s59 offen offset:1024 sc1
  buffer_load_dwordx4 v[56:59], v1, s[36:39], s59 offen offset:2048 sc1
  buffer_load_dwordx4 v[60:63], v1, s[36:39], s59 offen offset:3072 sc1
  s_add_u32 m0, s65, 4096
  s_lshl_b32 s58, s69, 18
  buffer_load_dwordx4 v2, s[28:31], s58 offen lds
  buffer_load_dwordx4 v3, s[28:31], s58 offen offset:1024 lds
  s_add_u32 s58, s58, s54
  buffer_load_dwordx4 v2, s[28:31], s58 offen offset:2048 lds
  buffer_load_dwordx4 v3, s[28:31], s58 offen offset:3072 lds
  s_lshl_b32 s59, s69, 15
  s_add_u32 s59, s59, s66
  s_add_u32 s69, s69, 1
  s_cmp_eq_u32 s69, 28
  s_cselect_b32 s69, 0, s69
  buffer_load_dwordx4 v[64:67], v1, s[36:39], s59 offen offset:0 sc1
  buffer_load_dwordx4 v[68:71], v1, s[36:39], s59 offen offset:1024 sc1
  buffer_load_dwordx4 v[72:75], v1, s[36:39], s59 offen offset:2048 sc1
  buffer_load_dwordx4 v[76:79], v1, s[36:39], s59 offen offset:3072 sc1
  s_add_u32 s59, s59, 4096
  buffer_load_dwordx4 v[80:83], v1, s[36:39], s59 offen offset:0 sc1
  buffer_load_dwordx4 v[84:87], v1, s[36:39], s59 offen offset:1024 sc1
  buffer_load_dwordx4 v[88:91], v1, s[36:39], s59 offen offset:2048 sc1
  buffer_load_dwordx4 v[92:95], v1, s[36:39], s59 offen offset:3072 sc1
  s_add_u32 m0, s65, 8192
  s_lshl_b32 s58, s69, 18
  buffer_load_dwordx4 v2, s[28:31], s58 offen lds
  buffer_load_dwordx4 v3, s[28:31], s58 offen offset:1024 lds
  s_add_u32 s58, s58, s54
  buffer_load_dwordx4 v2, s[28:31], s58 offen offset:2048 lds
  buffer_load_dwordx4 v3, s[28:31], s58 offen offset:3072 lds
  s_lshl_b32 s59, s69, 15
  s_add_u32 s59, s59, s66
  s_add_u32 s69, s69, 1
  s_cmp_eq_u32 s69, 28
  s_cselect_b32 s69, 0, s69
  buffer_load_dwordx4 v[96:99], v1, s[36:39], s59 offen offset:0 sc1
  buffer_load_dwordx4 v[100:103], v1, s[36:39], s59 offen offset:1024 sc1
  buffer_load_dwordx4 v[104:107], v1, s[36:39], s59 offen offset:2048 sc1
  buffer_load_dwordx4 v[108:111], v1, s[36:39], s59 offen offset:3072 sc1
  s_add_u32 s59, s59, 4096
  buffer_load_dwordx4 v[112:115], v1, s[36:39], s59 offen offset:0 sc1
parallel_sum__grouped_kv_mqa__mixer_channel_mlp__prompt_kernel_gp2:
  s_waitcnt vmcnt(29)
  ds_read_b64_tr_b16 v[16:17], v4 offset:0
  ds_read_b64_tr_b16 v[18:19], v4 offset:1024
  ds_read_b64_tr_b16 v[20:21], v5 offset:0
  ds_read_b64_tr_b16 v[22:23], v5 offset:1024
  ds_read_b64_tr_b16 v[24:25], v6 offset:0
  ds_read_b64_tr_b16 v[26:27], v6 offset:1024
  ds_read_b64_tr_b16 v[28:29], v7 offset:0
  ds_read_b64_tr_b16 v[30:31], v7 offset:1024
  s_mov_b32 s63, 0
  s_mov_b32 s71, 0
  s_mov_b32 s52, 0
  s_mov_b32 s53, 0
  .p2align 6
parallel_sum__grouped_kv_mqa__mixer_channel_mlp__prompt_kernel_gloop:
  s_waitcnt vmcnt(25) lgkmcnt(4)
  v_mfma_f32_16x16x32_bf16 v[128:131], v[16:19], v[32:35], v[128:131]
  buffer_load_dwordx4 v[116:119], v1, s[36:39], s59 offen offset:1024 sc1
  v_mfma_f32_16x16x32_bf16 v[144:147], v[16:19], v[36:39], v[144:147]
  v_mfma_f32_16x16x32_bf16 v[160:163], v[16:19], v[40:43], v[160:163]
  v_mfma_f32_16x16x32_bf16 v[176:179], v[16:19], v[44:47], v[176:179]
  buffer_load_dwordx4 v[120:123], v1, s[36:39], s59 offen offset:2048 sc1
  v_mfma_f32_16x16x32_bf16 v[132:135], v[20:23], v[32:35], v[132:135]
  v_mfma_f32_16x16x32_bf16 v[148:151], v[20:23], v[36:39], v[148:151]
  v_mfma_f32_16x16x32_bf16 v[164:167], v[20:23], v[40:43], v[164:167]
  buffer_load_dwordx4 v[124:127], v1, s[36:39], s59 offen offset:3072 sc1
  v_mfma_f32_16x16x32_bf16 v[180:183], v[20:23], v[44:47], v[180:183]
  s_waitcnt lgkmcnt(0)
  v_mfma_f32_16x16x32_bf16 v[136:139], v[24:27], v[32:35], v[136:139]
  s_cmp_eq_u32 s71, 0
  s_cbranch_scc1 L_nosel_1
  s_call_b64 s[74:75], parallel_sum__grouped_kv_mqa__mixer_channel_mlp__prompt_kernel_gsel
L_nosel_1:
  s_add_u32 m0, s65, 0
  s_lshl_b32 s58, s69, 18
  buffer_load_dwordx4 v2, s[28:31], s58 offen lds
  v_mfma_f32_16x16x32_bf16 v[152:155], v[24:27], v[36:39], v[152:155]
  v_mfma_f32_16x16x32_bf16 v[168:171], v[24:27], v[40:43], v[168:171]
  buffer_load_dwordx4 v3, s[28:31], s58 offen offset:1024 lds
  s_add_u32 s58, s58, s54
  v_mfma_f32_16x16x32_bf16 v[184:187], v[24:27], v[44:47], v[184:187]
  v_mfma_f32_16x16x32_bf16 v[140:143], v[28:31], v[32:35], v[140:143]
  buffer_load_dwordx4 v2, s[28:31], s58 offen offset:2048 lds
  v_mfma_f32_16x16x32_bf16 v[156:159], v[28:31], v[36:39], v[156:159]
  v_mfma_f32_16x16x32_bf16 v[172:175], v[28:31], v[40:43], v[172:175]
  buffer_load_dwordx4 v3, s[28:31], s58 offen offset:3072 lds
  s_lshl_b32 s59, s69, 15
  s_add_u32 s59, s59, s66
  s_add_u32 s69, s69, 1
  s_cmp_eq_u32 s69, 28
  s_cselect_b32 s69, 0, s69
  v_mfma_f32_16x16x32_bf16 v[188:191], v[28:31], v[44:47], v[188:191]
  s_waitcnt vmcnt(24)
  v_mfma_f32_16x16x32_bf16 v[192:195], v[16:19], v[48:51], v[192:195]
  v_mfma_f32_16x16x32_bf16 v[208:211], v[16:19], v[52:55], v[208:211]
  buffer_load_dwordx4 v[32:35], v1, s[36:39], s59 offen offset:0 sc1
  v_mfma_f32_16x16x32_bf16 v[224:227], v[16:19], v[56:59], v[224:227]
  v_mfma_f32_16x16x32_bf16 v[240:243], v[16:19], v[60:63], v[240:243]
  ds_read_b64_tr_b16 v[16:17], v4 offset:4096
  ds_read_b64_tr_b16 v[18:19], v4 offset:5120
  v_mfma_f32_16x16x32_bf16 v[196:199], v[20:23], v[48:51], v[196:199]
  buffer_load_dwordx4 v[36:39], v1, s[36:39], s59 offen offset:1024 sc1
  v_mfma_f32_16x16x32_bf16 v[212:215], v[20:23], v[52:55], v[212:215]
  v_mfma_f32_16x16x32_bf16 v[228:231], v[20:23], v[56:59], v[228:231]
  v_mfma_f32_16x16x32_bf16 v[244:247], v[20:23], v[60:63], v[244:247]
  ds_read_b64_tr_b16 v[20:21], v5 offset:4096
  ds_read_b64_tr_b16 v[22:23], v5 offset:5120
  v_mfma_f32_16x16x32_bf16 v[200:203], v[24:27], v[48:51], v[200:203]
  buffer_load_dwordx4 v[40:43], v1, s[36:39], s59 offen offset:2048 sc1
  v_mfma_f32_16x16x32_bf16 v[216:219], v[24:27], v[52:55], v[216:219]
  v_mfma_f32_16x16x32_bf16 v[232:235], v[24:27], v[56:59], v[232:235]
  buffer_load_dwordx4 v[44:47], v1, s[36:39], s59 offen offset:3072 sc1
  v_mfma_f32_16x16x32_bf16 v[248:251], v[24:27], v[60:63], v[248:251]
  ds_read_b64_tr_b16 v[24:25], v6 offset:4096
  ds_read_b64_tr_b16 v[26:27], v6 offset:5120
  v_mfma_f32_16x16x32_bf16 v[204:207], v[28:31], v[48:51], v[204:207]
  s_add_u32 s59, s59, 4096
  v_mfma_f32_16x16x32_bf16 v[220:223], v[28:31], v[52:55], v[220:223]
  buffer_load_dwordx4 v[48:51], v1, s[36:39], s59 offen offset:0 sc1
  v_mfma_f32_16x16x32_bf16 v[236:239], v[28:31], v[56:59], v[236:239]
  v_mfma_f32_16x16x32_bf16 v[252:255], v[28:31], v[60:63], v[252:255]
  ds_read_b64_tr_b16 v[28:29], v7 offset:4096
  ds_read_b64_tr_b16 v[30:31], v7 offset:5120
  s_cmp_ge_u32 s63, 7
  s_cbranch_scc1 parallel_sum__grouped_kv_mqa__mixer_channel_mlp__prompt_kernel_gsw
parallel_sum__grouped_kv_mqa__mixer_channel_mlp__prompt_kernel_gsw_ret:
  s_waitcnt vmcnt(25) lgkmcnt(4)
  v_mfma_f32_16x16x32_bf16 v[128:131], v[16:19], v[64:67], v[128:131]
  buffer_load_dwordx4 v[52:55], v1, s[36:39], s59 offen offset:1024 sc1
  v_mfma_f32_16x16x32_bf16 v[144:147], v[16:19], v[68:71], v[144:147]
  v_mfma_f32_16x16x32_bf16 v[160:163], v[16:19], v[72:75], v[160:163]
  v_mfma_f32_16x16x32_bf16 v[176:179], v[16:19], v[76:79], v[176:179]
  buffer_load_dwordx4 v[56:59], v1, s[36:39], s59 offen offset:2048 sc1
  v_mfma_f32_16x16x32_bf16 v[132:135], v[20:23], v[64:67], v[132:135]
  v_mfma_f32_16x16x32_bf16 v[148:151], v[20:23], v[68:71], v[148:151]
  v_mfma_f32_16x16x32_bf16 v[164:167], v[20:23], v[72:75], v[164:167]
  buffer_load_dwordx4 v[60:63], v1, s[36:39], s59 offen offset:3072 sc1
  v_mfma_f32_16x16x32_bf16 v[180:183], v[20:23], v[76:79], v[180:183]
  s_waitcnt lgkmcnt(0)
  v_mfma_f32_16x16x32_bf16 v[136:139], v[24:27], v[64:67], v[136:139]
  s_cmp_eq_u32 s71, 0
  s_cbranch_scc1 L_nosel_2
  s_call_b64 s[74:75], parallel_sum__grouped_kv_mqa__mixer_channel_mlp__prompt_kernel_gsel
L_nosel_2:
  s_add_u32 m0, s65, 4096
  s_lshl_b32 s58, s69, 18
  buffer_load_dwordx4 v2, s[28:31], s58 offen lds
  v_mfma_f32_16x16x32_bf16 v[152:155], v[24:27], v[68:71], v[152:155]
  v_mfma_f32_16x16x32_bf16 v[168:171], v[24:27], v[72:75], v[168:171]
  buffer_load_dwordx4 v3, s[28:31], s58 offen offset:1024 lds
  s_add_u32 s58, s58, s54
  v_mfma_f32_16x16x32_bf16 v[184:187], v[24:27], v[76:79], v[184:187]
  v_mfma_f32_16x16x32_bf16 v[140:143], v[28:31], v[64:67], v[140:143]
  buffer_load_dwordx4 v2, s[28:31], s58 offen offset:2048 lds
  v_mfma_f32_16x16x32_bf16 v[156:159], v[28:31], v[68:71], v[156:159]
  v_mfma_f32_16x16x32_bf16 v[172:175], v[28:31], v[72:75], v[172:175]
  buffer_load_dwordx4 v3, s[28:31], s58 offen offset:3072 lds
  s_lshl_b32 s59, s69, 15
  s_add_u32 s59, s59, s66
  s_add_u32 s69, s69, 1
  s_cmp_eq_u32 s69, 28
  s_cselect_b32 s69, 0, s69
  v_mfma_f32_16x16x32_bf16 v[188:191], v[28:31], v[76:79], v[188:191]
  s_waitcnt vmcnt(24)
  v_mfma_f32_16x16x32_bf16 v[192:195], v[16:19], v[80:83], v[192:195]
  v_mfma_f32_16x16x32_bf16 v[208:211], v[16:19], v[84:87], v[208:211]
  buffer_load_dwordx4 v[64:67], v1, s[36:39], s59 offen offset:0 sc1
  v_mfma_f32_16x16x32_bf16 v[224:227], v[16:19], v[88:91], v[224:227]
  v_mfma_f32_16x16x32_bf16 v[240:243], v[16:19], v[92:95], v[240:243]
  ds_read_b64_tr_b16 v[16:17], v4 offset:8192
  ds_read_b64_tr_b16 v[18:19], v4 offset:9216
  v_mfma_f32_16x16x32_bf16 v[196:199], v[20:23], v[80:83], v[196:199]
  buffer_load_dwordx4 v[68:71], v1, s[36:39], s59 offen offset:1024 sc1
  v_mfma_f32_16x16x32_bf16 v[212:215], v[20:23], v[84:87], v[212:215]
  v_mfma_f32_16x16x32_bf16 v[228:231], v[20:23], v[88:91], v[228:231]
  v_mfma_f32_16x16x32_bf16 v[244:247], v[20:23], v[92:95], v[244:247]
  ds_read_b64_tr_b16 v[20:21], v5 offset:8192
  ds_read_b64_tr_b16 v[22:23], v5 offset:9216
  v_mfma_f32_16x16x32_bf16 v[200:203], v[24:27], v[80:83], v[200:203]
  buffer_load_dwordx4 v[72:75], v1, s[36:39], s59 offen offset:2048 sc1
  v_mfma_f32_16x16x32_bf16 v[216:219], v[24:27], v[84:87], v[216:219]
  v_mfma_f32_16x16x32_bf16 v[232:235], v[24:27], v[88:91], v[232:235]
  buffer_load_dwordx4 v[76:79], v1, s[36:39], s59 offen offset:3072 sc1
  v_mfma_f32_16x16x32_bf16 v[248:251], v[24:27], v[92:95], v[248:251]
  ds_read_b64_tr_b16 v[24:25], v6 offset:8192
  ds_read_b64_tr_b16 v[26:27], v6 offset:9216
  v_mfma_f32_16x16x32_bf16 v[204:207], v[28:31], v[80:83], v[204:207]
  s_add_u32 s59, s59, 4096
  v_mfma_f32_16x16x32_bf16 v[220:223], v[28:31], v[84:87], v[220:223]
  buffer_load_dwordx4 v[80:83], v1, s[36:39], s59 offen offset:0 sc1
  v_mfma_f32_16x16x32_bf16 v[236:239], v[28:31], v[88:91], v[236:239]
  v_mfma_f32_16x16x32_bf16 v[252:255], v[28:31], v[92:95], v[252:255]
  ds_read_b64_tr_b16 v[28:29], v7 offset:8192
  ds_read_b64_tr_b16 v[30:31], v7 offset:9216
  s_waitcnt vmcnt(25) lgkmcnt(4)
  v_mfma_f32_16x16x32_bf16 v[128:131], v[16:19], v[96:99], v[128:131]
  buffer_load_dwordx4 v[84:87], v1, s[36:39], s59 offen offset:1024 sc1
  v_mfma_f32_16x16x32_bf16 v[144:147], v[16:19], v[100:103], v[144:147]
  v_mfma_f32_16x16x32_bf16 v[160:163], v[16:19], v[104:107], v[160:163]
  v_mfma_f32_16x16x32_bf16 v[176:179], v[16:19], v[108:111], v[176:179]
  buffer_load_dwordx4 v[88:91], v1, s[36:39], s59 offen offset:2048 sc1
  v_mfma_f32_16x16x32_bf16 v[132:135], v[20:23], v[96:99], v[132:135]
  v_mfma_f32_16x16x32_bf16 v[148:151], v[20:23], v[100:103], v[148:151]
  v_mfma_f32_16x16x32_bf16 v[164:167], v[20:23], v[104:107], v[164:167]
  buffer_load_dwordx4 v[92:95], v1, s[36:39], s59 offen offset:3072 sc1
  v_mfma_f32_16x16x32_bf16 v[180:183], v[20:23], v[108:111], v[180:183]
  s_waitcnt lgkmcnt(0)
  v_mfma_f32_16x16x32_bf16 v[136:139], v[24:27], v[96:99], v[136:139]
  s_cmp_eq_u32 s71, 0
  s_cbranch_scc1 L_nosel_3
  s_call_b64 s[74:75], parallel_sum__grouped_kv_mqa__mixer_channel_mlp__prompt_kernel_gsel
L_nosel_3:
  s_add_u32 m0, s65, 8192
  s_lshl_b32 s58, s69, 18
  buffer_load_dwordx4 v2, s[28:31], s58 offen lds
  v_mfma_f32_16x16x32_bf16 v[152:155], v[24:27], v[100:103], v[152:155]
  v_mfma_f32_16x16x32_bf16 v[168:171], v[24:27], v[104:107], v[168:171]
  buffer_load_dwordx4 v3, s[28:31], s58 offen offset:1024 lds
  s_add_u32 s58, s58, s54
  v_mfma_f32_16x16x32_bf16 v[184:187], v[24:27], v[108:111], v[184:187]
  v_mfma_f32_16x16x32_bf16 v[140:143], v[28:31], v[96:99], v[140:143]
  buffer_load_dwordx4 v2, s[28:31], s58 offen offset:2048 lds
  v_mfma_f32_16x16x32_bf16 v[156:159], v[28:31], v[100:103], v[156:159]
  v_mfma_f32_16x16x32_bf16 v[172:175], v[28:31], v[104:107], v[172:175]
  buffer_load_dwordx4 v3, s[28:31], s58 offen offset:3072 lds
  s_lshl_b32 s59, s69, 15
  s_add_u32 s59, s59, s66
  s_add_u32 s69, s69, 1
  s_cmp_eq_u32 s69, 28
  s_cselect_b32 s69, 0, s69
  v_mfma_f32_16x16x32_bf16 v[188:191], v[28:31], v[108:111], v[188:191]
  s_waitcnt vmcnt(24)
  v_mfma_f32_16x16x32_bf16 v[192:195], v[16:19], v[112:115], v[192:195]
  v_mfma_f32_16x16x32_bf16 v[208:211], v[16:19], v[116:119], v[208:211]
  buffer_load_dwordx4 v[96:99], v1, s[36:39], s59 offen offset:0 sc1
  v_mfma_f32_16x16x32_bf16 v[224:227], v[16:19], v[120:123], v[224:227]
  v_mfma_f32_16x16x32_bf16 v[240:243], v[16:19], v[124:127], v[240:243]
  ds_read_b64_tr_b16 v[16:17], v4 offset:0
  ds_read_b64_tr_b16 v[18:19], v4 offset:1024
  v_mfma_f32_16x16x32_bf16 v[196:199], v[20:23], v[112:115], v[196:199]
  buffer_load_dwordx4 v[100:103], v1, s[36:39], s59 offen offset:1024 sc1
  v_mfma_f32_16x16x32_bf16 v[212:215], v[20:23], v[116:119], v[212:215]
  v_mfma_f32_16x16x32_bf16 v[228:231], v[20:23], v[120:123], v[228:231]
  v_mfma_f32_16x16x32_bf16 v[244:247], v[20:23], v[124:127], v[244:247]
  ds_read_b64_tr_b16 v[20:21], v5 offset:0
  ds_read_b64_tr_b16 v[22:23], v5 offset:1024
  v_mfma_f32_16x16x32_bf16 v[200:203], v[24:27], v[112:115], v[200:203]
  buffer_load_dwordx4 v[104:107], v1, s[36:39], s59 offen offset:2048 sc1
  v_mfma_f32_16x16x32_bf16 v[216:219], v[24:27], v[116:119], v[216:219]
  v_mfma_f32_16x16x32_bf16 v[232:235], v[24:27], v[120:123], v[232:235]
  buffer_load_dwordx4 v[108:111], v1, s[36:39], s59 offen offset:3072 sc1
  v_mfma_f32_16x16x32_bf16 v[248:251], v[24:27], v[124:127], v[248:251]
  ds_read_b64_tr_b16 v[24:25], v6 offset:0
  ds_read_b64_tr_b16 v[26:27], v6 offset:1024
  v_mfma_f32_16x16x32_bf16 v[204:207], v[28:31], v[112:115], v[204:207]
  s_add_u32 s59, s59, 4096
  v_mfma_f32_16x16x32_bf16 v[220:223], v[28:31], v[116:119], v[220:223]
  buffer_load_dwordx4 v[112:115], v1, s[36:39], s59 offen offset:0 sc1
  v_mfma_f32_16x16x32_bf16 v[236:239], v[28:31], v[120:123], v[236:239]
  v_mfma_f32_16x16x32_bf16 v[252:255], v[28:31], v[124:127], v[252:255]
  ds_read_b64_tr_b16 v[28:29], v7 offset:0
  ds_read_b64_tr_b16 v[30:31], v7 offset:1024
  s_add_u32 s63, s63, 1
  s_cmp_lt_u32 s63, 11
  s_cbranch_scc1 parallel_sum__grouped_kv_mqa__mixer_channel_mlp__prompt_kernel_gloop
  s_waitcnt vmcnt(25) lgkmcnt(4)
  v_mfma_f32_16x16x32_bf16 v[128:131], v[16:19], v[32:35], v[128:131]
  buffer_load_dwordx4 v[116:119], v1, s[36:39], s59 offen offset:1024 sc1
  v_mfma_f32_16x16x32_bf16 v[144:147], v[16:19], v[36:39], v[144:147]
  v_mfma_f32_16x16x32_bf16 v[160:163], v[16:19], v[40:43], v[160:163]
  v_mfma_f32_16x16x32_bf16 v[176:179], v[16:19], v[44:47], v[176:179]
  buffer_load_dwordx4 v[120:123], v1, s[36:39], s59 offen offset:2048 sc1
  v_mfma_f32_16x16x32_bf16 v[132:135], v[20:23], v[32:35], v[132:135]
  v_mfma_f32_16x16x32_bf16 v[148:151], v[20:23], v[36:39], v[148:151]
  v_mfma_f32_16x16x32_bf16 v[164:167], v[20:23], v[40:43], v[164:167]
  buffer_load_dwordx4 v[124:127], v1, s[36:39], s59 offen offset:3072 sc1
  v_mfma_f32_16x16x32_bf16 v[180:183], v[20:23], v[44:47], v[180:183]
  s_waitcnt lgkmcnt(0)
  v_mfma_f32_16x16x32_bf16 v[136:139], v[24:27], v[32:35], v[136:139]
  v_mfma_f32_16x16x32_bf16 v[152:155], v[24:27], v[36:39], v[152:155]
  v_mfma_f32_16x16x32_bf16 v[168:171], v[24:27], v[40:43], v[168:171]
  v_mfma_f32_16x16x32_bf16 v[184:187], v[24:27], v[44:47], v[184:187]
  v_mfma_f32_16x16x32_bf16 v[140:143], v[28:31], v[32:35], v[140:143]
  v_mfma_f32_16x16x32_bf16 v[156:159], v[28:31], v[36:39], v[156:159]
  v_mfma_f32_16x16x32_bf16 v[172:175], v[28:31], v[40:43], v[172:175]
  v_mfma_f32_16x16x32_bf16 v[188:191], v[28:31], v[44:47], v[188:191]
  s_waitcnt vmcnt(20)
  v_mfma_f32_16x16x32_bf16 v[192:195], v[16:19], v[48:51], v[192:195]
  v_mfma_f32_16x16x32_bf16 v[208:211], v[16:19], v[52:55], v[208:211]
  v_mfma_f32_16x16x32_bf16 v[224:227], v[16:19], v[56:59], v[224:227]
  v_mfma_f32_16x16x32_bf16 v[240:243], v[16:19], v[60:63], v[240:243]
  ds_read_b64_tr_b16 v[16:17], v4 offset:4096
  ds_read_b64_tr_b16 v[18:19], v4 offset:5120
  v_mfma_f32_16x16x32_bf16 v[196:199], v[20:23], v[48:51], v[196:199]
  v_mfma_f32_16x16x32_bf16 v[212:215], v[20:23], v[52:55], v[212:215]
  v_mfma_f32_16x16x32_bf16 v[228:231], v[20:23], v[56:59], v[228:231]
  v_mfma_f32_16x16x32_bf16 v[244:247], v[20:23], v[60:63], v[244:247]
  ds_read_b64_tr_b16 v[20:21], v5 offset:4096
  ds_read_b64_tr_b16 v[22:23], v5 offset:5120
  v_mfma_f32_16x16x32_bf16 v[200:203], v[24:27], v[48:51], v[200:203]
  v_mfma_f32_16x16x32_bf16 v[216:219], v[24:27], v[52:55], v[216:219]
  v_mfma_f32_16x16x32_bf16 v[232:235], v[24:27], v[56:59], v[232:235]
  v_mfma_f32_16x16x32_bf16 v[248:251], v[24:27], v[60:63], v[248:251]
  ds_read_b64_tr_b16 v[24:25], v6 offset:4096
  ds_read_b64_tr_b16 v[26:27], v6 offset:5120
  v_mfma_f32_16x16x32_bf16 v[204:207], v[28:31], v[48:51], v[204:207]
  v_mfma_f32_16x16x32_bf16 v[220:223], v[28:31], v[52:55], v[220:223]
  v_mfma_f32_16x16x32_bf16 v[236:239], v[28:31], v[56:59], v[236:239]
  v_mfma_f32_16x16x32_bf16 v[252:255], v[28:31], v[60:63], v[252:255]
  ds_read_b64_tr_b16 v[28:29], v7 offset:4096
  ds_read_b64_tr_b16 v[30:31], v7 offset:5120
  s_waitcnt vmcnt(16) lgkmcnt(4)
  v_mfma_f32_16x16x32_bf16 v[128:131], v[16:19], v[64:67], v[128:131]
  v_mfma_f32_16x16x32_bf16 v[144:147], v[16:19], v[68:71], v[144:147]
  v_mfma_f32_16x16x32_bf16 v[160:163], v[16:19], v[72:75], v[160:163]
  v_mfma_f32_16x16x32_bf16 v[176:179], v[16:19], v[76:79], v[176:179]
  v_mfma_f32_16x16x32_bf16 v[132:135], v[20:23], v[64:67], v[132:135]
  v_mfma_f32_16x16x32_bf16 v[148:151], v[20:23], v[68:71], v[148:151]
  v_mfma_f32_16x16x32_bf16 v[164:167], v[20:23], v[72:75], v[164:167]
  v_mfma_f32_16x16x32_bf16 v[180:183], v[20:23], v[76:79], v[180:183]
  s_waitcnt lgkmcnt(0)
  v_mfma_f32_16x16x32_bf16 v[136:139], v[24:27], v[64:67], v[136:139]
  v_mfma_f32_16x16x32_bf16 v[152:155], v[24:27], v[68:71], v[152:155]
  v_mfma_f32_16x16x32_bf16 v[168:171], v[24:27], v[72:75], v[168:171]
  v_mfma_f32_16x16x32_bf16 v[184:187], v[24:27], v[76:79], v[184:187]
  v_mfma_f32_16x16x32_bf16 v[140:143], v[28:31], v[64:67], v[140:143]
  v_mfma_f32_16x16x32_bf16 v[156:159], v[28:31], v[68:71], v[156:159]
  v_mfma_f32_16x16x32_bf16 v[172:175], v[28:31], v[72:75], v[172:175]
  v_mfma_f32_16x16x32_bf16 v[188:191], v[28:31], v[76:79], v[188:191]
  s_waitcnt vmcnt(8)
  v_mfma_f32_16x16x32_bf16 v[192:195], v[16:19], v[80:83], v[192:195]
  v_mfma_f32_16x16x32_bf16 v[208:211], v[16:19], v[84:87], v[208:211]
  v_mfma_f32_16x16x32_bf16 v[224:227], v[16:19], v[88:91], v[224:227]
  v_mfma_f32_16x16x32_bf16 v[240:243], v[16:19], v[92:95], v[240:243]
  ds_read_b64_tr_b16 v[16:17], v4 offset:8192
  ds_read_b64_tr_b16 v[18:19], v4 offset:9216
  v_mfma_f32_16x16x32_bf16 v[196:199], v[20:23], v[80:83], v[196:199]
  v_mfma_f32_16x16x32_bf16 v[212:215], v[20:23], v[84:87], v[212:215]
  v_mfma_f32_16x16x32_bf16 v[228:231], v[20:23], v[88:91], v[228:231]
  v_mfma_f32_16x16x32_bf16 v[244:247], v[20:23], v[92:95], v[244:247]
  ds_read_b64_tr_b16 v[20:21], v5 offset:8192
  ds_read_b64_tr_b16 v[22:23], v5 offset:9216
  v_mfma_f32_16x16x32_bf16 v[200:203], v[24:27], v[80:83], v[200:203]
  v_mfma_f32_16x16x32_bf16 v[216:219], v[24:27], v[84:87], v[216:219]
  v_mfma_f32_16x16x32_bf16 v[232:235], v[24:27], v[88:91], v[232:235]
  v_mfma_f32_16x16x32_bf16 v[248:251], v[24:27], v[92:95], v[248:251]
  ds_read_b64_tr_b16 v[24:25], v6 offset:8192
  ds_read_b64_tr_b16 v[26:27], v6 offset:9216
  v_mfma_f32_16x16x32_bf16 v[204:207], v[28:31], v[80:83], v[204:207]
  v_mfma_f32_16x16x32_bf16 v[220:223], v[28:31], v[84:87], v[220:223]
  v_mfma_f32_16x16x32_bf16 v[236:239], v[28:31], v[88:91], v[236:239]
  v_mfma_f32_16x16x32_bf16 v[252:255], v[28:31], v[92:95], v[252:255]
  ds_read_b64_tr_b16 v[28:29], v7 offset:8192
  ds_read_b64_tr_b16 v[30:31], v7 offset:9216
  s_waitcnt vmcnt(4) lgkmcnt(4)
  v_mfma_f32_16x16x32_bf16 v[128:131], v[16:19], v[96:99], v[128:131]
  v_mfma_f32_16x16x32_bf16 v[144:147], v[16:19], v[100:103], v[144:147]
  v_mfma_f32_16x16x32_bf16 v[160:163], v[16:19], v[104:107], v[160:163]
  v_mfma_f32_16x16x32_bf16 v[176:179], v[16:19], v[108:111], v[176:179]
  v_mfma_f32_16x16x32_bf16 v[132:135], v[20:23], v[96:99], v[132:135]
  v_mfma_f32_16x16x32_bf16 v[148:151], v[20:23], v[100:103], v[148:151]
  v_mfma_f32_16x16x32_bf16 v[164:167], v[20:23], v[104:107], v[164:167]
  v_mfma_f32_16x16x32_bf16 v[180:183], v[20:23], v[108:111], v[180:183]
  s_waitcnt lgkmcnt(0)
  v_mfma_f32_16x16x32_bf16 v[136:139], v[24:27], v[96:99], v[136:139]
  v_mfma_f32_16x16x32_bf16 v[152:155], v[24:27], v[100:103], v[152:155]
  v_mfma_f32_16x16x32_bf16 v[168:171], v[24:27], v[104:107], v[168:171]
  v_mfma_f32_16x16x32_bf16 v[184:187], v[24:27], v[108:111], v[184:187]
  v_mfma_f32_16x16x32_bf16 v[140:143], v[28:31], v[96:99], v[140:143]
  v_mfma_f32_16x16x32_bf16 v[156:159], v[28:31], v[100:103], v[156:159]
  v_mfma_f32_16x16x32_bf16 v[172:175], v[28:31], v[104:107], v[172:175]
  v_mfma_f32_16x16x32_bf16 v[188:191], v[28:31], v[108:111], v[188:191]
  s_waitcnt vmcnt(0)
  v_mfma_f32_16x16x32_bf16 v[192:195], v[16:19], v[112:115], v[192:195]
  v_mfma_f32_16x16x32_bf16 v[208:211], v[16:19], v[116:119], v[208:211]
  v_mfma_f32_16x16x32_bf16 v[224:227], v[16:19], v[120:123], v[224:227]
  v_mfma_f32_16x16x32_bf16 v[240:243], v[16:19], v[124:127], v[240:243]
  v_mfma_f32_16x16x32_bf16 v[196:199], v[20:23], v[112:115], v[196:199]
  v_mfma_f32_16x16x32_bf16 v[212:215], v[20:23], v[116:119], v[212:215]
  v_mfma_f32_16x16x32_bf16 v[228:231], v[20:23], v[120:123], v[228:231]
  v_mfma_f32_16x16x32_bf16 v[244:247], v[20:23], v[124:127], v[244:247]
  v_mfma_f32_16x16x32_bf16 v[200:203], v[24:27], v[112:115], v[200:203]
  v_mfma_f32_16x16x32_bf16 v[216:219], v[24:27], v[116:119], v[216:219]
  v_mfma_f32_16x16x32_bf16 v[232:235], v[24:27], v[120:123], v[232:235]
  v_mfma_f32_16x16x32_bf16 v[248:251], v[24:27], v[124:127], v[248:251]
  v_mfma_f32_16x16x32_bf16 v[204:207], v[28:31], v[112:115], v[204:207]
  v_mfma_f32_16x16x32_bf16 v[220:223], v[28:31], v[116:119], v[220:223]
  v_mfma_f32_16x16x32_bf16 v[236:239], v[28:31], v[120:123], v[236:239]
  v_mfma_f32_16x16x32_bf16 v[252:255], v[28:31], v[124:127], v[252:255]
  s_branch parallel_sum__grouped_kv_mqa__mixer_channel_mlp__prompt_kernel_final
parallel_sum__grouped_kv_mqa__mixer_channel_mlp__prompt_kernel_gsw:
  v_mov_b32 v10, 2
  ds_write_b32 v14, v10
  s_cmp_eq_u32 s63, 8
  s_cbranch_scc0 parallel_sum__grouped_kv_mqa__mixer_channel_mlp__prompt_kernel_gsw_ret
  s_mov_b32 s28, s4
  s_mov_b32 s29, s5
  s_mov_b32 s30, 2097152
  s_mov_b32 s69, 0
  s_mov_b32 s66, s67
  s_lshl_b32 s57, s2, 2
  s_add_u32 s57, s57, s55
  s_lshl_b32 s57, s57, 11
  v_and_b32 v11, 31, v0
  v_lshlrev_b32 v11, 6, v11
  s_mov_b32 s71, 1
  v_add_u32 v3, 15360, v2
  s_mov_b32 s54, 30720
  s_mul_i32 s60, s48, 1024
  s_add_u32 s60, s60, 23642112
  v_lshrrev_b32 v10, 5, v0
  v_lshlrev_b32 v8, 1, v0
  v_lshl_add_u32 v8, v10, 24, v8
  s_lshl_b32 s53, 0x11111111, s55
  s_not_b32 s53, s53
  s_branch parallel_sum__grouped_kv_mqa__mixer_channel_mlp__prompt_kernel_gsw_ret
parallel_sum__grouped_kv_mqa__mixer_channel_mlp__prompt_kernel_gsel:
  s_mov_b32 s68, 0
parallel_sum__grouped_kv_mqa__mixer_channel_mlp__prompt_kernel_gsel_l:
  s_andn2_b32 s57, s52, s53
  s_cbranch_scc1 parallel_sum__grouped_kv_mqa__mixer_channel_mlp__prompt_kernel_gsel_ok
  s_add_u32 s68, s68, 1
  s_cmp_gt_u32 s68, 0x100000
  s_cselect_b32 s52, -1, s52
  s_cbranch_scc1 parallel_sum__grouped_kv_mqa__mixer_channel_mlp__prompt_kernel_gsel_l
  s_cmp_eq_u32 s68, 1
  s_cbranch_scc1 parallel_sum__grouped_kv_mqa__mixer_channel_mlp__prompt_kernel_gsel_fns
  s_sleep 2
  s_or_b32 s57, s55, s58
  s_cmp_eq_u32 s57, 0
  s_cbranch_scc0 parallel_sum__grouped_kv_mqa__mixer_channel_mlp__prompt_kernel_gsel_fns
  s_sleep 8
  buffer_load_ushort v10, v8, s[36:39], s60 offen sc1
  s_waitcnt vmcnt(0)
  v_cmp_eq_u32 vcc, 0x0101, v10
  s_nop 1
  v_mov_b32 v10, vcc_lo
  s_mov_b64 exec, 1
  ds_or_b32 v14, v10 offset:4
  s_mov_b64 exec, -1
parallel_sum__grouped_kv_mqa__mixer_channel_mlp__prompt_kernel_gsel_fns:
  ds_read_b32 v10, v14 offset:4
  ds_read_b32 v11, v14 offset:20
  s_waitcnt lgkmcnt(0)
  v_readfirstlane_b32 s52, v10
  v_readfirstlane_b32 s58, v11
  s_branch parallel_sum__grouped_kv_mqa__mixer_channel_mlp__prompt_kernel_gsel_l
parallel_sum__grouped_kv_mqa__mixer_channel_mlp__prompt_kernel_gsel_ok:
  s_ff1_i32_b32 s69, s57
  s_bitset1_b32 s53, s69
  s_lshr_b32 s69, s69, 2
  s_setpc_b64 s[74:75]
parallel_sum__grouped_kv_mqa__mixer_channel_mlp__prompt_kernel_final:
  v_lshrrev_b32 v2, 3, v0
  v_and_b32 v3, 7, v0
  s_lshl_b32 s57, s48, 7
  s_lshl_b32 s58, s55, 4
  s_add_u32 s57, s57, s58
  s_lshl_b32 s57, s57, 11
  s_lshl_b32 s59, s49, 7
  s_add_u32 s57, s57, s59
  s_add_u32 s58, s57, 16384
  v_lshlrev_b32 v4, 4, v3
  v_lshl_add_u32 v108, v2, 11, v4
  buffer_load_dwordx4 v[96:99], v108, s[24:27], s57 offen
  buffer_load_dwordx4 v[100:103], v108, s[24:27], s58 offen
  buffer_load_dwordx4 v[104:107], v4, s[40:43], s59 offen
  v_mul_u32_u24 v110, 272, v2
  v_lshl_add_u32 v110, v3, 5, v110
  s_mul_i32 s60, s55, 4352
  v_add_u32 v110, s60, v110
  v_add_u32 v111, 69632, v110
  s_waitcnt vmcnt(3) lgkmcnt(0)
  s_barrier
  s_cmp_ge_u32 s55, 4
  s_cbranch_scc1 parallel_sum__grouped_kv_mqa__mixer_channel_mlp__prompt_kernel_fin2
  v_and_b32 v2, 15, v0
  v_mul_u32_u24 v2, 272, v2
  v_lshrrev_b32 v3, 4, v0
  v_lshl_add_u32 v2, v3, 4, v2
  s_mul_i32 s60, s55, 34816
  v_add_u32 v2, s60, v2
  ds_write_b128 v2, v[128:131] offset:0
  ds_write_b128 v2, v[132:135] offset:64
  ds_write_b128 v2, v[136:139] offset:128
  ds_write_b128 v2, v[140:143] offset:192
  ds_write_b128 v2, v[144:147] offset:4352
  ds_write_b128 v2, v[148:151] offset:4416
  ds_write_b128 v2, v[152:155] offset:4480
  ds_write_b128 v2, v[156:159] offset:4544
  ds_write_b128 v2, v[160:163] offset:8704
  ds_write_b128 v2, v[164:167] offset:8768
  ds_write_b128 v2, v[168:171] offset:8832
  ds_write_b128 v2, v[172:175] offset:8896
  ds_write_b128 v2, v[176:179] offset:13056
  ds_write_b128 v2, v[180:183] offset:13120
  ds_write_b128 v2, v[184:187] offset:13184
  ds_write_b128 v2, v[188:191] offset:13248
  ds_write_b128 v2, v[192:195] offset:17408
  ds_write_b128 v2, v[196:199] offset:17472
  ds_write_b128 v2, v[200:203] offset:17536
  ds_write_b128 v2, v[204:207] offset:17600
  ds_write_b128 v2, v[208:211] offset:21760
  ds_write_b128 v2, v[212:215] offset:21824
  ds_write_b128 v2, v[216:219] offset:21888
  ds_write_b128 v2, v[220:223] offset:21952
  ds_write_b128 v2, v[224:227] offset:26112
  ds_write_b128 v2, v[228:231] offset:26176
  ds_write_b128 v2, v[232:235] offset:26240
  ds_write_b128 v2, v[236:239] offset:26304
  ds_write_b128 v2, v[240:243] offset:30464
  ds_write_b128 v2, v[244:247] offset:30528
  ds_write_b128 v2, v[248:251] offset:30592
  ds_write_b128 v2, v[252:255] offset:30656
  s_waitcnt lgkmcnt(0)
parallel_sum__grouped_kv_mqa__mixer_channel_mlp__prompt_kernel_fin2:
  s_barrier
  ds_read_b128 v[16:19], v110 offset:0
  ds_read_b128 v[20:23], v110 offset:16
  ds_read_b128 v[24:27], v110 offset:34816
  ds_read_b128 v[28:31], v110 offset:34832
  ds_read_b128 v[32:35], v111 offset:0
  ds_read_b128 v[36:39], v111 offset:16
  ds_read_b128 v[40:43], v111 offset:34816
  ds_read_b128 v[44:47], v111 offset:34832
  ds_read_b128 v[48:51], v110 offset:2176
  ds_read_b128 v[52:55], v110 offset:2192
  ds_read_b128 v[56:59], v110 offset:36992
  ds_read_b128 v[60:63], v110 offset:37008
  ds_read_b128 v[64:67], v111 offset:2176
  ds_read_b128 v[68:71], v111 offset:2192
  ds_read_b128 v[72:75], v111 offset:36992
  ds_read_b128 v[76:79], v111 offset:37008
  s_waitcnt vmcnt(0)
  v_lshlrev_b32 v80, 16, v104
  v_and_b32 v81, 0xffff0000, v104
  v_lshlrev_b32 v82, 16, v105
  v_and_b32 v83, 0xffff0000, v105
  v_lshlrev_b32 v84, 16, v106
  v_and_b32 v85, 0xffff0000, v106
  v_lshlrev_b32 v86, 16, v107
  v_and_b32 v87, 0xffff0000, v107
  v_lshlrev_b32 v88, 16, v96
  v_and_b32 v89, 0xffff0000, v96
  v_lshlrev_b32 v90, 16, v97
  v_and_b32 v91, 0xffff0000, v97
  v_lshlrev_b32 v92, 16, v98
  v_and_b32 v93, 0xffff0000, v98
  v_lshlrev_b32 v94, 16, v99
  v_and_b32 v95, 0xffff0000, v99
  v_pk_add_f32 v[88:89], v[88:89], v[80:81]
  v_pk_add_f32 v[90:91], v[90:91], v[82:83]
  v_pk_add_f32 v[92:93], v[92:93], v[84:85]
  v_pk_add_f32 v[94:95], v[94:95], v[86:87]
  s_waitcnt lgkmcnt(8)
  v_pk_add_f32 v[16:17], v[16:17], v[24:25]
  v_pk_add_f32 v[32:33], v[32:33], v[40:41]
  v_pk_add_f32 v[18:19], v[18:19], v[26:27]
  v_pk_add_f32 v[34:35], v[34:35], v[42:43]
  v_pk_add_f32 v[20:21], v[20:21], v[28:29]
  v_pk_add_f32 v[36:37], v[36:37], v[44:45]
  v_pk_add_f32 v[22:23], v[22:23], v[30:31]
  v_pk_add_f32 v[38:39], v[38:39], v[46:47]
  v_pk_add_f32 v[16:17], v[16:17], v[32:33]
  v_pk_add_f32 v[18:19], v[18:19], v[34:35]
  v_pk_add_f32 v[20:21], v[20:21], v[36:37]
  v_pk_add_f32 v[22:23], v[22:23], v[38:39]
  v_pk_add_f32 v[16:17], v[16:17], v[88:89]
  v_pk_add_f32 v[18:19], v[18:19], v[90:91]
  v_pk_add_f32 v[20:21], v[20:21], v[92:93]
  v_pk_add_f32 v[22:23], v[22:23], v[94:95]
  v_cvt_pk_bf16_f32 v24, v16, v17
  v_cvt_pk_bf16_f32 v25, v18, v19
  v_cvt_pk_bf16_f32 v26, v20, v21
  v_cvt_pk_bf16_f32 v27, v22, v23
  buffer_store_dwordx4 v[24:27], v108, s[44:47], s57 offen
  v_lshlrev_b32 v88, 16, v100
  v_and_b32 v89, 0xffff0000, v100
  v_lshlrev_b32 v90, 16, v101
  v_and_b32 v91, 0xffff0000, v101
  v_lshlrev_b32 v92, 16, v102
  v_and_b32 v93, 0xffff0000, v102
  v_lshlrev_b32 v94, 16, v103
  v_and_b32 v95, 0xffff0000, v103
  v_pk_add_f32 v[88:89], v[88:89], v[80:81]
  v_pk_add_f32 v[90:91], v[90:91], v[82:83]
  v_pk_add_f32 v[92:93], v[92:93], v[84:85]
  v_pk_add_f32 v[94:95], v[94:95], v[86:87]
  s_waitcnt lgkmcnt(0)
  v_pk_add_f32 v[48:49], v[48:49], v[56:57]
  v_pk_add_f32 v[64:65], v[64:65], v[72:73]
  v_pk_add_f32 v[50:51], v[50:51], v[58:59]
  v_pk_add_f32 v[66:67], v[66:67], v[74:75]
  v_pk_add_f32 v[52:53], v[52:53], v[60:61]
  v_pk_add_f32 v[68:69], v[68:69], v[76:77]
  v_pk_add_f32 v[54:55], v[54:55], v[62:63]
  v_pk_add_f32 v[70:71], v[70:71], v[78:79]
  v_pk_add_f32 v[48:49], v[48:49], v[64:65]
  v_pk_add_f32 v[50:51], v[50:51], v[66:67]
  v_pk_add_f32 v[52:53], v[52:53], v[68:69]
  v_pk_add_f32 v[54:55], v[54:55], v[70:71]
  v_pk_add_f32 v[48:49], v[48:49], v[88:89]
  v_pk_add_f32 v[50:51], v[50:51], v[90:91]
  v_pk_add_f32 v[52:53], v[52:53], v[92:93]
  v_pk_add_f32 v[54:55], v[54:55], v[94:95]
  v_cvt_pk_bf16_f32 v56, v48, v49
  v_cvt_pk_bf16_f32 v57, v50, v51
  v_cvt_pk_bf16_f32 v58, v52, v53
  v_cvt_pk_bf16_f32 v59, v54, v55
  buffer_store_dwordx4 v[56:59], v108, s[44:47], s58 offen
parallel_sum__grouped_kv_mqa__mixer_channel_mlp__prompt_kernel_exit:
  s_endpgm
code_end:
.section .rodata,"a"
.p2align 6
.amdhsa_kernel parallel_sum__grouped_kv_mqa__mixer_channel_mlp__prompt_kernel
  .amdhsa_next_free_vgpr 256
  .amdhsa_next_free_sgpr 102
  .amdhsa_accum_offset 256
  .amdhsa_group_segment_fixed_size 0
  .amdhsa_kernarg_size 104
  .amdhsa_user_sgpr_count 2
  .amdhsa_user_sgpr_kernarg_segment_ptr 1
  .amdhsa_system_sgpr_workgroup_id_x 1
.end_amdhsa_kernel
```
